```python
import torch

def _softmax(x, axis=-1):
    return torch.softmax(x, dim=axis)
def _gelu(x):
    return torch.nn.functional.gelu(x, approximate="tanh")
def _silu(x):
    return torch.nn.functional.silu(x)
def _sigmoid(x):
    return torch.sigmoid(x)
def _layernorm(x, axis=-1, eps=1e-5):
    m = x.mean(dim=axis, keepdim=True)
    v = x.var(dim=axis, keepdim=True, unbiased=False)
    return (x - m) / torch.sqrt(v + eps)
def _scatter_add(tgt, idx, src, axis=0):
    return tgt.clone().index_add_(axis, idx, src)
def _segment_sum(src, seg, n):
    out = torch.zeros((n,) + src.shape[1:], dtype=src.dtype)
    return out.index_add_(0, seg, src)
def _pad(x, pw):
    flat = tuple(v for pair in reversed(pw) for v in pair)
    return torch.nn.functional.pad(x, flat)

kernel_name = 'interleave_layers__sliding_block__mixer_channel_mlp__prompt'

def setup_inputs():

    _w = (lambda a: (lambda t: t.to(torch.bfloat16) if t.is_floating_point() else t)(torch.as_tensor(a)))
    def _A_setup():
        B, S, D = 1, 2048, 640
        return {
            "x": _w((lambda *s: torch.randn(*s, dtype=torch.bfloat16) * 0.05)(B, S, D)),
            "wqkv": _w((lambda *s: torch.randn(*s, dtype=torch.bfloat16) * 0.05)(D, 3 * D)),
            "wo": _w((lambda *s: torch.randn(*s, dtype=torch.bfloat16) * 0.05)(D, D)),
        }
    _A_in = _A_setup()

    def _B_setup():
        B, S, D, F = 1, 2048, 640, 1728
        return {
            "x": _w((lambda *s: torch.randn(*s, dtype=torch.bfloat16) * 0.05)(B, S, D)),
            "w1": _w((lambda *s: torch.randn(*s, dtype=torch.bfloat16) * 1.6)(D, F) * (D ** -0.5)),
            "b1": _w((lambda *s: torch.randn(*s, dtype=torch.bfloat16) * 1.6)(F)),
            "w2": _w((lambda *s: torch.randn(*s, dtype=torch.bfloat16) * 0.4)(F, D) * (F ** -0.5)),
            "b2": _w((lambda *s: torch.randn(*s, dtype=torch.bfloat16) * 0.4)(D)),
        }
    _B_in = _B_setup()

    return {
        "A_x": _A_in["x"],
        "A_wqkv": _A_in["wqkv"],
        "A_wo": _A_in["wo"],
        "B_x": _B_in["x"],
        "B_w1": _B_in["w1"],
        "B_b1": _B_in["b1"],
        "B_w2": _B_in["w2"],
        "B_b2": _B_in["b2"],
    }

def reference(A_x, A_wqkv, A_wo, B_x, B_w1, B_b1, B_w2, B_b2):
    def _A_ref(x, wqkv, wo):
        B, S, D = x.shape
        H = 32; Dh = D // H; W = 256
        qkv = (lambda x, *d: x.permute(*d))((x @ wqkv).reshape(B, S, 3, H, Dh), 2, 0, 3, 1, 4)
        q, k, v = qkv[0], qkv[1], qkv[2]
        scores = torch.einsum("bhqd,bhkd->bhqk", q, k) * (Dh ** -0.5)
        idx = torch.arange(S)
        mask = (idx[:, None] - idx[None, :] >= 0) & (idx[:, None] - idx[None, :] < W)
        scores = torch.where(mask[None, None], scores, -1e9)
        p = _softmax(scores, axis=-1)
        o = torch.einsum("bhqk,bhkd->bhqd", p, v)
        return (lambda x, *d: x.permute(*d))(o, 0, 2, 1, 3).reshape(B, S, D) @ wo

    def _B_ref(x, w1, b1, w2, b2):
        y = _layernorm(x, axis=-1)
        h = _gelu(torch.einsum("bsd,df->bsf", y, w1) + b1)
        return torch.einsum("bsf,fd->bsd", h, w2) + b2

    x = A_x
    x = x + _A_ref(_layernorm(x, axis=-1), A_wqkv, A_wo)
    x = x + _B_ref(_layernorm(x, axis=-1), B_w1, B_b1, B_w2, B_b2)
    x = x + _A_ref(_layernorm(x, axis=-1), A_wqkv, A_wo)
    x = x + _B_ref(_layernorm(x, axis=-1), B_w1, B_b1, B_w2, B_b2)
    return x
```

```asm
; @launch grid=(256,1,1) block=(512,1,1) lds=163840
.amdgcn_target "amdgcn-amd-amdhsa--gfx950"
.text
.globl interleave_layers__sliding_block__mixer_channel_mlp__prompt_kernel
.p2align 8
.type interleave_layers__sliding_block__mixer_channel_mlp__prompt_kernel,@function
interleave_layers__sliding_block__mixer_channel_mlp__prompt_kernel:
  s_cmp_ge_u32 s2, 256
  s_cbranch_scc1 L_EXIT
  s_load_dwordx16 s[56:71], s[0:1], 0
  s_load_dwordx4 s[72:75], s[0:1], 64
  s_load_dwordx2 s[76:77], s[0:1], 80
  s_getreg_b32 s4, hwreg(HW_REG_XCC_ID)
  v_and_b32 v254, 63, v0
  v_lshrrev_b32 v1, 6, v0
  v_lshlrev_b32 v255, 4, v254
  v_readfirstlane_b32 s3, v1
  s_and_b32 s4, s4, 7
  s_waitcnt lgkmcnt(0)
  s_mov_b64 s[32:33], s[56:57]
  s_mov_b64 s[34:35], s[66:67]
  s_mov_b64 s[36:37], s[70:71]
  s_mov_b64 s[38:39], s[72:73]
  s_mov_b64 s[40:41], s[74:75]
  s_mov_b32 s8, s76
  s_and_b32 s9, s77, 0xffff
  s_mov_b32 s10, 268435456
  s_mov_b32 s11, 0x20000
  s_mov_b32 s12, s58
  s_and_b32 s13, s59, 0xffff
  s_mov_b32 s14, 2457600
  s_mov_b32 s15, 0x20000
  s_mov_b32 s16, s60
  s_and_b32 s17, s61, 0xffff
  s_mov_b32 s18, 819200
  s_mov_b32 s19, 0x20000
  s_mov_b32 s20, s64
  s_and_b32 s21, s65, 0xffff
  s_mov_b32 s22, 2211840
  s_mov_b32 s23, 0x20000
  s_mov_b32 s24, s68
  s_and_b32 s25, s69, 0xffff
  s_mov_b32 s26, 2211840
  s_mov_b32 s27, 0x20000
  s_mov_b32 s42, 0
  s_cmp_lg_u32 s3, 4
  s_cbranch_scc1 CP_1
  s_getpc_b64 s[28:29]
  s_and_b32 s28, s28, 0xffffff00
  s_and_b32 s29, s29, 0xffff
  s_mov_b32 s30, L_CODE_END - interleave_layers__sliding_block__mixer_channel_mlp__prompt_kernel - 512
  s_mov_b32 s31, 0x20000
  s_lshr_b32 s54, s2, 3
  s_and_b32 s54, s54, 31
  s_lshl_b32 s54, s54, 11
  buffer_load_dwordx4 v[100:103], v255, s[28:31], s54 offen
  buffer_load_dwordx4 v[104:107], v255, s[28:31], s54 offen offset:1024
CP_1:
  s_lshr_b32 s5, s2, 3
  s_and_b32 s5, s5, 31
  s_mov_b32 s6, 0
  s_cmp_lg_u32 s3, 0
  s_cbranch_scc1 TK_2
  s_mov_b32 s28, s40
  s_and_b32 s29, s41, 0xffff
  s_mov_b32 s30, 256
  s_mov_b32 s31, 0x20000
  s_mov_b64 exec, 1
  s_lshl_b32 s54, s4, 5
  v_mov_b32 v100, s54
  s_lshl_b32 s56, 1, s5
  v_mov_b32 v101, s56
  v_mov_b32 v102, 0
  s_mov_b32 s55, 47316992
  buffer_atomic_or v101, v100, s[28:31], 0 offen sc0 sc1
  buffer_load_dword v103, v102, s[8:11], s55 offen sc1
  v_mov_b32 v8, 0
  v_mov_b32 v9, 0
  v_mov_b32 v10, 0
  v_mov_b32 v11, 0
  v_mov_b32 v2, 161792
  ds_write_b128 v2, v[8:11]
  ds_write_b128 v2, v[8:11] offset:16
  v_mov_b32 v2, 161856
  ds_write_b128 v2, v[8:11]
  ds_write_b128 v2, v[8:11] offset:16
  ds_write_b128 v2, v[8:11] offset:32
  ds_write_b128 v2, v[8:11] offset:48
  ds_write_b128 v2, v[8:11] offset:64
  ds_write_b128 v2, v[8:11] offset:96
  s_waitcnt lgkmcnt(0)
  s_mov_b64 exec, -1
TK_2:
  v_add_u32 v2, 0, v254
  v_mul_u32_u24 v3, 6554, v2
  v_lshrrev_b32 v3, 16, v3
  v_mul_u32_u24 v4, 10, v3
  v_sub_u32 v4, v2, v4
  v_mul_u32_u24 v7, 86, v4
  v_lshrrev_b32 v7, 8, v7
  v_mul_u32_u24 v8, 3, v7
  v_sub_u32 v8, v4, v8
  v_mul_u32_u24 v7, 1280, v7
  v_lshlrev_b32 v9, 4, v8
  v_lshrrev_b32 v8, 1, v8
  v_lshlrev_b32 v8, 3, v8
  v_sub_u32 v9, v9, v8
  v_add_u32 v7, v7, v9
  v_mul_u32_u24 v5, 3840, v3
  v_add_u32 v7, v7, v5
  v_mov_b32 v8, 0x80000000
  v_cmp_eq_u32 vcc, 9, v4
  s_nop 1
  v_cndmask_b32 v224, v7, v8, vcc
  v_add_u32 v2, 64, v254
  v_mul_u32_u24 v3, 6554, v2
  v_lshrrev_b32 v3, 16, v3
  v_mul_u32_u24 v4, 10, v3
  v_sub_u32 v4, v2, v4
  v_mul_u32_u24 v7, 86, v4
  v_lshrrev_b32 v7, 8, v7
  v_mul_u32_u24 v8, 3, v7
  v_sub_u32 v8, v4, v8
  v_mul_u32_u24 v7, 1280, v7
  v_lshlrev_b32 v9, 4, v8
  v_lshrrev_b32 v8, 1, v8
  v_lshlrev_b32 v8, 3, v8
  v_sub_u32 v9, v9, v8
  v_add_u32 v7, v7, v9
  v_mul_u32_u24 v5, 3840, v3
  v_add_u32 v7, v7, v5
  v_mov_b32 v8, 0x80000000
  v_cmp_eq_u32 vcc, 9, v4
  s_nop 1
  v_cndmask_b32 v225, v7, v8, vcc
  v_add_u32 v2, 128, v254
  v_mul_u32_u24 v3, 6554, v2
  v_lshrrev_b32 v3, 16, v3
  v_mul_u32_u24 v4, 10, v3
  v_sub_u32 v4, v2, v4
  v_mul_u32_u24 v7, 86, v4
  v_lshrrev_b32 v7, 8, v7
  v_mul_u32_u24 v8, 3, v7
  v_sub_u32 v8, v4, v8
  v_mul_u32_u24 v7, 1280, v7
  v_lshlrev_b32 v9, 4, v8
  v_lshrrev_b32 v8, 1, v8
  v_lshlrev_b32 v8, 3, v8
  v_sub_u32 v9, v9, v8
  v_add_u32 v7, v7, v9
  v_mul_u32_u24 v5, 3840, v3
  v_add_u32 v7, v7, v5
  v_mov_b32 v8, 0x80000000
  v_cmp_eq_u32 vcc, 9, v4
  s_nop 1
  v_cndmask_b32 v226, v7, v8, vcc
  v_add_u32 v2, 192, v254
  v_mul_u32_u24 v3, 6554, v2
  v_lshrrev_b32 v3, 16, v3
  v_mul_u32_u24 v4, 10, v3
  v_sub_u32 v4, v2, v4
  v_mul_u32_u24 v7, 86, v4
  v_lshrrev_b32 v7, 8, v7
  v_mul_u32_u24 v8, 3, v7
  v_sub_u32 v8, v4, v8
  v_mul_u32_u24 v7, 1280, v7
  v_lshlrev_b32 v9, 4, v8
  v_lshrrev_b32 v8, 1, v8
  v_lshlrev_b32 v8, 3, v8
  v_sub_u32 v9, v9, v8
  v_add_u32 v7, v7, v9
  v_mul_u32_u24 v5, 3840, v3
  v_add_u32 v7, v7, v5
  v_mov_b32 v8, 0x80000000
  v_cmp_eq_u32 vcc, 9, v4
  s_nop 1
  v_cndmask_b32 v227, v7, v8, vcc
  v_add_u32 v2, 256, v254
  v_mul_u32_u24 v3, 6554, v2
  v_lshrrev_b32 v3, 16, v3
  v_mul_u32_u24 v4, 10, v3
  v_sub_u32 v4, v2, v4
  v_mul_u32_u24 v7, 86, v4
  v_lshrrev_b32 v7, 8, v7
  v_mul_u32_u24 v8, 3, v7
  v_sub_u32 v8, v4, v8
  v_mul_u32_u24 v7, 1280, v7
  v_lshlrev_b32 v9, 4, v8
  v_lshrrev_b32 v8, 1, v8
  v_lshlrev_b32 v8, 3, v8
  v_sub_u32 v9, v9, v8
  v_add_u32 v7, v7, v9
  v_mul_u32_u24 v5, 3840, v3
  v_add_u32 v7, v7, v5
  v_mov_b32 v8, 0x80000000
  v_cmp_eq_u32 vcc, 9, v4
  s_nop 1
  v_cndmask_b32 v228, v7, v8, vcc
  v_lshrrev_b32 v2, 2, v254
  v_and_b32 v3, 3, v254
  v_lshlrev_b32 v3, 3, v3
  v_mul_u32_u24 v4, 160, v2
  v_add_u32 v253, v4, v3
  v_mul_u32_u24 v4, 224, v2
  v_add_u32 v252, v4, v3
  s_barrier
  s_cmp_eq_u32 s42, 0
  s_mov_b32 s84, 3145728
  s_cselect_b32 s43, 0, s84
  s_mov_b32 s84, 46268416
  s_cselect_b32 s44, 46137344, s84
  s_mov_b32 s84, 9437184
  s_cselect_b32 s45, 6291456, s84
  s_mov_b32 s84, 46530560
  s_cselect_b32 s46, 46399488, s84
  s_mov_b32 s84, 15728640
  s_cselect_b32 s47, 12582912, s84
  s_mov_b32 s84, 26214400
  s_cselect_b32 s48, 18874368, s84
  s_mov_b32 s84, 39845888
  s_cselect_b32 s49, 33554432, s84
  s_mov_b32 s84, 3145728
  s_cselect_b32 s50, 3145728, s84
  s_mov_b32 s84, 46268416
  s_cselect_b32 s51, 46268416, s84
  s_mov_b32 s84, 47218688
  s_cselect_b32 s52, 47185920, s84
  s_cmp_ge_u32 s3, 4
  s_cbranch_scc1 L_H0
  s_mov_b32 s71, 0
  s_mov_b32 s70, 0
L_P0C:
  s_lshl_b32 s54, s4, 4
  s_lshr_b32 s55, s5, 1
  s_add_u32 s54, s54, s55
  s_and_b32 s55, s5, 1
  s_mul_i32 s56, s55, 10
  s_add_u32 s56, s56, s3
  s_lshl_b32 s57, s55, 2
  s_add_u32 s57, s57, s3
  s_mov_b32 s28, s32
  s_and_b32 s29, s33, 0xffff
  s_mov_b32 s30, 2621440
  s_mov_b32 s31, 0x20000
  v_and_b32 v2, 15, v254
  v_mul_u32_u24 v2, 1280, v2
  v_lshrrev_b32 v3, 4, v254
  v_lshlrev_b32 v3, 3, v3
  v_add_u32 v2, v2, v3
  s_mul_i32 s58, s54, 20480
  s_lshl_b32 s59, s56, 6
  s_add_u32 s58, s58, s59
  s_add_u32 s59, s58, 0
  buffer_load_dwordx2 v[8:9], v2, s[28:31], s59 offen
  buffer_load_dwordx2 v[10:11], v2, s[28:31], s59 offen offset:32
  s_add_u32 s59, s58, 256
  buffer_load_dwordx2 v[12:13], v2, s[28:31], s59 offen
  buffer_load_dwordx2 v[14:15], v2, s[28:31], s59 offen offset:32
  s_cmp_lt_u32 s3, 2
  s_cselect_b32 s59, 512, 0
  s_add_u32 s59, s59, s58
  buffer_load_dwordx2 v[16:17], v2, s[28:31], s59 offen
  buffer_load_dwordx2 v[18:19], v2, s[28:31], s59 offen offset:32
  s_mov_b32 s94, s54
  s_mov_b32 s95, s56
  s_mov_b32 s96, s57
  s_cmp_lg_u32 s3, 0
  s_cbranch_scc1 NRC_3
  s_cmp_lg_u32 s71, 0
  s_cbranch_scc1 NRC_3
  s_waitcnt vmcnt(6)
  v_readfirstlane_b32 s84, v101
  v_readfirstlane_b32 s7, v103
  s_nop 0
  s_mul_i32 s7, s7, 0x9E3779B1
  s_add_u32 s7, s7, 0x7F4A7C15
  s_mov_b32 s92, 1
  s_mov_b32 s93, 0
  s_lshr_b32 s85, s84, s5
  s_and_b32 s85, s85, 1
  s_cmp_eq_u32 s85, 0
  s_cbranch_scc1 RP_7
  s_mov_b32 s92, 2
  s_mov_b32 s28, s40
  s_and_b32 s29, s41, 0xffff
  s_mov_b32 s30, 256
  s_mov_b32 s31, 0x20000
RL_5:
  s_cmp_eq_u32 s84, -1
  s_cbranch_scc1 RO_6
  s_ff0_i32_b32 s5, s84
  s_lshl_b32 s85, 1, s5
  s_lshl_b32 s86, s4, 5
  s_mov_b64 exec, 1
  v_mov_b32 v100, s86
  v_mov_b32 v101, s85
  buffer_atomic_or v101, v100, s[28:31], 0 offen sc0 sc1
  s_waitcnt vmcnt(0)
  s_mov_b64 exec, -1
  v_readfirstlane_b32 s84, v101
  s_nop 0
  s_and_b32 s85, s84, s85
  s_cmp_eq_u32 s85, 0
  s_cbranch_scc1 RP_7
  s_branch RL_5
RO_6:
  s_lshl_b32 s86, s4, 5
  s_add_u32 s86, s86, 4
  s_mov_b64 exec, 1
  v_mov_b32 v100, s86
  v_mov_b32 v101, 1
  buffer_atomic_add v101, v100, s[28:31], 0 offen sc0 sc1
  s_waitcnt vmcnt(0)
  s_mov_b64 exec, -1
  v_readfirstlane_b32 s87, v101
  s_mov_b32 s90, 0
RW_8:
  s_mov_b64 exec, 0xff
  v_lshlrev_b32 v40, 5, v254
  buffer_load_dwordx2 v[42:43], v40, s[28:31], 0 offen sc1
  s_waitcnt vmcnt(0)
  v_bcnt_u32_b32 v44, v42, v43
  s_mov_b64 exec, -1
  s_mov_b32 s89, 0
  v_readlane_b32 s88, v44, 0
  s_nop 0
  s_add_u32 s89, s89, s88
  v_readlane_b32 s88, v44, 1
  s_nop 0
  s_add_u32 s89, s89, s88
  v_readlane_b32 s88, v44, 2
  s_nop 0
  s_add_u32 s89, s89, s88
  v_readlane_b32 s88, v44, 3
  s_nop 0
  s_add_u32 s89, s89, s88
  v_readlane_b32 s88, v44, 4
  s_nop 0
  s_add_u32 s89, s89, s88
  v_readlane_b32 s88, v44, 5
  s_nop 0
  s_add_u32 s89, s89, s88
  v_readlane_b32 s88, v44, 6
  s_nop 0
  s_add_u32 s89, s89, s88
  v_readlane_b32 s88, v44, 7
  s_nop 0
  s_add_u32 s89, s89, s88
  s_add_u32 s90, s90, 1
  s_cmp_ge_u32 s89, 256
  s_cbranch_scc1 RW_8_d
  s_cmp_lt_u32 s90, 0x100000
  s_cbranch_scc1 RW_8
RW_8_d:
  v_readlane_b32 s88, v43, 0
  s_cmp_gt_u32 s4, 0
  s_cselect_b32 s88, s88, 0
  s_add_u32 s87, s87, s88
  v_readlane_b32 s88, v43, 1
  s_cmp_gt_u32 s4, 1
  s_cselect_b32 s88, s88, 0
  s_add_u32 s87, s87, s88
  v_readlane_b32 s88, v43, 2
  s_cmp_gt_u32 s4, 2
  s_cselect_b32 s88, s88, 0
  s_add_u32 s87, s87, s88
  v_readlane_b32 s88, v43, 3
  s_cmp_gt_u32 s4, 3
  s_cselect_b32 s88, s88, 0
  s_add_u32 s87, s87, s88
  v_readlane_b32 s88, v43, 4
  s_cmp_gt_u32 s4, 4
  s_cselect_b32 s88, s88, 0
  s_add_u32 s87, s87, s88
  v_readlane_b32 s88, v43, 5
  s_cmp_gt_u32 s4, 5
  s_cselect_b32 s88, s88, 0
  s_add_u32 s87, s87, s88
  v_readlane_b32 s88, v43, 6
  s_cmp_gt_u32 s4, 6
  s_cselect_b32 s88, s88, 0
  s_add_u32 s87, s87, s88
  v_readlane_b32 s88, v43, 7
  s_cmp_gt_u32 s4, 7
  s_cselect_b32 s88, s88, 0
  s_add_u32 s87, s87, s88
  v_readlane_b32 s84, v42, 0
  s_nop 0
  s_bcnt0_i32_b32 s85, s84
  s_cmp_lt_u32 s87, s85
  s_cbranch_scc0 RN_10
RB_11:
  s_ff0_i32_b32 s5, s84
  s_cmp_eq_u32 s87, 0
  s_cbranch_scc1 RB_11_d
  s_bitset1_b32 s84, s5
  s_sub_u32 s87, s87, 1
  s_branch RB_11
RB_11_d:
  s_mov_b32 s4, 0
  s_branch RF_9
RN_10:
  s_sub_u32 s87, s87, s85
  v_readlane_b32 s84, v42, 1
  s_nop 0
  s_bcnt0_i32_b32 s85, s84
  s_cmp_lt_u32 s87, s85
  s_cbranch_scc0 RN_12
RB_13:
  s_ff0_i32_b32 s5, s84
  s_cmp_eq_u32 s87, 0
  s_cbranch_scc1 RB_13_d
  s_bitset1_b32 s84, s5
  s_sub_u32 s87, s87, 1
  s_branch RB_13
RB_13_d:
  s_mov_b32 s4, 1
  s_branch RF_9
RN_12:
  s_sub_u32 s87, s87, s85
  v_readlane_b32 s84, v42, 2
  s_nop 0
  s_bcnt0_i32_b32 s85, s84
  s_cmp_lt_u32 s87, s85
  s_cbranch_scc0 RN_14
RB_15:
  s_ff0_i32_b32 s5, s84
  s_cmp_eq_u32 s87, 0
  s_cbranch_scc1 RB_15_d
  s_bitset1_b32 s84, s5
  s_sub_u32 s87, s87, 1
  s_branch RB_15
RB_15_d:
  s_mov_b32 s4, 2
  s_branch RF_9
RN_14:
  s_sub_u32 s87, s87, s85
  v_readlane_b32 s84, v42, 3
  s_nop 0
  s_bcnt0_i32_b32 s85, s84
  s_cmp_lt_u32 s87, s85
  s_cbranch_scc0 RN_16
RB_17:
  s_ff0_i32_b32 s5, s84
  s_cmp_eq_u32 s87, 0
  s_cbranch_scc1 RB_17_d
  s_bitset1_b32 s84, s5
  s_sub_u32 s87, s87, 1
  s_branch RB_17
RB_17_d:
  s_mov_b32 s4, 3
  s_branch RF_9
RN_16:
  s_sub_u32 s87, s87, s85
  v_readlane_b32 s84, v42, 4
  s_nop 0
  s_bcnt0_i32_b32 s85, s84
  s_cmp_lt_u32 s87, s85
  s_cbranch_scc0 RN_18
RB_19:
  s_ff0_i32_b32 s5, s84
  s_cmp_eq_u32 s87, 0
  s_cbranch_scc1 RB_19_d
  s_bitset1_b32 s84, s5
  s_sub_u32 s87, s87, 1
  s_branch RB_19
RB_19_d:
  s_mov_b32 s4, 4
  s_branch RF_9
RN_18:
  s_sub_u32 s87, s87, s85
  v_readlane_b32 s84, v42, 5
  s_nop 0
  s_bcnt0_i32_b32 s85, s84
  s_cmp_lt_u32 s87, s85
  s_cbranch_scc0 RN_20
RB_21:
  s_ff0_i32_b32 s5, s84
  s_cmp_eq_u32 s87, 0
  s_cbranch_scc1 RB_21_d
  s_bitset1_b32 s84, s5
  s_sub_u32 s87, s87, 1
  s_branch RB_21
RB_21_d:
  s_mov_b32 s4, 5
  s_branch RF_9
RN_20:
  s_sub_u32 s87, s87, s85
  v_readlane_b32 s84, v42, 6
  s_nop 0
  s_bcnt0_i32_b32 s85, s84
  s_cmp_lt_u32 s87, s85
  s_cbranch_scc0 RN_22
RB_23:
  s_ff0_i32_b32 s5, s84
  s_cmp_eq_u32 s87, 0
  s_cbranch_scc1 RB_23_d
  s_bitset1_b32 s84, s5
  s_sub_u32 s87, s87, 1
  s_branch RB_23
RB_23_d:
  s_mov_b32 s4, 6
  s_branch RF_9
RN_22:
  s_sub_u32 s87, s87, s85
  v_readlane_b32 s84, v42, 7
  s_nop 0
  s_bcnt0_i32_b32 s85, s84
  s_cmp_lt_u32 s87, s85
  s_cbranch_scc0 RN_24
RB_25:
  s_ff0_i32_b32 s5, s84
  s_cmp_eq_u32 s87, 0
  s_cbranch_scc1 RB_25_d
  s_bitset1_b32 s84, s5
  s_sub_u32 s87, s87, 1
  s_branch RB_25
RB_25_d:
  s_mov_b32 s4, 7
  s_branch RF_9
RN_24:
  s_sub_u32 s87, s87, s85
RF_9:
  s_mov_b32 s93, 1
RP_7:
  s_mov_b64 exec, 1
  v_mov_b32 v2, 161792
  v_mov_b32 v4, s4
  v_mov_b32 v5, s5
  v_mov_b32 v6, s7
  v_mov_b32 v7, s93
  ds_write_b128 v2, v[4:7]
  s_waitcnt lgkmcnt(0)
  v_mov_b32 v4, s92
  ds_write_b32 v2, v4 offset:16
  s_waitcnt lgkmcnt(0)
  s_mov_b64 exec, -1
NRC_3:
  s_mov_b32 s92, 161808
  s_mov_b32 s93, 1
  v_mov_b32 v220, s92
  s_mov_b32 s90, 0
LW_26:
  ds_read_b32 v216, v220
  s_waitcnt lgkmcnt(0)
  v_readfirstlane_b32 s91, v216
  s_add_u32 s90, s90, 1
  s_cmp_ge_u32 s91, s93
  s_cbranch_scc1 LWD_27
  s_sleep 1
  s_cmp_lt_u32 s90, 0x400000
  s_cbranch_scc1 LW_26
LWD_27:
  v_mov_b32 v40, 161792
  ds_read_b128 v[44:47], v40
  s_waitcnt lgkmcnt(0)
  v_readfirstlane_b32 s4, v44
  v_readfirstlane_b32 s5, v45
  v_readfirstlane_b32 s7, v46
  v_readfirstlane_b32 s6, v47
  s_cmp_lt_u32 s91, 2
  s_cbranch_scc1 RD_28
  s_cmp_lg_u32 s71, 0
  s_cbranch_scc1 RD_28
  s_mov_b32 s71, 1
  s_branch L_P0C
RD_28:
  s_waitcnt vmcnt(0)
  v_mov_b32 v20, 0
  v_mov_b32 v21, 0
  s_mov_b32 s54, 0x3f803f80
  v_dot2_f32_bf16 v20, v8, s54, v20
  v_dot2_f32_bf16 v21, v8, v8, v21
  v_dot2_f32_bf16 v20, v9, s54, v20
  v_dot2_f32_bf16 v21, v9, v9, v21
  v_dot2_f32_bf16 v20, v10, s54, v20
  v_dot2_f32_bf16 v21, v10, v10, v21
  v_dot2_f32_bf16 v20, v11, s54, v20
  v_dot2_f32_bf16 v21, v11, v11, v21
  v_dot2_f32_bf16 v20, v12, s54, v20
  v_dot2_f32_bf16 v21, v12, v12, v21
  v_dot2_f32_bf16 v20, v13, s54, v20
  v_dot2_f32_bf16 v21, v13, v13, v21
  v_dot2_f32_bf16 v20, v14, s54, v20
  v_dot2_f32_bf16 v21, v14, v14, v21
  v_dot2_f32_bf16 v20, v15, s54, v20
  v_dot2_f32_bf16 v21, v15, v15, v21
  s_cmp_ge_u32 s3, 2
  s_cbranch_scc1 P0S_29
  v_dot2_f32_bf16 v20, v16, s54, v20
  v_dot2_f32_bf16 v21, v16, v16, v21
  v_dot2_f32_bf16 v20, v17, s54, v20
  v_dot2_f32_bf16 v21, v17, v17, v21
  v_dot2_f32_bf16 v20, v18, s54, v20
  v_dot2_f32_bf16 v21, v18, v18, v21
  v_dot2_f32_bf16 v20, v19, s54, v20
  v_dot2_f32_bf16 v21, v19, v19, v21
P0S_29:
  s_nop 3
  v_mov_b32 v22, v20
  v_mov_b32 v23, v21
  s_nop 0
  v_permlane16_swap_b32 v20, v22
  v_permlane16_swap_b32 v21, v23
  v_add_f32 v20, v20, v22
  v_add_f32 v21, v21, v23
  v_mov_b32 v22, v20
  v_mov_b32 v23, v21
  s_nop 0
  v_permlane32_swap_b32 v20, v22
  v_permlane32_swap_b32 v21, v23
  v_add_f32 v20, v20, v22
  v_add_f32 v21, v21, v23
  s_mul_i32 s54, s94, 20480
  s_lshl_b32 s55, s95, 10
  s_add_u32 s54, s54, s55
  s_add_u32 s54, s54, s43
  s_add_u32 s55, s54, 4096
  s_add_u32 s56, s54, 8192
  s_lshl_b32 s57, s94, 10
  s_lshl_b32 s58, s96, 7
  s_add_u32 s57, s57, s58
  s_add_u32 s57, s57, s44
  v_and_b32 v3, 15, v254
  v_lshlrev_b32 v3, 3, v3
  buffer_store_dwordx4 v[8:11], v255, s[8:11], s54 offen sc1
  buffer_store_dwordx4 v[12:15], v255, s[8:11], s55 offen sc1
  s_mov_b64 exec, 0xffff
  buffer_store_dwordx2 v[20:21], v3, s[8:11], s57 offen sc1
  s_mov_b64 exec, -1
  s_cmp_ge_u32 s3, 2
  s_cbranch_scc1 P0T_30
  buffer_store_dwordx4 v[16:19], v255, s[8:11], s56 offen sc1
P0T_30:
  s_branch L_CS1
L_CATT:
  s_cmp_lg_u32 s3, 0
  s_cbranch_scc1 AFL_118
  s_lshl_b32 s54, s4, 9
  s_lshl_b32 s55, s5, 4
  s_add_u32 s54, s54, s55
  s_add_u32 s54, s54, s52
  s_add_u32 s54, s54, 4096
  v_mov_b32 v220, s7
  v_lshlrev_b32 v221, 2, v254
  s_mov_b64 exec, 15
  s_nop 3
  s_cmp_lg_u32 s6, 0
  s_cbranch_scc1 HS_119
  buffer_store_dword v220, v221, s[8:11], s54 offen
  s_branch HE_120
HS_119:
  buffer_store_dword v220, v221, s[8:11], s54 offen sc1
HE_120:
  s_nop 1
  s_mov_b64 exec, -1
AFL_118:
  s_lshl_b32 s94, s4, 4
  s_lshr_b32 s87, s5, 3
  s_lshl_b32 s87, s87, 2
  s_add_u32 s94, s94, s87
  s_and_b32 s87, s3, 1
  s_lshl_b32 s87, s87, 1
  s_add_u32 s87, s87, s94
  s_lshr_b32 s93, s3, 1
  s_add_u32 s89, s87, 0
  s_mul_i32 s68, s89, 20480
  s_add_u32 s68, s68, s47
  s_mul_i32 s89, s93, 10240
  s_add_u32 s68, s68, s89
  s_add_u32 s89, s87, 1
  s_mul_i32 s69, s89, 20480
  s_add_u32 s69, s69, s47
  s_mul_i32 s89, s93, 10240
  s_add_u32 s69, s69, s89
  s_add_u32 s95, s87, s93
  s_and_b32 s96, s5, 7
  s_mul_i32 s90, s96, 5
  s_add_u32 s91, s90, 0
  s_lshr_b32 s92, s91, 1
  s_lshl_b32 s92, s92, 10
  s_and_b32 s91, s91, 1
  s_lshl_b32 s91, s91, 3
  s_add_u32 s63, s92, s91
  s_add_u32 s91, s90, 1
  s_lshr_b32 s92, s91, 1
  s_lshl_b32 s92, s92, 10
  s_and_b32 s91, s91, 1
  s_lshl_b32 s91, s91, 3
  s_add_u32 s64, s92, s91
  s_add_u32 s91, s90, 2
  s_lshr_b32 s92, s91, 1
  s_lshl_b32 s92, s92, 10
  s_and_b32 s91, s91, 1
  s_lshl_b32 s91, s91, 3
  s_add_u32 s65, s92, s91
  s_add_u32 s91, s90, 3
  s_lshr_b32 s92, s91, 1
  s_lshl_b32 s92, s92, 10
  s_and_b32 s91, s91, 1
  s_lshl_b32 s91, s91, 3
  s_add_u32 s66, s92, s91
  s_add_u32 s91, s90, 4
  s_lshr_b32 s92, s91, 1
  s_lshl_b32 s92, s92, 10
  s_and_b32 s91, s91, 1
  s_lshl_b32 s91, s91, 3
  s_add_u32 s67, s92, s91
  s_mul_i32 s91, s93, 5120
  v_add_u32 v246, s91, v255
  v_add_u32 v247, 65536, v246
  v_add_u32 v248, 131072, v246
  s_mul_i32 s91, s3, 5120
  s_add_u32 s91, s91, 81920
  v_add_u32 v249, s91, v255
  s_xor_b32 s92, s3, 2
  s_mul_i32 s92, s92, 5120
  s_add_u32 s92, s92, 81920
  v_add_u32 v250, s92, v255
  v_and_b32 v251, 15, v254
  v_lshlrev_b32 v251, 3, v251
  s_mul_i32 s89, s95, 20480
  s_add_u32 s89, s89, s43
  s_add_u32 s91, s63, s89
  buffer_load_dwordx2 v[100:101], v255, s[8:11], s91 offen sc1
  s_add_u32 s91, s64, s89
  buffer_load_dwordx2 v[102:103], v255, s[8:11], s91 offen sc1
  s_add_u32 s91, s65, s89
  buffer_load_dwordx2 v[104:105], v255, s[8:11], s91 offen sc1
  s_add_u32 s91, s66, s89
  buffer_load_dwordx2 v[106:107], v255, s[8:11], s91 offen sc1
  s_add_u32 s91, s67, s89
  buffer_load_dwordx2 v[108:109], v255, s[8:11], s91 offen sc1
  s_waitcnt vmcnt(0)
  v_lshlrev_b32 v224, 16, v100
  v_and_b32 v225, 0xffff0000, v100
  v_lshlrev_b32 v226, 16, v101
  v_and_b32 v227, 0xffff0000, v101
  v_lshlrev_b32 v228, 16, v102
  v_and_b32 v229, 0xffff0000, v102
  v_lshlrev_b32 v230, 16, v103
  v_and_b32 v231, 0xffff0000, v103
  v_lshlrev_b32 v232, 16, v104
  v_and_b32 v233, 0xffff0000, v104
  v_lshlrev_b32 v234, 16, v105
  v_and_b32 v235, 0xffff0000, v105
  v_lshlrev_b32 v236, 16, v106
  v_and_b32 v237, 0xffff0000, v106
  v_lshlrev_b32 v238, 16, v107
  v_and_b32 v239, 0xffff0000, v107
  v_lshlrev_b32 v240, 16, v108
  v_and_b32 v241, 0xffff0000, v108
  v_lshlrev_b32 v242, 16, v109
  v_and_b32 v243, 0xffff0000, v109
  s_cmp_lg_u32 s3, 0
  s_cbranch_scc1 NS_121
  s_lshl_b32 s62, s4, 9
  s_add_u32 s62, s62, s52
  s_add_u32 s62, s62, 4096
  v_lshlrev_b32 v221, 2, v254
  s_mov_b32 s58, 0
POLL_122:
  buffer_load_dword v220, v221, s[8:11], s62 offen sc1
  buffer_load_dword v219, v221, s[8:11], s62 offen offset:256 sc1
  s_waitcnt vmcnt(0)
  v_cmp_ne_u32 vcc, s7, v220
  v_cmp_ne_u32 s[60:61], s7, v219
  s_nop 1
  s_or_b64 vcc, vcc, s[60:61]
  s_add_u32 s58, s58, 1
  s_cmp_eq_u64 vcc, 0
  s_cbranch_scc1 POLLD_123
  s_cmp_lt_u32 s58, 0x200000
  s_cbranch_scc1 POLL_122
  v_mov_b32 v220, 12
  v_mov_b32 v221, 8
  s_mov_b32 s28, s40
  s_and_b32 s29, s41, 0xffff
  s_mov_b32 s30, 256
  s_mov_b32 s31, 0x20000
  s_mov_b64 exec, 1
  buffer_store_dword v220, v221, s[28:31], 0 offen
POLLD_123:
  s_mov_b64 exec, -1
NS_121:
  s_barrier
  s_add_u32 s58, s68, 0
  buffer_load_dwordx4 v[64:67], v255, s[8:11], s58 offen offset:0 sc1
  s_add_u32 s59, s69, 0
  buffer_load_dwordx4 v[68:71], v255, s[8:11], s59 offen offset:0 sc1
  buffer_load_dwordx4 v[72:75], v255, s[8:11], s58 offen offset:1024 sc1
  buffer_load_dwordx4 v[76:79], v255, s[8:11], s59 offen offset:1024 sc1
  buffer_load_dwordx4 v[80:83], v255, s[8:11], s58 offen offset:2048 sc1
  buffer_load_dwordx4 v[84:87], v255, s[8:11], s59 offen offset:2048 sc1
  buffer_load_dwordx4 v[88:91], v255, s[8:11], s58 offen offset:3072 sc1
  buffer_load_dwordx4 v[92:95], v255, s[8:11], s59 offen offset:3072 sc1
  s_add_u32 s58, s68, 4096
  buffer_load_dwordx4 v[96:99], v255, s[8:11], s58 offen offset:0 sc1
  s_add_u32 s59, s69, 4096
  buffer_load_dwordx4 v[100:103], v255, s[8:11], s59 offen offset:0 sc1
  buffer_load_dwordx4 v[104:107], v255, s[8:11], s58 offen offset:1024 sc1
  buffer_load_dwordx4 v[108:111], v255, s[8:11], s59 offen offset:1024 sc1
  buffer_load_dwordx4 v[112:115], v255, s[8:11], s58 offen offset:2048 sc1
  buffer_load_dwordx4 v[116:119], v255, s[8:11], s59 offen offset:2048 sc1
  buffer_load_dwordx4 v[120:123], v255, s[8:11], s58 offen offset:3072 sc1
  buffer_load_dwordx4 v[124:127], v255, s[8:11], s59 offen offset:3072 sc1
  s_add_u32 s58, s68, 8192
  buffer_load_dwordx4 v[128:131], v255, s[8:11], s58 offen offset:0 sc1
  s_add_u32 s59, s69, 8192
  buffer_load_dwordx4 v[132:135], v255, s[8:11], s59 offen offset:0 sc1
  buffer_load_dwordx4 v[136:139], v255, s[8:11], s58 offen offset:1024 sc1
  buffer_load_dwordx4 v[140:143], v255, s[8:11], s59 offen offset:1024 sc1
  ds_read_b128 v[40:43], v246 offset:0
  ds_read_b128 v[44:47], v246 offset:1024
  ds_read_b128 v[48:51], v246 offset:2048
  ds_read_b128 v[52:55], v246 offset:3072
  ds_read_b128 v[56:59], v246 offset:4096
  s_mul_i32 s89, s95, 20480
  s_add_u32 s89, s89, s45
  s_lshl_b32 s90, s95, 10
  s_lshl_b32 s91, s96, 7
  s_add_u32 s90, s90, s91
  s_add_u32 s90, s90, s46
  buffer_load_dword v216, v251, s[8:11], s90 offen
  s_waitcnt vmcnt(20) lgkmcnt(4)
  v_mfma_f32_16x16x32_bf16 v[0:3], v[40:43], v[64:67], 0
  ds_read_b128 v[60:63], v246 offset:10240
  s_waitcnt vmcnt(19)
  v_mfma_f32_16x16x32_bf16 v[4:7], v[40:43], v[68:71], 0
  s_waitcnt lgkmcnt(4)
  v_mfma_f32_16x16x32_bf16 v[8:11], v[44:47], v[64:67], 0
  ds_read_b128 v[40:43], v246 offset:11264
  v_mfma_f32_16x16x32_bf16 v[12:15], v[44:47], v[68:71], 0
  s_waitcnt lgkmcnt(4)
  v_mfma_f32_16x16x32_bf16 v[16:19], v[48:51], v[64:67], 0
  ds_read_b128 v[44:47], v246 offset:12288
  v_mfma_f32_16x16x32_bf16 v[20:23], v[48:51], v[68:71], 0
  s_waitcnt lgkmcnt(4)
  v_mfma_f32_16x16x32_bf16 v[24:27], v[52:55], v[64:67], 0
  ds_read_b128 v[48:51], v246 offset:13312
  v_mfma_f32_16x16x32_bf16 v[28:31], v[52:55], v[68:71], 0
  s_waitcnt lgkmcnt(4)
  v_mfma_f32_16x16x32_bf16 v[32:35], v[56:59], v[64:67], 0
  ds_read_b128 v[52:55], v246 offset:14336
  v_mfma_f32_16x16x32_bf16 v[36:39], v[56:59], v[68:71], 0
  s_waitcnt vmcnt(18) lgkmcnt(4)
  v_mfma_f32_16x16x32_bf16 v[0:3], v[60:63], v[72:75], v[0:3]
  ds_read_b128 v[56:59], v246 offset:20480
  s_waitcnt vmcnt(17)
  v_mfma_f32_16x16x32_bf16 v[4:7], v[60:63], v[76:79], v[4:7]
  s_waitcnt lgkmcnt(4)
  v_mfma_f32_16x16x32_bf16 v[8:11], v[40:43], v[72:75], v[8:11]
  ds_read_b128 v[60:63], v246 offset:21504
  v_mfma_f32_16x16x32_bf16 v[12:15], v[40:43], v[76:79], v[12:15]
  s_waitcnt lgkmcnt(4)
  v_mfma_f32_16x16x32_bf16 v[16:19], v[44:47], v[72:75], v[16:19]
  ds_read_b128 v[40:43], v246 offset:22528
  v_mfma_f32_16x16x32_bf16 v[20:23], v[44:47], v[76:79], v[20:23]
  s_waitcnt lgkmcnt(4)
  v_mfma_f32_16x16x32_bf16 v[24:27], v[48:51], v[72:75], v[24:27]
  ds_read_b128 v[44:47], v246 offset:23552
  v_mfma_f32_16x16x32_bf16 v[28:31], v[48:51], v[76:79], v[28:31]
  s_waitcnt lgkmcnt(4)
  v_mfma_f32_16x16x32_bf16 v[32:35], v[52:55], v[72:75], v[32:35]
  ds_read_b128 v[48:51], v246 offset:24576
  v_mfma_f32_16x16x32_bf16 v[36:39], v[52:55], v[76:79], v[36:39]
  s_waitcnt vmcnt(16) lgkmcnt(4)
  v_mfma_f32_16x16x32_bf16 v[0:3], v[56:59], v[80:83], v[0:3]
  ds_read_b128 v[52:55], v246 offset:30720
  s_waitcnt vmcnt(15)
  v_mfma_f32_16x16x32_bf16 v[4:7], v[56:59], v[84:87], v[4:7]
  s_waitcnt lgkmcnt(4)
  v_mfma_f32_16x16x32_bf16 v[8:11], v[60:63], v[80:83], v[8:11]
  ds_read_b128 v[56:59], v246 offset:31744
  v_mfma_f32_16x16x32_bf16 v[12:15], v[60:63], v[84:87], v[12:15]
  s_waitcnt lgkmcnt(4)
  v_mfma_f32_16x16x32_bf16 v[16:19], v[40:43], v[80:83], v[16:19]
  ds_read_b128 v[60:63], v246 offset:32768
  v_mfma_f32_16x16x32_bf16 v[20:23], v[40:43], v[84:87], v[20:23]
  s_waitcnt lgkmcnt(4)
  v_mfma_f32_16x16x32_bf16 v[24:27], v[44:47], v[80:83], v[24:27]
  ds_read_b128 v[40:43], v246 offset:33792
  v_mfma_f32_16x16x32_bf16 v[28:31], v[44:47], v[84:87], v[28:31]
  s_waitcnt lgkmcnt(4)
  v_mfma_f32_16x16x32_bf16 v[32:35], v[48:51], v[80:83], v[32:35]
  ds_read_b128 v[44:47], v246 offset:34816
  v_mfma_f32_16x16x32_bf16 v[36:39], v[48:51], v[84:87], v[36:39]
  s_waitcnt vmcnt(14) lgkmcnt(4)
  v_mfma_f32_16x16x32_bf16 v[0:3], v[52:55], v[88:91], v[0:3]
  ds_read_b128 v[48:51], v246 offset:40960
  s_waitcnt vmcnt(13)
  v_mfma_f32_16x16x32_bf16 v[4:7], v[52:55], v[92:95], v[4:7]
  s_waitcnt lgkmcnt(4)
  v_mfma_f32_16x16x32_bf16 v[8:11], v[56:59], v[88:91], v[8:11]
  ds_read_b128 v[52:55], v246 offset:41984
  v_mfma_f32_16x16x32_bf16 v[12:15], v[56:59], v[92:95], v[12:15]
  s_waitcnt lgkmcnt(4)
  v_mfma_f32_16x16x32_bf16 v[16:19], v[60:63], v[88:91], v[16:19]
  ds_read_b128 v[56:59], v246 offset:43008
  v_mfma_f32_16x16x32_bf16 v[20:23], v[60:63], v[92:95], v[20:23]
  s_waitcnt lgkmcnt(4)
  v_mfma_f32_16x16x32_bf16 v[24:27], v[40:43], v[88:91], v[24:27]
  ds_read_b128 v[60:63], v246 offset:44032
  v_mfma_f32_16x16x32_bf16 v[28:31], v[40:43], v[92:95], v[28:31]
  s_waitcnt lgkmcnt(4)
  v_mfma_f32_16x16x32_bf16 v[32:35], v[44:47], v[88:91], v[32:35]
  ds_read_b128 v[40:43], v246 offset:45056
  v_mfma_f32_16x16x32_bf16 v[36:39], v[44:47], v[92:95], v[36:39]
  s_waitcnt vmcnt(12) lgkmcnt(4)
  v_mfma_f32_16x16x32_bf16 v[0:3], v[48:51], v[96:99], v[0:3]
  ds_read_b128 v[44:47], v246 offset:51200
  s_waitcnt vmcnt(11)
  v_mfma_f32_16x16x32_bf16 v[4:7], v[48:51], v[100:103], v[4:7]
  s_waitcnt lgkmcnt(4)
  v_mfma_f32_16x16x32_bf16 v[8:11], v[52:55], v[96:99], v[8:11]
  ds_read_b128 v[48:51], v246 offset:52224
  v_mfma_f32_16x16x32_bf16 v[12:15], v[52:55], v[100:103], v[12:15]
  s_waitcnt lgkmcnt(4)
  v_mfma_f32_16x16x32_bf16 v[16:19], v[56:59], v[96:99], v[16:19]
  ds_read_b128 v[52:55], v246 offset:53248
  v_mfma_f32_16x16x32_bf16 v[20:23], v[56:59], v[100:103], v[20:23]
  s_waitcnt lgkmcnt(4)
  v_mfma_f32_16x16x32_bf16 v[24:27], v[60:63], v[96:99], v[24:27]
  ds_read_b128 v[56:59], v246 offset:54272
  v_mfma_f32_16x16x32_bf16 v[28:31], v[60:63], v[100:103], v[28:31]
  s_waitcnt lgkmcnt(4)
  v_mfma_f32_16x16x32_bf16 v[32:35], v[40:43], v[96:99], v[32:35]
  ds_read_b128 v[60:63], v246 offset:55296
  v_mfma_f32_16x16x32_bf16 v[36:39], v[40:43], v[100:103], v[36:39]
  s_waitcnt vmcnt(10) lgkmcnt(4)
  v_mfma_f32_16x16x32_bf16 v[0:3], v[44:47], v[104:107], v[0:3]
  s_barrier
  ds_read_b128 v[40:43], v246 offset:61440
  s_waitcnt vmcnt(9)
  v_mfma_f32_16x16x32_bf16 v[4:7], v[44:47], v[108:111], v[4:7]
  s_waitcnt lgkmcnt(4)
  v_mfma_f32_16x16x32_bf16 v[8:11], v[48:51], v[104:107], v[8:11]
  ds_read_b128 v[44:47], v246 offset:62464
  v_mfma_f32_16x16x32_bf16 v[12:15], v[48:51], v[108:111], v[12:15]
  s_waitcnt lgkmcnt(4)
  v_mfma_f32_16x16x32_bf16 v[16:19], v[52:55], v[104:107], v[16:19]
  ds_read_b128 v[48:51], v246 offset:63488
  v_mfma_f32_16x16x32_bf16 v[20:23], v[52:55], v[108:111], v[20:23]
  s_waitcnt lgkmcnt(4)
  v_mfma_f32_16x16x32_bf16 v[24:27], v[56:59], v[104:107], v[24:27]
  ds_read_b128 v[52:55], v246 offset:64512
  v_mfma_f32_16x16x32_bf16 v[28:31], v[56:59], v[108:111], v[28:31]
  s_waitcnt lgkmcnt(4)
  v_mfma_f32_16x16x32_bf16 v[32:35], v[60:63], v[104:107], v[32:35]
  ds_read_b128 v[56:59], v247 offset:0
  v_mfma_f32_16x16x32_bf16 v[36:39], v[60:63], v[108:111], v[36:39]
  s_waitcnt vmcnt(8) lgkmcnt(4)
  v_mfma_f32_16x16x32_bf16 v[0:3], v[40:43], v[112:115], v[0:3]
  ds_read_b128 v[60:63], v247 offset:6144
  s_waitcnt vmcnt(7)
  v_mfma_f32_16x16x32_bf16 v[4:7], v[40:43], v[116:119], v[4:7]
  s_waitcnt lgkmcnt(4)
  v_mfma_f32_16x16x32_bf16 v[8:11], v[44:47], v[112:115], v[8:11]
  ds_read_b128 v[40:43], v247 offset:7168
  v_mfma_f32_16x16x32_bf16 v[12:15], v[44:47], v[116:119], v[12:15]
  s_waitcnt lgkmcnt(4)
  v_mfma_f32_16x16x32_bf16 v[16:19], v[48:51], v[112:115], v[16:19]
  ds_read_b128 v[44:47], v247 offset:8192
  v_mfma_f32_16x16x32_bf16 v[20:23], v[48:51], v[116:119], v[20:23]
  s_waitcnt lgkmcnt(4)
  v_mfma_f32_16x16x32_bf16 v[24:27], v[52:55], v[112:115], v[24:27]
  ds_read_b128 v[48:51], v247 offset:9216
  v_mfma_f32_16x16x32_bf16 v[28:31], v[52:55], v[116:119], v[28:31]
  s_waitcnt lgkmcnt(4)
  v_mfma_f32_16x16x32_bf16 v[32:35], v[56:59], v[112:115], v[32:35]
  ds_read_b128 v[52:55], v247 offset:10240
  v_mfma_f32_16x16x32_bf16 v[36:39], v[56:59], v[116:119], v[36:39]
  s_waitcnt vmcnt(6) lgkmcnt(4)
  v_mfma_f32_16x16x32_bf16 v[0:3], v[60:63], v[120:123], v[0:3]
  ds_read_b128 v[56:59], v247 offset:16384
  s_waitcnt vmcnt(5)
  v_mfma_f32_16x16x32_bf16 v[4:7], v[60:63], v[124:127], v[4:7]
  s_waitcnt lgkmcnt(4)
  v_mfma_f32_16x16x32_bf16 v[8:11], v[40:43], v[120:123], v[8:11]
  ds_read_b128 v[60:63], v247 offset:17408
  v_mfma_f32_16x16x32_bf16 v[12:15], v[40:43], v[124:127], v[12:15]
  s_waitcnt lgkmcnt(4)
  v_mfma_f32_16x16x32_bf16 v[16:19], v[44:47], v[120:123], v[16:19]
  ds_read_b128 v[40:43], v247 offset:18432
  v_mfma_f32_16x16x32_bf16 v[20:23], v[44:47], v[124:127], v[20:23]
  s_waitcnt lgkmcnt(4)
  v_mfma_f32_16x16x32_bf16 v[24:27], v[48:51], v[120:123], v[24:27]
  ds_read_b128 v[44:47], v247 offset:19456
  v_mfma_f32_16x16x32_bf16 v[28:31], v[48:51], v[124:127], v[28:31]
  s_waitcnt lgkmcnt(4)
  v_mfma_f32_16x16x32_bf16 v[32:35], v[52:55], v[120:123], v[32:35]
  ds_read_b128 v[48:51], v247 offset:20480
  v_mfma_f32_16x16x32_bf16 v[36:39], v[52:55], v[124:127], v[36:39]
  s_waitcnt vmcnt(4) lgkmcnt(4)
  v_mfma_f32_16x16x32_bf16 v[0:3], v[56:59], v[128:131], v[0:3]
  ds_read_b128 v[52:55], v247 offset:26624
  s_waitcnt vmcnt(3)
  v_mfma_f32_16x16x32_bf16 v[4:7], v[56:59], v[132:135], v[4:7]
  s_waitcnt lgkmcnt(4)
  v_mfma_f32_16x16x32_bf16 v[8:11], v[60:63], v[128:131], v[8:11]
  ds_read_b128 v[56:59], v247 offset:27648
  v_mfma_f32_16x16x32_bf16 v[12:15], v[60:63], v[132:135], v[12:15]
  s_waitcnt lgkmcnt(4)
  v_mfma_f32_16x16x32_bf16 v[16:19], v[40:43], v[128:131], v[16:19]
  ds_read_b128 v[60:63], v247 offset:28672
  v_mfma_f32_16x16x32_bf16 v[20:23], v[40:43], v[132:135], v[20:23]
  s_waitcnt lgkmcnt(4)
  v_mfma_f32_16x16x32_bf16 v[24:27], v[44:47], v[128:131], v[24:27]
  ds_read_b128 v[40:43], v247 offset:29696
  v_mfma_f32_16x16x32_bf16 v[28:31], v[44:47], v[132:135], v[28:31]
  s_waitcnt lgkmcnt(4)
  v_mfma_f32_16x16x32_bf16 v[32:35], v[48:51], v[128:131], v[32:35]
  ds_read_b128 v[44:47], v247 offset:30720
  v_mfma_f32_16x16x32_bf16 v[36:39], v[48:51], v[132:135], v[36:39]
  s_waitcnt vmcnt(2) lgkmcnt(4)
  v_mfma_f32_16x16x32_bf16 v[0:3], v[52:55], v[136:139], v[0:3]
  s_waitcnt vmcnt(1)
  v_mfma_f32_16x16x32_bf16 v[4:7], v[52:55], v[140:143], v[4:7]
  s_waitcnt lgkmcnt(3)
  v_mfma_f32_16x16x32_bf16 v[8:11], v[56:59], v[136:139], v[8:11]
  v_mfma_f32_16x16x32_bf16 v[12:15], v[56:59], v[140:143], v[12:15]
  s_waitcnt lgkmcnt(2)
  v_mfma_f32_16x16x32_bf16 v[16:19], v[60:63], v[136:139], v[16:19]
  v_mfma_f32_16x16x32_bf16 v[20:23], v[60:63], v[140:143], v[20:23]
  s_waitcnt lgkmcnt(1)
  v_mfma_f32_16x16x32_bf16 v[24:27], v[40:43], v[136:139], v[24:27]
  v_mfma_f32_16x16x32_bf16 v[28:31], v[40:43], v[140:143], v[28:31]
  s_waitcnt lgkmcnt(0)
  v_mfma_f32_16x16x32_bf16 v[32:35], v[44:47], v[136:139], v[32:35]
  v_mfma_f32_16x16x32_bf16 v[36:39], v[44:47], v[140:143], v[36:39]
  s_barrier
  s_cmp_eq_u32 s93, 1
  s_cbranch_scc1 RK_124
  s_nop 5
  ds_write_b128 v249, v[4:7] offset:0
  ds_write_b128 v249, v[12:15] offset:1024
  ds_write_b128 v249, v[20:23] offset:2048
  ds_write_b128 v249, v[28:31] offset:3072
  ds_write_b128 v249, v[36:39] offset:4096
  s_branch RD_125
RK_124:
  s_nop 5
  ds_write_b128 v249, v[0:3] offset:0
  ds_write_b128 v249, v[8:11] offset:1024
  ds_write_b128 v249, v[16:19] offset:2048
  ds_write_b128 v249, v[24:27] offset:3072
  ds_write_b128 v249, v[32:35] offset:4096
  s_waitcnt lgkmcnt(0)
  v_mov_b32 v0, v4
  v_mov_b32 v1, v5
  v_mov_b32 v2, v6
  v_mov_b32 v3, v7
  v_mov_b32 v8, v12
  v_mov_b32 v9, v13
  v_mov_b32 v10, v14
  v_mov_b32 v11, v15
  v_mov_b32 v16, v20
  v_mov_b32 v17, v21
  v_mov_b32 v18, v22
  v_mov_b32 v19, v23
  v_mov_b32 v24, v28
  v_mov_b32 v25, v29
  v_mov_b32 v26, v30
  v_mov_b32 v27, v31
  v_mov_b32 v32, v36
  v_mov_b32 v33, v37
  v_mov_b32 v34, v38
  v_mov_b32 v35, v39
RD_125:
  s_waitcnt lgkmcnt(0)
  s_barrier
  ds_read_b128 v[40:43], v250 offset:0
  ds_read_b128 v[44:47], v250 offset:1024
  ds_read_b128 v[48:51], v250 offset:2048
  ds_read_b128 v[52:55], v250 offset:3072
  ds_read_b128 v[56:59], v250 offset:4096
  v_pk_add_f32 v[0:1], v[0:1], v[224:225]
  v_pk_add_f32 v[2:3], v[2:3], v[226:227]
  v_pk_add_f32 v[8:9], v[8:9], v[228:229]
  v_pk_add_f32 v[10:11], v[10:11], v[230:231]
  v_pk_add_f32 v[16:17], v[16:17], v[232:233]
  v_pk_add_f32 v[18:19], v[18:19], v[234:235]
  v_pk_add_f32 v[24:25], v[24:25], v[236:237]
  v_pk_add_f32 v[26:27], v[26:27], v[238:239]
  v_pk_add_f32 v[32:33], v[32:33], v[240:241]
  v_pk_add_f32 v[34:35], v[34:35], v[242:243]
  s_waitcnt lgkmcnt(4)
  v_pk_add_f32 v[0:1], v[0:1], v[40:41]
  v_pk_add_f32 v[2:3], v[2:3], v[42:43]
  s_waitcnt lgkmcnt(3)
  v_pk_add_f32 v[8:9], v[8:9], v[44:45]
  v_pk_add_f32 v[10:11], v[10:11], v[46:47]
  s_waitcnt lgkmcnt(2)
  v_pk_add_f32 v[16:17], v[16:17], v[48:49]
  v_pk_add_f32 v[18:19], v[18:19], v[50:51]
  s_waitcnt lgkmcnt(1)
  v_pk_add_f32 v[24:25], v[24:25], v[52:53]
  v_pk_add_f32 v[26:27], v[26:27], v[54:55]
  s_waitcnt lgkmcnt(0)
  v_pk_add_f32 v[32:33], v[32:33], v[56:57]
  v_pk_add_f32 v[34:35], v[34:35], v[58:59]
  v_cvt_pk_bf16_f32 v70, v0, v1
  v_cvt_pk_bf16_f32 v71, v2, v3
  v_cvt_pk_bf16_f32 v72, v8, v9
  v_cvt_pk_bf16_f32 v73, v10, v11
  v_cvt_pk_bf16_f32 v74, v16, v17
  v_cvt_pk_bf16_f32 v75, v18, v19
  v_cvt_pk_bf16_f32 v76, v24, v25
  v_cvt_pk_bf16_f32 v77, v26, v27
  v_cvt_pk_bf16_f32 v78, v32, v33
  v_cvt_pk_bf16_f32 v79, v34, v35
  s_mul_i32 s89, s95, 20480
  s_add_u32 s89, s89, s45
  s_lshl_b32 s90, s95, 10
  s_lshl_b32 s91, s96, 7
  s_add_u32 s90, s90, s91
  s_add_u32 s90, s90, s46
  s_bitcmp1_b32 s96, 0
  s_cbranch_scc1 XO_126
  s_nop 3
  s_cmp_lg_u32 s6, 0
  s_cbranch_scc1 HS_128
  s_add_u32 s91, s63, s89
  buffer_store_dwordx4 v[70:73], v255, s[8:11], s91 offen
  s_add_u32 s91, s65, s89
  buffer_store_dwordx4 v[74:77], v255, s[8:11], s91 offen
  s_add_u32 s91, s67, s89
  buffer_store_dwordx2 v[78:79], v255, s[8:11], s91 offen
  s_branch HE_129
HS_128:
  s_add_u32 s91, s63, s89
  buffer_store_dwordx4 v[70:73], v255, s[8:11], s91 offen sc1
  s_add_u32 s91, s65, s89
  buffer_store_dwordx4 v[74:77], v255, s[8:11], s91 offen sc1
  s_add_u32 s91, s67, s89
  buffer_store_dwordx2 v[78:79], v255, s[8:11], s91 offen sc1
HE_129:
  s_nop 1
  s_branch XE_127
XO_126:
  s_nop 3
  s_cmp_lg_u32 s6, 0
  s_cbranch_scc1 HS_130
  s_add_u32 s91, s63, s89
  buffer_store_dwordx2 v[70:71], v255, s[8:11], s91 offen
  s_add_u32 s91, s64, s89
  buffer_store_dwordx4 v[72:75], v255, s[8:11], s91 offen
  s_add_u32 s91, s66, s89
  buffer_store_dwordx4 v[76:79], v255, s[8:11], s91 offen
  s_branch HE_131
HS_130:
  s_add_u32 s91, s63, s89
  buffer_store_dwordx2 v[70:71], v255, s[8:11], s91 offen sc1
  s_add_u32 s91, s64, s89
  buffer_store_dwordx4 v[72:75], v255, s[8:11], s91 offen sc1
  s_add_u32 s91, s66, s89
  buffer_store_dwordx4 v[76:79], v255, s[8:11], s91 offen sc1
HE_131:
  s_nop 1
XE_127:
  s_mov_b32 s91, 0x3f803f80
  v_mov_b32 v80, 0
  v_mov_b32 v81, 0
  v_mov_b32 v82, 0
  v_mov_b32 v83, 0
  v_dot2_f32_bf16 v80, v70, s91, v80
  v_dot2_f32_bf16 v81, v70, v70, v81
  v_dot2_f32_bf16 v82, v71, s91, v82
  v_dot2_f32_bf16 v83, v71, v71, v83
  v_dot2_f32_bf16 v80, v72, s91, v80
  v_dot2_f32_bf16 v81, v72, v72, v81
  v_dot2_f32_bf16 v82, v73, s91, v82
  v_dot2_f32_bf16 v83, v73, v73, v83
  v_dot2_f32_bf16 v80, v74, s91, v80
  v_dot2_f32_bf16 v81, v74, v74, v81
  v_dot2_f32_bf16 v82, v75, s91, v82
  v_dot2_f32_bf16 v83, v75, v75, v83
  v_dot2_f32_bf16 v80, v76, s91, v80
  v_dot2_f32_bf16 v81, v76, v76, v81
  v_dot2_f32_bf16 v82, v77, s91, v82
  v_dot2_f32_bf16 v83, v77, v77, v83
  v_dot2_f32_bf16 v80, v78, s91, v80
  v_dot2_f32_bf16 v81, v78, v78, v81
  v_dot2_f32_bf16 v82, v79, s91, v82
  v_dot2_f32_bf16 v83, v79, v79, v83
  s_nop 2
  v_pk_add_f32 v[80:81], v[80:81], v[82:83]
  v_mov_b32 v82, v80
  v_mov_b32 v83, v81
  s_nop 0
  v_permlane16_swap_b32 v80, v82
  v_permlane16_swap_b32 v81, v83
  v_add_f32 v80, v80, v82
  v_add_f32 v81, v81, v83
  v_mov_b32 v82, v80
  v_mov_b32 v83, v81
  s_nop 0
  v_permlane32_swap_b32 v80, v82
  v_permlane32_swap_b32 v81, v83
  v_add_f32 v80, v80, v82
  v_add_f32 v81, v81, v83
  s_nop 3
  s_cmp_lg_u32 s6, 0
  s_cbranch_scc1 HS_132
  s_mov_b64 exec, 0xffff
  buffer_store_dwordx2 v[80:81], v251, s[8:11], s90 offen
  s_mov_b64 exec, -1
  s_branch HE_133
HS_132:
  s_mov_b64 exec, 0xffff
  buffer_store_dwordx2 v[80:81], v251, s[8:11], s90 offen sc1
  s_mov_b64 exec, -1
HE_133:
  s_nop 1
  s_waitcnt vmcnt(0) lgkmcnt(0)
  s_lshl_b32 s54, s4, 9
  s_lshl_b32 s55, s5, 4
  s_add_u32 s54, s54, s55
  s_add_u32 s54, s54, s52
  s_add_u32 s54, s54, 8192
  s_lshl_b32 s55, s3, 2
  s_add_u32 s54, s54, s55
  v_mov_b32 v220, s7
  v_lshlrev_b32 v221, 2, v254
  s_mov_b64 exec, 1
  s_nop 3
  s_cmp_lg_u32 s6, 0
  s_cbranch_scc1 HS_134
  buffer_store_dword v220, v221, s[8:11], s54 offen
  s_branch HE_135
HS_134:
  buffer_store_dword v220, v221, s[8:11], s54 offen sc1
HE_135:
  s_nop 1
  s_mov_b64 exec, -1
  s_lshl_b32 s94, s4, 4
  s_lshr_b32 s87, s5, 4
  s_lshl_b32 s87, s87, 3
  s_add_u32 s94, s94, s87
  s_lshl_b32 s87, s3, 1
  s_add_u32 s94, s94, s87
  s_add_u32 s89, s94, 0
  s_mul_i32 s68, s89, 20480
  s_add_u32 s68, s68, s45
  s_add_u32 s89, s94, 1
  s_mul_i32 s69, s89, 20480
  s_add_u32 s69, s69, s45
  s_and_b32 s95, s5, 15
  s_mul_i32 s95, s95, 27
  s_lshr_b32 s95, s95, 2
  s_cmp_lg_u32 s3, 0
  s_cbranch_scc1 NBT_137
  s_mov_b32 s28, s34
  s_and_b32 s29, s35, 0xffff
  s_mov_b32 s30, 3456
  s_mov_b32 s31, 0x20000
  v_lshrrev_b32 v100, 4, v254
  v_lshlrev_b32 v101, 3, v100
  s_lshl_b32 s91, s95, 5
  v_lshlrev_b32 v100, 4, v100
  v_add_u32 v100, 162496, v100
  buffer_load_dwordx2 v[106:107], v101, s[28:31], s91 offen offset:0
  buffer_load_dwordx2 v[110:111], v101, s[28:31], s91 offen offset:32
  buffer_load_dwordx2 v[114:115], v101, s[28:31], s91 offen offset:64
  buffer_load_dwordx2 v[118:119], v101, s[28:31], s91 offen offset:96
  buffer_load_dwordx2 v[122:123], v101, s[28:31], s91 offen offset:128
  buffer_load_dwordx2 v[126:127], v101, s[28:31], s91 offen offset:160
  buffer_load_dwordx2 v[130:131], v101, s[28:31], s91 offen offset:192
  s_waitcnt vmcnt(0)
  v_lshlrev_b32 v104, 16, v106
  v_and_b32 v105, 0xffff0000, v106
  v_lshlrev_b32 v106, 16, v107
  v_and_b32 v107, 0xffff0000, v107
  v_lshlrev_b32 v108, 16, v110
  v_and_b32 v109, 0xffff0000, v110
  v_lshlrev_b32 v110, 16, v111
  v_and_b32 v111, 0xffff0000, v111
  v_lshlrev_b32 v112, 16, v114
  v_and_b32 v113, 0xffff0000, v114
  v_lshlrev_b32 v114, 16, v115
  v_and_b32 v115, 0xffff0000, v115
  v_lshlrev_b32 v116, 16, v118
  v_and_b32 v117, 0xffff0000, v118
  v_lshlrev_b32 v118, 16, v119
  v_and_b32 v119, 0xffff0000, v119
  v_lshlrev_b32 v120, 16, v122
  v_and_b32 v121, 0xffff0000, v122
  v_lshlrev_b32 v122, 16, v123
  v_and_b32 v123, 0xffff0000, v123
  v_lshlrev_b32 v124, 16, v126
  v_and_b32 v125, 0xffff0000, v126
  v_lshlrev_b32 v126, 16, v127
  v_and_b32 v127, 0xffff0000, v127
  v_lshlrev_b32 v128, 16, v130
  v_and_b32 v129, 0xffff0000, v130
  v_lshlrev_b32 v130, 16, v131
  v_and_b32 v131, 0xffff0000, v131
  ds_write_b128 v100, v[104:107] offset:0
  ds_write_b128 v100, v[108:111] offset:64
  ds_write_b128 v100, v[112:115] offset:128
  ds_write_b128 v100, v[116:119] offset:192
  ds_write_b128 v100, v[120:123] offset:256
  ds_write_b128 v100, v[124:127] offset:320
  ds_write_b128 v100, v[128:131] offset:384
  s_waitcnt lgkmcnt(0)
NBT_137:
  v_lshrrev_b32 v243, 4, v254
  v_lshlrev_b32 v243, 8, v243
  v_and_b32 v220, 15, v254
  v_lshlrev_b32 v220, 3, v220
  v_add_u32 v243, v243, v220
  v_mov_b32 v240, v255
  v_add_u32 v241, 65536, v255
  v_add_u32 v242, 131072, v255
  s_add_u32 s91, s95, 0
  s_lshr_b32 s92, s91, 1
  s_lshl_b32 s92, s92, 10
  s_and_b32 s91, s91, 1
  s_lshl_b32 s91, s91, 3
  s_add_u32 s63, s91, s92
  s_add_u32 s91, s95, 1
  s_lshr_b32 s92, s91, 1
  s_lshl_b32 s92, s92, 10
  s_and_b32 s91, s91, 1
  s_lshl_b32 s91, s91, 3
  s_add_u32 s64, s91, s92
  s_add_u32 s91, s95, 2
  s_lshr_b32 s92, s91, 1
  s_lshl_b32 s92, s92, 10
  s_and_b32 s91, s91, 1
  s_lshl_b32 s91, s91, 3
  s_add_u32 s65, s91, s92
  s_add_u32 s91, s95, 3
  s_lshr_b32 s92, s91, 1
  s_lshl_b32 s92, s92, 10
  s_and_b32 s91, s91, 1
  s_lshl_b32 s91, s91, 3
  s_add_u32 s66, s91, s92
  s_add_u32 s91, s95, 4
  s_lshr_b32 s92, s91, 1
  s_lshl_b32 s92, s92, 10
  s_and_b32 s91, s91, 1
  s_lshl_b32 s91, s91, 3
  s_add_u32 s67, s91, s92
  s_add_u32 s91, s95, 5
  s_lshr_b32 s92, s91, 1
  s_lshl_b32 s92, s92, 10
  s_and_b32 s91, s91, 1
  s_lshl_b32 s91, s91, 3
  s_add_u32 s56, s91, s92
  s_add_u32 s91, s95, 6
  s_lshr_b32 s92, s91, 1
  s_lshl_b32 s92, s92, 10
  s_and_b32 s91, s91, 1
  s_lshl_b32 s91, s91, 3
  s_add_u32 s57, s91, s92
  s_cmp_lg_u32 s3, 0
  s_cbranch_scc1 NS_138
  s_lshl_b32 s62, s4, 9
  s_add_u32 s62, s62, s52
  s_add_u32 s62, s62, 8192
  s_lshr_b32 s88, s5, 4
  s_lshl_b32 s88, s88, 8
  s_add_u32 s62, s62, s88
  v_lshlrev_b32 v221, 2, v254
  s_mov_b32 s58, 0
POLL_139:
  buffer_load_dword v220, v221, s[8:11], s62 offen sc1
  s_waitcnt vmcnt(0)
  v_cmp_ne_u32 vcc, s7, v220
  s_add_u32 s58, s58, 1
  s_cbranch_vccz POLLD_140
  s_cmp_lt_u32 s58, 0x200000
  s_cbranch_scc1 POLL_139
  v_mov_b32 v220, 13
  v_mov_b32 v221, 8
  s_mov_b32 s28, s40
  s_and_b32 s29, s41, 0xffff
  s_mov_b32 s30, 256
  s_mov_b32 s31, 0x20000
  s_mov_b64 exec, 1
  buffer_store_dword v220, v221, s[28:31], 0 offen
POLLD_140:
  s_mov_b64 exec, -1
NS_138:
  s_barrier
  s_add_u32 s89, s94, 0
  s_lshl_b32 s85, s89, 10
  s_add_u32 s85, s85, s46
  buffer_load_dwordx2 v[244:245], v243, s[8:11], s85 offen sc1
  buffer_load_dwordx2 v[246:247], v243, s[8:11], s85 offen offset:128 sc1
  s_add_u32 s89, s94, 1
  s_lshl_b32 s85, s89, 10
  s_add_u32 s85, s85, s46
  buffer_load_dwordx2 v[248:249], v243, s[8:11], s85 offen sc1
  buffer_load_dwordx2 v[250:251], v243, s[8:11], s85 offen offset:128 sc1
  s_add_u32 s58, s68, 0
  buffer_load_dwordx4 v[80:83], v255, s[8:11], s58 offen offset:0 sc1
  s_add_u32 s59, s69, 0
  buffer_load_dwordx4 v[84:87], v255, s[8:11], s59 offen offset:0 sc1
  buffer_load_dwordx4 v[88:91], v255, s[8:11], s58 offen offset:1024 sc1
  buffer_load_dwordx4 v[92:95], v255, s[8:11], s59 offen offset:1024 sc1
  buffer_load_dwordx4 v[96:99], v255, s[8:11], s58 offen offset:2048 sc1
  buffer_load_dwordx4 v[100:103], v255, s[8:11], s59 offen offset:2048 sc1
  buffer_load_dwordx4 v[104:107], v255, s[8:11], s58 offen offset:3072 sc1
  buffer_load_dwordx4 v[108:111], v255, s[8:11], s59 offen offset:3072 sc1
  s_add_u32 s58, s68, 4096
  buffer_load_dwordx4 v[112:115], v255, s[8:11], s58 offen offset:0 sc1
  s_add_u32 s59, s69, 4096
  buffer_load_dwordx4 v[116:119], v255, s[8:11], s59 offen offset:0 sc1
  ds_read_b128 v[56:59], v241 offset:36864
  ds_read_b128 v[60:63], v241 offset:37888
  ds_read_b128 v[64:67], v241 offset:38912
  ds_read_b128 v[68:71], v241 offset:39936
  ds_read_b128 v[72:75], v241 offset:40960
  s_waitcnt vmcnt(9) lgkmcnt(4)
  v_mfma_f32_16x16x32_bf16 v[0:3], v[56:59], v[80:83], 0
  ds_read_b128 v[76:79], v241 offset:41984
  buffer_load_dwordx4 v[120:123], v255, s[8:11], s58 offen offset:1024 sc1
  s_waitcnt vmcnt(9)
  v_mfma_f32_16x16x32_bf16 v[4:7], v[56:59], v[84:87], 0
  s_waitcnt lgkmcnt(4)
  v_mfma_f32_16x16x32_bf16 v[8:11], v[60:63], v[80:83], 0
  ds_read_b128 v[56:59], v241 offset:43008
  v_mfma_f32_16x16x32_bf16 v[12:15], v[60:63], v[84:87], 0
  s_waitcnt lgkmcnt(4)
  v_mfma_f32_16x16x32_bf16 v[16:19], v[64:67], v[80:83], 0
  ds_read_b128 v[60:63], v241 offset:44032
  v_mfma_f32_16x16x32_bf16 v[20:23], v[64:67], v[84:87], 0
  s_waitcnt lgkmcnt(4)
  v_mfma_f32_16x16x32_bf16 v[24:27], v[68:71], v[80:83], 0
  ds_read_b128 v[64:67], v241 offset:45056
  v_mfma_f32_16x16x32_bf16 v[28:31], v[68:71], v[84:87], 0
  buffer_load_dwordx4 v[124:127], v255, s[8:11], s59 offen offset:1024 sc1
  s_waitcnt lgkmcnt(4)
  v_mfma_f32_16x16x32_bf16 v[32:35], v[72:75], v[80:83], 0
  ds_read_b128 v[68:71], v241 offset:46080
  v_mfma_f32_16x16x32_bf16 v[36:39], v[72:75], v[84:87], 0
  s_waitcnt lgkmcnt(4)
  v_mfma_f32_16x16x32_bf16 v[40:43], v[76:79], v[80:83], 0
  ds_read_b128 v[72:75], v241 offset:47104
  v_mfma_f32_16x16x32_bf16 v[44:47], v[76:79], v[84:87], 0
  s_waitcnt lgkmcnt(4)
  v_mfma_f32_16x16x32_bf16 v[48:51], v[56:59], v[80:83], 0
  ds_read_b128 v[76:79], v241 offset:48128
  v_mfma_f32_16x16x32_bf16 v[52:55], v[56:59], v[84:87], 0
  s_waitcnt vmcnt(9) lgkmcnt(4)
  v_mfma_f32_16x16x32_bf16 v[0:3], v[60:63], v[88:91], v[0:3]
  ds_read_b128 v[56:59], v241 offset:49152
  buffer_load_dwordx4 v[128:131], v255, s[8:11], s58 offen offset:2048 sc1
  s_waitcnt vmcnt(9)
  v_mfma_f32_16x16x32_bf16 v[4:7], v[60:63], v[92:95], v[4:7]
  s_waitcnt lgkmcnt(4)
  v_mfma_f32_16x16x32_bf16 v[8:11], v[64:67], v[88:91], v[8:11]
  ds_read_b128 v[60:63], v241 offset:50176
  v_mfma_f32_16x16x32_bf16 v[12:15], v[64:67], v[92:95], v[12:15]
  s_waitcnt lgkmcnt(4)
  v_mfma_f32_16x16x32_bf16 v[16:19], v[68:71], v[88:91], v[16:19]
  ds_read_b128 v[64:67], v241 offset:51200
  v_mfma_f32_16x16x32_bf16 v[20:23], v[68:71], v[92:95], v[20:23]
  s_waitcnt lgkmcnt(4)
  v_mfma_f32_16x16x32_bf16 v[24:27], v[72:75], v[88:91], v[24:27]
  ds_read_b128 v[68:71], v241 offset:52224
  v_mfma_f32_16x16x32_bf16 v[28:31], v[72:75], v[92:95], v[28:31]
  buffer_load_dwordx4 v[132:135], v255, s[8:11], s59 offen offset:2048 sc1
  s_waitcnt lgkmcnt(4)
  v_mfma_f32_16x16x32_bf16 v[32:35], v[76:79], v[88:91], v[32:35]
  ds_read_b128 v[72:75], v241 offset:53248
  v_mfma_f32_16x16x32_bf16 v[36:39], v[76:79], v[92:95], v[36:39]
  s_waitcnt lgkmcnt(4)
  v_mfma_f32_16x16x32_bf16 v[40:43], v[56:59], v[88:91], v[40:43]
  ds_read_b128 v[76:79], v241 offset:54272
  v_mfma_f32_16x16x32_bf16 v[44:47], v[56:59], v[92:95], v[44:47]
  s_waitcnt lgkmcnt(4)
  v_mfma_f32_16x16x32_bf16 v[48:51], v[60:63], v[88:91], v[48:51]
  ds_read_b128 v[56:59], v241 offset:55296
  v_mfma_f32_16x16x32_bf16 v[52:55], v[60:63], v[92:95], v[52:55]
  s_waitcnt vmcnt(9) lgkmcnt(4)
  v_mfma_f32_16x16x32_bf16 v[0:3], v[64:67], v[96:99], v[0:3]
  ds_read_b128 v[60:63], v241 offset:56320
  buffer_load_dwordx4 v[136:139], v255, s[8:11], s58 offen offset:3072 sc1
  s_waitcnt vmcnt(9)
  v_mfma_f32_16x16x32_bf16 v[4:7], v[64:67], v[100:103], v[4:7]
  s_waitcnt lgkmcnt(4)
  v_mfma_f32_16x16x32_bf16 v[8:11], v[68:71], v[96:99], v[8:11]
  ds_read_b128 v[64:67], v241 offset:57344
  v_mfma_f32_16x16x32_bf16 v[12:15], v[68:71], v[100:103], v[12:15]
  s_waitcnt lgkmcnt(4)
  v_mfma_f32_16x16x32_bf16 v[16:19], v[72:75], v[96:99], v[16:19]
  ds_read_b128 v[68:71], v241 offset:58368
  v_mfma_f32_16x16x32_bf16 v[20:23], v[72:75], v[100:103], v[20:23]
  s_waitcnt lgkmcnt(4)
  v_mfma_f32_16x16x32_bf16 v[24:27], v[76:79], v[96:99], v[24:27]
  ds_read_b128 v[72:75], v241 offset:59392
  v_mfma_f32_16x16x32_bf16 v[28:31], v[76:79], v[100:103], v[28:31]
  buffer_load_dwordx4 v[140:143], v255, s[8:11], s59 offen offset:3072 sc1
  s_waitcnt lgkmcnt(4)
  v_mfma_f32_16x16x32_bf16 v[32:35], v[56:59], v[96:99], v[32:35]
  ds_read_b128 v[76:79], v241 offset:60416
  v_mfma_f32_16x16x32_bf16 v[36:39], v[56:59], v[100:103], v[36:39]
  s_waitcnt lgkmcnt(4)
  v_mfma_f32_16x16x32_bf16 v[40:43], v[60:63], v[96:99], v[40:43]
  ds_read_b128 v[56:59], v241 offset:61440
  v_mfma_f32_16x16x32_bf16 v[44:47], v[60:63], v[100:103], v[44:47]
  s_waitcnt lgkmcnt(4)
  v_mfma_f32_16x16x32_bf16 v[48:51], v[64:67], v[96:99], v[48:51]
  ds_read_b128 v[60:63], v241 offset:62464
  v_mfma_f32_16x16x32_bf16 v[52:55], v[64:67], v[100:103], v[52:55]
  s_waitcnt vmcnt(9) lgkmcnt(4)
  v_mfma_f32_16x16x32_bf16 v[0:3], v[68:71], v[104:107], v[0:3]
  ds_read_b128 v[64:67], v241 offset:63488
  s_add_u32 s58, s68, 8192
  buffer_load_dwordx4 v[144:147], v255, s[8:11], s58 offen offset:0 sc1
  s_waitcnt vmcnt(9)
  v_mfma_f32_16x16x32_bf16 v[4:7], v[68:71], v[108:111], v[4:7]
  s_waitcnt lgkmcnt(4)
  v_mfma_f32_16x16x32_bf16 v[8:11], v[72:75], v[104:107], v[8:11]
  ds_read_b128 v[68:71], v241 offset:64512
  v_mfma_f32_16x16x32_bf16 v[12:15], v[72:75], v[108:111], v[12:15]
  s_waitcnt lgkmcnt(4)
  v_mfma_f32_16x16x32_bf16 v[16:19], v[76:79], v[104:107], v[16:19]
  ds_read_b128 v[72:75], v242 offset:0
  v_mfma_f32_16x16x32_bf16 v[20:23], v[76:79], v[108:111], v[20:23]
  s_waitcnt lgkmcnt(4)
  v_mfma_f32_16x16x32_bf16 v[24:27], v[56:59], v[104:107], v[24:27]
  ds_read_b128 v[76:79], v242 offset:1024
  v_mfma_f32_16x16x32_bf16 v[28:31], v[56:59], v[108:111], v[28:31]
  s_add_u32 s59, s69, 8192
  buffer_load_dwordx4 v[148:151], v255, s[8:11], s59 offen offset:0 sc1
  s_waitcnt lgkmcnt(4)
  v_mfma_f32_16x16x32_bf16 v[32:35], v[60:63], v[104:107], v[32:35]
  ds_read_b128 v[56:59], v242 offset:2048
  v_mfma_f32_16x16x32_bf16 v[36:39], v[60:63], v[108:111], v[36:39]
  s_waitcnt lgkmcnt(4)
  v_mfma_f32_16x16x32_bf16 v[40:43], v[64:67], v[104:107], v[40:43]
  ds_read_b128 v[60:63], v242 offset:3072
  v_mfma_f32_16x16x32_bf16 v[44:47], v[64:67], v[108:111], v[44:47]
  s_waitcnt lgkmcnt(4)
  v_mfma_f32_16x16x32_bf16 v[48:51], v[68:71], v[104:107], v[48:51]
  ds_read_b128 v[64:67], v242 offset:4096
  v_mfma_f32_16x16x32_bf16 v[52:55], v[68:71], v[108:111], v[52:55]
  s_waitcnt vmcnt(9) lgkmcnt(4)
  v_mfma_f32_16x16x32_bf16 v[0:3], v[72:75], v[112:115], v[0:3]
  ds_read_b128 v[68:71], v242 offset:5120
  buffer_load_dwordx4 v[152:155], v255, s[8:11], s58 offen offset:1024 sc1
  s_waitcnt vmcnt(9)
  v_mfma_f32_16x16x32_bf16 v[4:7], v[72:75], v[116:119], v[4:7]
  v_pk_add_f32 v[244:245], v[244:245], v[246:247]
  s_waitcnt lgkmcnt(4)
  v_mfma_f32_16x16x32_bf16 v[8:11], v[76:79], v[112:115], v[8:11]
  ds_read_b128 v[72:75], v242 offset:6144
  v_mfma_f32_16x16x32_bf16 v[12:15], v[76:79], v[116:119], v[12:15]
  v_pk_add_f32 v[248:249], v[248:249], v[250:251]
  s_waitcnt lgkmcnt(4)
  v_mfma_f32_16x16x32_bf16 v[16:19], v[56:59], v[112:115], v[16:19]
  ds_read_b128 v[76:79], v242 offset:7168
  v_mfma_f32_16x16x32_bf16 v[20:23], v[56:59], v[116:119], v[20:23]
  v_mov_b32 v246, v244
  s_waitcnt lgkmcnt(4)
  v_mfma_f32_16x16x32_bf16 v[24:27], v[60:63], v[112:115], v[24:27]
  ds_read_b128 v[56:59], v242 offset:8192
  v_mfma_f32_16x16x32_bf16 v[28:31], v[60:63], v[116:119], v[28:31]
  buffer_load_dwordx4 v[156:159], v255, s[8:11], s59 offen offset:1024 sc1
  v_mov_b32 v247, v245
  s_waitcnt lgkmcnt(4)
  v_mfma_f32_16x16x32_bf16 v[32:35], v[64:67], v[112:115], v[32:35]
  ds_read_b128 v[60:63], v242 offset:9216
  v_mov_b32 v250, v248
  v_mfma_f32_16x16x32_bf16 v[36:39], v[64:67], v[116:119], v[36:39]
  s_waitcnt lgkmcnt(4)
  v_mfma_f32_16x16x32_bf16 v[40:43], v[68:71], v[112:115], v[40:43]
  ds_read_b128 v[64:67], v242 offset:10240
  v_mov_b32 v251, v249
  v_mfma_f32_16x16x32_bf16 v[44:47], v[68:71], v[116:119], v[44:47]
  s_waitcnt lgkmcnt(4)
  v_mfma_f32_16x16x32_bf16 v[48:51], v[72:75], v[112:115], v[48:51]
  ds_read_b128 v[68:71], v242 offset:11264
  v_permlane16_swap_b32 v244, v246
  v_mfma_f32_16x16x32_bf16 v[52:55], v[72:75], v[116:119], v[52:55]
  s_waitcnt vmcnt(9) lgkmcnt(4)
  v_mfma_f32_16x16x32_bf16 v[0:3], v[76:79], v[120:123], v[0:3]
  ds_read_b128 v[72:75], v242 offset:12288
  buffer_load_dwordx4 v[160:163], v255, s[8:11], s58 offen offset:2048 sc1
  v_permlane16_swap_b32 v245, v247
  s_waitcnt vmcnt(9)
  v_mfma_f32_16x16x32_bf16 v[4:7], v[76:79], v[124:127], v[4:7]
  v_permlane16_swap_b32 v248, v250
  s_waitcnt lgkmcnt(4)
  v_mfma_f32_16x16x32_bf16 v[8:11], v[56:59], v[120:123], v[8:11]
  ds_read_b128 v[76:79], v242 offset:13312
  v_mfma_f32_16x16x32_bf16 v[12:15], v[56:59], v[124:127], v[12:15]
  v_permlane16_swap_b32 v249, v251
  s_waitcnt lgkmcnt(4)
  v_mfma_f32_16x16x32_bf16 v[16:19], v[60:63], v[120:123], v[16:19]
  ds_read_b128 v[56:59], v242 offset:14336
  v_add_f32 v244, v244, v246
  v_mfma_f32_16x16x32_bf16 v[20:23], v[60:63], v[124:127], v[20:23]
  s_waitcnt lgkmcnt(4)
  v_mfma_f32_16x16x32_bf16 v[24:27], v[64:67], v[120:123], v[24:27]
  ds_read_b128 v[60:63], v242 offset:15360
  v_add_f32 v245, v245, v247
  v_mfma_f32_16x16x32_bf16 v[28:31], v[64:67], v[124:127], v[28:31]
  buffer_load_dwordx4 v[164:167], v255, s[8:11], s59 offen offset:2048 sc1
  v_add_f32 v248, v248, v250
  s_waitcnt lgkmcnt(4)
  v_mfma_f32_16x16x32_bf16 v[32:35], v[68:71], v[120:123], v[32:35]
  ds_read_b128 v[64:67], v242 offset:16384
  v_mfma_f32_16x16x32_bf16 v[36:39], v[68:71], v[124:127], v[36:39]
  v_add_f32 v249, v249, v251
  s_waitcnt lgkmcnt(4)
  v_mfma_f32_16x16x32_bf16 v[40:43], v[72:75], v[120:123], v[40:43]
  ds_read_b128 v[68:71], v242 offset:17408
  v_mov_b32 v246, v244
  v_mfma_f32_16x16x32_bf16 v[44:47], v[72:75], v[124:127], v[44:47]
  s_waitcnt lgkmcnt(4)
  v_mfma_f32_16x16x32_bf16 v[48:51], v[76:79], v[120:123], v[48:51]
  ds_read_b128 v[72:75], v242 offset:18432
  v_mov_b32 v247, v245
  v_mfma_f32_16x16x32_bf16 v[52:55], v[76:79], v[124:127], v[52:55]
  s_waitcnt vmcnt(9) lgkmcnt(4)
  v_mfma_f32_16x16x32_bf16 v[0:3], v[56:59], v[128:131], v[0:3]
  ds_read_b128 v[76:79], v242 offset:19456
  buffer_load_dwordx4 v[168:171], v255, s[8:11], s58 offen offset:3072 sc1
  v_mov_b32 v250, v248
  s_waitcnt vmcnt(9)
  v_mfma_f32_16x16x32_bf16 v[4:7], v[56:59], v[132:135], v[4:7]
  v_mov_b32 v251, v249
  s_waitcnt lgkmcnt(4)
  v_mfma_f32_16x16x32_bf16 v[8:11], v[60:63], v[128:131], v[8:11]
  ds_read_b128 v[56:59], v242 offset:20480
  v_mfma_f32_16x16x32_bf16 v[12:15], v[60:63], v[132:135], v[12:15]
  v_permlane32_swap_b32 v244, v246
  s_waitcnt lgkmcnt(4)
  v_mfma_f32_16x16x32_bf16 v[16:19], v[64:67], v[128:131], v[16:19]
  ds_read_b128 v[60:63], v242 offset:21504
  v_mfma_f32_16x16x32_bf16 v[20:23], v[64:67], v[132:135], v[20:23]
  v_permlane32_swap_b32 v245, v247
  s_waitcnt lgkmcnt(4)
  v_mfma_f32_16x16x32_bf16 v[24:27], v[68:71], v[128:131], v[24:27]
  ds_read_b128 v[64:67], v242 offset:22528
  v_mfma_f32_16x16x32_bf16 v[28:31], v[68:71], v[132:135], v[28:31]
  buffer_load_dwordx4 v[172:175], v255, s[8:11], s59 offen offset:3072 sc1
  v_permlane32_swap_b32 v248, v250
  s_waitcnt lgkmcnt(4)
  v_mfma_f32_16x16x32_bf16 v[32:35], v[72:75], v[128:131], v[32:35]
  ds_read_b128 v[68:71], v242 offset:23552
  v_permlane32_swap_b32 v249, v251
  v_mfma_f32_16x16x32_bf16 v[36:39], v[72:75], v[132:135], v[36:39]
  s_waitcnt lgkmcnt(4)
  v_mfma_f32_16x16x32_bf16 v[40:43], v[76:79], v[128:131], v[40:43]
  ds_read_b128 v[72:75], v242 offset:24576
  v_add_f32 v244, v244, v246
  v_mfma_f32_16x16x32_bf16 v[44:47], v[76:79], v[132:135], v[44:47]
  s_waitcnt lgkmcnt(4)
  v_mfma_f32_16x16x32_bf16 v[48:51], v[56:59], v[128:131], v[48:51]
  ds_read_b128 v[76:79], v242 offset:25600
  v_add_f32 v245, v245, v247
  v_mfma_f32_16x16x32_bf16 v[52:55], v[56:59], v[132:135], v[52:55]
  s_waitcnt vmcnt(9) lgkmcnt(4)
  v_mfma_f32_16x16x32_bf16 v[0:3], v[60:63], v[136:139], v[0:3]
  ds_read_b128 v[56:59], v242 offset:26624
  s_add_u32 s58, s68, 12288
  buffer_load_dwordx4 v[176:179], v255, s[8:11], s58 offen offset:0 sc1
  v_add_f32 v248, v248, v250
  s_waitcnt vmcnt(9)
  v_mfma_f32_16x16x32_bf16 v[4:7], v[60:63], v[140:143], v[4:7]
  v_add_f32 v249, v249, v251
  s_waitcnt lgkmcnt(4)
  v_mfma_f32_16x16x32_bf16 v[8:11], v[64:67], v[136:139], v[8:11]
  ds_read_b128 v[60:63], v242 offset:27648
  v_mfma_f32_16x16x32_bf16 v[12:15], v[64:67], v[140:143], v[12:15]
  v_mul_f32 v80, 0x3acccccd, v244
  s_waitcnt lgkmcnt(4)
  v_mfma_f32_16x16x32_bf16 v[16:19], v[68:71], v[136:139], v[16:19]
  ds_read_b128 v[64:67], v240 offset:0
  v_mul_f32 v92, 0x3acccccd, v248
  v_mfma_f32_16x16x32_bf16 v[20:23], v[68:71], v[140:143], v[20:23]
  s_waitcnt lgkmcnt(4)
  v_mfma_f32_16x16x32_bf16 v[24:27], v[72:75], v[136:139], v[24:27]
  ds_read_b128 v[68:71], v240 offset:1024
  v_mul_f32 v245, 0x3acccccd, v245
  v_mfma_f32_16x16x32_bf16 v[28:31], v[72:75], v[140:143], v[28:31]
  s_add_u32 s59, s69, 12288
  buffer_load_dwordx4 v[180:183], v255, s[8:11], s59 offen offset:0 sc1
  v_mul_f32 v249, 0x3acccccd, v249
  s_waitcnt lgkmcnt(4)
  v_mfma_f32_16x16x32_bf16 v[32:35], v[76:79], v[136:139], v[32:35]
  ds_read_b128 v[72:75], v240 offset:2048
  v_mfma_f32_16x16x32_bf16 v[36:39], v[76:79], v[140:143], v[36:39]
  v_fma_f32 v245, -v80, v80, v245
  s_waitcnt lgkmcnt(4)
  v_mfma_f32_16x16x32_bf16 v[40:43], v[56:59], v[136:139], v[40:43]
  ds_read_b128 v[76:79], v240 offset:3072
  v_fma_f32 v249, -v92, v92, v249
  v_mfma_f32_16x16x32_bf16 v[44:47], v[56:59], v[140:143], v[44:47]
  s_waitcnt lgkmcnt(4)
  v_mfma_f32_16x16x32_bf16 v[48:51], v[60:63], v[136:139], v[48:51]
  ds_read_b128 v[56:59], v240 offset:4096
  v_max_f32 v245, 0, v245
  v_mfma_f32_16x16x32_bf16 v[52:55], v[60:63], v[140:143], v[52:55]
  s_waitcnt vmcnt(9) lgkmcnt(4)
  v_mfma_f32_16x16x32_bf16 v[0:3], v[64:67], v[144:147], v[0:3]
  ds_read_b128 v[60:63], v240 offset:5120
  buffer_load_dwordx4 v[184:187], v255, s[8:11], s58 offen offset:1024 sc1
  v_max_f32 v249, 0, v249
  s_waitcnt vmcnt(9)
  v_mfma_f32_16x16x32_bf16 v[4:7], v[64:67], v[148:151], v[4:7]
  v_add_f32 v246, 0x3727c5ac, v245
  s_waitcnt lgkmcnt(4)
  v_mfma_f32_16x16x32_bf16 v[8:11], v[68:71], v[144:147], v[8:11]
  ds_read_b128 v[64:67], v240 offset:6144
  v_mfma_f32_16x16x32_bf16 v[12:15], v[68:71], v[148:151], v[12:15]
  v_add_f32 v247, 0x3727c5ac, v249
  s_waitcnt lgkmcnt(4)
  v_mfma_f32_16x16x32_bf16 v[16:19], v[72:75], v[144:147], v[16:19]
  s_barrier
  ds_read_b128 v[68:71], v240 offset:7168
  v_mfma_f32_16x16x32_bf16 v[20:23], v[72:75], v[148:151], v[20:23]
  v_rsq_f32 v88, v246
  s_waitcnt lgkmcnt(4)
  v_mfma_f32_16x16x32_bf16 v[24:27], v[76:79], v[144:147], v[24:27]
  ds_read_b128 v[72:75], v240 offset:8192
  v_mfma_f32_16x16x32_bf16 v[28:31], v[76:79], v[148:151], v[28:31]
  buffer_load_dwordx4 v[188:191], v255, s[8:11], s59 offen offset:1024 sc1
  v_rsq_f32 v100, v247
  s_waitcnt lgkmcnt(4)
  v_mfma_f32_16x16x32_bf16 v[32:35], v[56:59], v[144:147], v[32:35]
  ds_read_b128 v[76:79], v240 offset:9216
  v_mul_f32 v246, v88, v88
  v_mfma_f32_16x16x32_bf16 v[36:39], v[56:59], v[148:151], v[36:39]
  s_waitcnt lgkmcnt(4)
  v_mfma_f32_16x16x32_bf16 v[40:43], v[60:63], v[144:147], v[40:43]
  ds_read_b128 v[56:59], v240 offset:10240
  v_mul_f32 v250, v100, v100
  v_mfma_f32_16x16x32_bf16 v[44:47], v[60:63], v[148:151], v[44:47]
  s_waitcnt lgkmcnt(4)
  v_mfma_f32_16x16x32_bf16 v[48:51], v[64:67], v[144:147], v[48:51]
  ds_read_b128 v[60:63], v240 offset:11264
  v_mul_f32 v246, v246, v245
  v_mfma_f32_16x16x32_bf16 v[52:55], v[64:67], v[148:151], v[52:55]
  s_waitcnt vmcnt(9) lgkmcnt(4)
  v_mfma_f32_16x16x32_bf16 v[0:3], v[68:71], v[152:155], v[0:3]
  ds_read_b128 v[64:67], v240 offset:12288
  buffer_load_dwordx4 v[192:195], v255, s[8:11], s58 offen offset:2048 sc1
  v_mul_f32 v250, v250, v249
  s_waitcnt vmcnt(9)
  v_mfma_f32_16x16x32_bf16 v[4:7], v[68:71], v[156:159], v[4:7]
  v_add_f32 v246, 0x3727c5ac, v246
  s_waitcnt lgkmcnt(4)
  v_mfma_f32_16x16x32_bf16 v[8:11], v[72:75], v[152:155], v[8:11]
  ds_read_b128 v[68:71], v240 offset:13312
  v_mfma_f32_16x16x32_bf16 v[12:15], v[72:75], v[156:159], v[12:15]
  v_add_f32 v250, 0x3727c5ac, v250
  s_waitcnt lgkmcnt(4)
  v_mfma_f32_16x16x32_bf16 v[16:19], v[76:79], v[152:155], v[16:19]
  ds_read_b128 v[72:75], v240 offset:14336
  v_rsq_f32 v246, v246
  v_mfma_f32_16x16x32_bf16 v[20:23], v[76:79], v[156:159], v[20:23]
  s_waitcnt lgkmcnt(4)
  v_mfma_f32_16x16x32_bf16 v[24:27], v[56:59], v[152:155], v[24:27]
  ds_read_b128 v[76:79], v240 offset:15360
  v_rsq_f32 v250, v250
  v_mfma_f32_16x16x32_bf16 v[28:31], v[56:59], v[156:159], v[28:31]
  buffer_load_dwordx4 v[196:199], v255, s[8:11], s59 offen offset:2048 sc1
  s_nop 0
  s_waitcnt lgkmcnt(4)
  v_mfma_f32_16x16x32_bf16 v[32:35], v[60:63], v[152:155], v[32:35]
  ds_read_b128 v[56:59], v240 offset:16384
  v_mfma_f32_16x16x32_bf16 v[36:39], v[60:63], v[156:159], v[36:39]
  v_mul_f32 v88, v88, v246
  s_waitcnt lgkmcnt(4)
  v_mfma_f32_16x16x32_bf16 v[40:43], v[64:67], v[152:155], v[40:43]
  ds_read_b128 v[60:63], v240 offset:17408
  v_mul_f32 v100, v100, v250
  v_mfma_f32_16x16x32_bf16 v[44:47], v[64:67], v[156:159], v[44:47]
  s_waitcnt lgkmcnt(4)
  v_mfma_f32_16x16x32_bf16 v[48:51], v[68:71], v[152:155], v[48:51]
  ds_read_b128 v[64:67], v240 offset:18432
  v_rcp_f32 v82, v88
  v_mfma_f32_16x16x32_bf16 v[52:55], v[68:71], v[156:159], v[52:55]
  s_waitcnt vmcnt(9) lgkmcnt(4)
  v_mfma_f32_16x16x32_bf16 v[0:3], v[72:75], v[160:163], v[0:3]
  ds_read_b128 v[68:71], v240 offset:19456
  buffer_load_dwordx4 v[200:203], v255, s[8:11], s58 offen offset:3072 sc1
  v_rcp_f32 v94, v100
  s_waitcnt vmcnt(9)
  v_mfma_f32_16x16x32_bf16 v[4:7], v[72:75], v[164:167], v[4:7]
  v_mul_f32 v84, 0xc0135761, v88
  s_waitcnt lgkmcnt(4)
  v_mfma_f32_16x16x32_bf16 v[8:11], v[76:79], v[160:163], v[8:11]
  ds_read_b128 v[72:75], v240 offset:20480
  v_mfma_f32_16x16x32_bf16 v[12:15], v[76:79], v[164:167], v[12:15]
  v_mul_f32 v96, 0xc0135761, v100
  s_waitcnt lgkmcnt(4)
  v_mfma_f32_16x16x32_bf16 v[16:19], v[56:59], v[160:163], v[16:19]
  ds_read_b128 v[76:79], v240 offset:21504
  v_mfma_f32_16x16x32_bf16 v[20:23], v[56:59], v[164:167], v[20:23]
  v_mul_f32 v246, v88, v88
  s_waitcnt lgkmcnt(4)
  v_mfma_f32_16x16x32_bf16 v[24:27], v[60:63], v[160:163], v[24:27]
  ds_read_b128 v[56:59], v240 offset:22528
  v_mfma_f32_16x16x32_bf16 v[28:31], v[60:63], v[164:167], v[28:31]
  buffer_load_dwordx4 v[204:207], v255, s[8:11], s59 offen offset:3072 sc1
  v_mul_f32 v250, v100, v100
  s_waitcnt lgkmcnt(4)
  v_mfma_f32_16x16x32_bf16 v[32:35], v[64:67], v[160:163], v[32:35]
  ds_read_b128 v[60:63], v240 offset:23552
  v_mul_f32 v246, v246, v88
  v_mfma_f32_16x16x32_bf16 v[36:39], v[64:67], v[164:167], v[36:39]
  s_waitcnt lgkmcnt(4)
  v_mfma_f32_16x16x32_bf16 v[40:43], v[68:71], v[160:163], v[40:43]
  ds_read_b128 v[64:67], v240 offset:24576
  v_mul_f32 v250, v250, v100
  v_mfma_f32_16x16x32_bf16 v[44:47], v[68:71], v[164:167], v[44:47]
  s_waitcnt lgkmcnt(4)
  v_mfma_f32_16x16x32_bf16 v[48:51], v[72:75], v[160:163], v[48:51]
  ds_read_b128 v[68:71], v240 offset:25600
  v_mul_f32 v86, 0xbdd2d3e8, v246
  v_mfma_f32_16x16x32_bf16 v[52:55], v[72:75], v[164:167], v[52:55]
  s_waitcnt vmcnt(9) lgkmcnt(4)
  v_mfma_f32_16x16x32_bf16 v[0:3], v[76:79], v[168:171], v[0:3]
  ds_read_b128 v[72:75], v240 offset:26624
  s_add_u32 s58, s68, 16384
  buffer_load_dwordx4 v[208:211], v255, s[8:11], s58 offen offset:0 sc1
  v_mul_f32 v98, 0xbdd2d3e8, v250
  s_waitcnt vmcnt(9)
  v_mfma_f32_16x16x32_bf16 v[4:7], v[76:79], v[172:175], v[4:7]
  v_mov_b32 v81, v80
  s_waitcnt lgkmcnt(4)
  v_mfma_f32_16x16x32_bf16 v[8:11], v[56:59], v[168:171], v[8:11]
  ds_read_b128 v[76:79], v240 offset:27648
  v_mfma_f32_16x16x32_bf16 v[12:15], v[56:59], v[172:175], v[12:15]
  v_mov_b32 v83, v82
  s_waitcnt lgkmcnt(4)
  v_mfma_f32_16x16x32_bf16 v[16:19], v[60:63], v[168:171], v[16:19]
  ds_read_b128 v[56:59], v240 offset:28672
  v_mov_b32 v85, v84
  v_mfma_f32_16x16x32_bf16 v[20:23], v[60:63], v[172:175], v[20:23]
  s_waitcnt lgkmcnt(4)
  v_mfma_f32_16x16x32_bf16 v[24:27], v[64:67], v[168:171], v[24:27]
  ds_read_b128 v[60:63], v240 offset:29696
  v_mov_b32 v87, v86
  v_mfma_f32_16x16x32_bf16 v[28:31], v[64:67], v[172:175], v[28:31]
  s_add_u32 s59, s69, 16384
  buffer_load_dwordx4 v[212:215], v255, s[8:11], s59 offen offset:0 sc1
  v_mov_b32 v93, v92
  s_waitcnt lgkmcnt(4)
  v_mfma_f32_16x16x32_bf16 v[32:35], v[68:71], v[168:171], v[32:35]
  ds_read_b128 v[64:67], v240 offset:30720
  v_mfma_f32_16x16x32_bf16 v[36:39], v[68:71], v[172:175], v[36:39]
  v_mov_b32 v95, v94
  s_waitcnt lgkmcnt(4)
  v_mfma_f32_16x16x32_bf16 v[40:43], v[72:75], v[168:171], v[40:43]
  ds_read_b128 v[68:71], v240 offset:31744
  v_mov_b32 v97, v96
  v_mfma_f32_16x16x32_bf16 v[44:47], v[72:75], v[172:175], v[44:47]
  s_waitcnt lgkmcnt(4)
  v_mfma_f32_16x16x32_bf16 v[48:51], v[76:79], v[168:171], v[48:51]
  ds_read_b128 v[72:75], v240 offset:32768
  v_mov_b32 v99, v98
  v_mfma_f32_16x16x32_bf16 v[52:55], v[76:79], v[172:175], v[52:55]
  s_waitcnt vmcnt(9) lgkmcnt(4)
  v_mfma_f32_16x16x32_bf16 v[0:3], v[56:59], v[176:179], v[0:3]
  ds_read_b128 v[76:79], v240 offset:33792
  buffer_load_dwordx4 v[216:219], v255, s[8:11], s58 offen offset:1024 sc1
  s_waitcnt vmcnt(9)
  v_mfma_f32_16x16x32_bf16 v[4:7], v[56:59], v[180:183], v[4:7]
  s_waitcnt lgkmcnt(4)
  v_mfma_f32_16x16x32_bf16 v[8:11], v[60:63], v[176:179], v[8:11]
  ds_read_b128 v[56:59], v240 offset:34816
  v_mfma_f32_16x16x32_bf16 v[12:15], v[60:63], v[180:183], v[12:15]
  s_waitcnt lgkmcnt(4)
  v_mfma_f32_16x16x32_bf16 v[16:19], v[64:67], v[176:179], v[16:19]
  ds_read_b128 v[60:63], v240 offset:35840
  v_mfma_f32_16x16x32_bf16 v[20:23], v[64:67], v[180:183], v[20:23]
  s_waitcnt lgkmcnt(4)
  v_mfma_f32_16x16x32_bf16 v[24:27], v[68:71], v[176:179], v[24:27]
  ds_read_b128 v[64:67], v240 offset:36864
  v_mfma_f32_16x16x32_bf16 v[28:31], v[68:71], v[180:183], v[28:31]
  buffer_load_dwordx4 v[220:223], v255, s[8:11], s59 offen offset:1024 sc1
  s_waitcnt lgkmcnt(4)
  v_mfma_f32_16x16x32_bf16 v[32:35], v[72:75], v[176:179], v[32:35]
  ds_read_b128 v[68:71], v240 offset:37888
  v_mfma_f32_16x16x32_bf16 v[36:39], v[72:75], v[180:183], v[36:39]
  s_waitcnt lgkmcnt(4)
  v_mfma_f32_16x16x32_bf16 v[40:43], v[76:79], v[176:179], v[40:43]
  ds_read_b128 v[72:75], v240 offset:38912
  v_mfma_f32_16x16x32_bf16 v[44:47], v[76:79], v[180:183], v[44:47]
  s_waitcnt lgkmcnt(4)
  v_mfma_f32_16x16x32_bf16 v[48:51], v[56:59], v[176:179], v[48:51]
  ds_read_b128 v[76:79], v240 offset:39936
  v_mfma_f32_16x16x32_bf16 v[52:55], v[56:59], v[180:183], v[52:55]
  s_waitcnt vmcnt(9) lgkmcnt(4)
  v_mfma_f32_16x16x32_bf16 v[0:3], v[60:63], v[184:187], v[0:3]
  ds_read_b128 v[56:59], v240 offset:40960
  buffer_load_dwordx4 v[224:227], v255, s[8:11], s58 offen offset:2048 sc1
  v_lshrrev_b32 v104, 4, v254
  v_lshlrev_b32 v104, 4, v104
  s_lshl_b32 s91, s3, 6
  s_add_u32 s92, s91, 159744
  v_add_u32 v105, s92, v104
  s_add_u32 s92, s91, 162048
  v_add_u32 v104, s92, v104
  ds_read_b128 v[108:111], v105 offset:0
  ds_read_b128 v[112:115], v105 offset:448
  ds_read_b128 v[116:119], v105 offset:896
  ds_read_b128 v[120:123], v105 offset:1344
  ds_read_b128 v[124:127], v105 offset:256
  ds_read_b128 v[128:131], v105 offset:704
  ds_read_b128 v[132:135], v105 offset:1152
  ds_read_b128 v[136:139], v105 offset:1600
  s_waitcnt vmcnt(9)
  v_mfma_f32_16x16x32_bf16 v[4:7], v[60:63], v[188:191], v[4:7]
  s_waitcnt lgkmcnt(12)
  v_mfma_f32_16x16x32_bf16 v[8:11], v[64:67], v[184:187], v[8:11]
  ds_read_b128 v[60:63], v240 offset:41984
  v_mfma_f32_16x16x32_bf16 v[12:15], v[64:67], v[188:191], v[12:15]
  s_waitcnt lgkmcnt(12)
  v_mfma_f32_16x16x32_bf16 v[16:19], v[68:71], v[184:187], v[16:19]
  ds_read_b128 v[64:67], v240 offset:43008
  v_mfma_f32_16x16x32_bf16 v[20:23], v[68:71], v[188:191], v[20:23]
  s_waitcnt lgkmcnt(12)
  v_mfma_f32_16x16x32_bf16 v[24:27], v[72:75], v[184:187], v[24:27]
  ds_read_b128 v[68:71], v240 offset:44032
  v_mfma_f32_16x16x32_bf16 v[28:31], v[72:75], v[188:191], v[28:31]
  buffer_load_dwordx4 v[228:231], v255, s[8:11], s59 offen offset:2048 sc1
  s_waitcnt lgkmcnt(12)
  v_mfma_f32_16x16x32_bf16 v[32:35], v[76:79], v[184:187], v[32:35]
  ds_read_b128 v[72:75], v240 offset:45056
  v_mfma_f32_16x16x32_bf16 v[36:39], v[76:79], v[188:191], v[36:39]
  s_waitcnt lgkmcnt(12)
  v_mfma_f32_16x16x32_bf16 v[40:43], v[56:59], v[184:187], v[40:43]
  ds_read_b128 v[76:79], v240 offset:46080
  v_mfma_f32_16x16x32_bf16 v[44:47], v[56:59], v[188:191], v[44:47]
  s_waitcnt lgkmcnt(4)
  v_mfma_f32_16x16x32_bf16 v[48:51], v[60:63], v[184:187], v[48:51]
  ds_read_b128 v[56:59], v240 offset:47104
  v_mfma_f32_16x16x32_bf16 v[52:55], v[60:63], v[188:191], v[52:55]
  s_waitcnt vmcnt(9) lgkmcnt(4)
  v_mfma_f32_16x16x32_bf16 v[0:3], v[64:67], v[192:195], v[0:3]
  ds_read_b128 v[60:63], v240 offset:48128
  buffer_load_dwordx4 v[232:235], v255, s[8:11], s58 offen offset:3072 sc1
  v_pk_add_f32 v[108:109], v[108:109], v[112:113]
  v_pk_add_f32 v[116:117], v[116:117], v[120:121]
  v_pk_add_f32 v[110:111], v[110:111], v[114:115]
  v_pk_add_f32 v[118:119], v[118:119], v[122:123]
  v_pk_add_f32 v[124:125], v[124:125], v[128:129]
  v_pk_add_f32 v[132:133], v[132:133], v[136:137]
  v_pk_add_f32 v[126:127], v[126:127], v[130:131]
  v_pk_add_f32 v[134:135], v[134:135], v[138:139]
  v_pk_add_f32 v[108:109], v[108:109], v[116:117]
  v_pk_add_f32 v[110:111], v[110:111], v[118:119]
  v_pk_add_f32 v[124:125], v[124:125], v[132:133]
  v_pk_add_f32 v[126:127], v[126:127], v[134:135]
  s_waitcnt vmcnt(9)
  v_mfma_f32_16x16x32_bf16 v[4:7], v[64:67], v[196:199], v[4:7]
  s_waitcnt lgkmcnt(4)
  v_mfma_f32_16x16x32_bf16 v[8:11], v[68:71], v[192:195], v[8:11]
  ds_read_b128 v[64:67], v240 offset:49152
  v_mfma_f32_16x16x32_bf16 v[12:15], v[68:71], v[196:199], v[12:15]
  s_waitcnt lgkmcnt(4)
  v_mfma_f32_16x16x32_bf16 v[16:19], v[72:75], v[192:195], v[16:19]
  ds_read_b128 v[68:71], v240 offset:50176
  v_mfma_f32_16x16x32_bf16 v[20:23], v[72:75], v[196:199], v[20:23]
  s_waitcnt lgkmcnt(4)
  v_mfma_f32_16x16x32_bf16 v[24:27], v[76:79], v[192:195], v[24:27]
  ds_read_b128 v[72:75], v240 offset:51200
  v_mfma_f32_16x16x32_bf16 v[28:31], v[76:79], v[196:199], v[28:31]
  buffer_load_dwordx4 v[236:239], v255, s[8:11], s59 offen offset:3072 sc1
  s_waitcnt lgkmcnt(4)
  v_mfma_f32_16x16x32_bf16 v[32:35], v[56:59], v[192:195], v[32:35]
  ds_read_b128 v[76:79], v240 offset:52224
  v_mfma_f32_16x16x32_bf16 v[36:39], v[56:59], v[196:199], v[36:39]
  s_waitcnt lgkmcnt(4)
  v_mfma_f32_16x16x32_bf16 v[40:43], v[60:63], v[192:195], v[40:43]
  ds_read_b128 v[56:59], v240 offset:53248
  v_mfma_f32_16x16x32_bf16 v[44:47], v[60:63], v[196:199], v[44:47]
  s_waitcnt lgkmcnt(4)
  v_mfma_f32_16x16x32_bf16 v[48:51], v[64:67], v[192:195], v[48:51]
  ds_read_b128 v[60:63], v240 offset:54272
  v_mfma_f32_16x16x32_bf16 v[52:55], v[64:67], v[196:199], v[52:55]
  s_waitcnt vmcnt(9) lgkmcnt(4)
  v_mfma_f32_16x16x32_bf16 v[0:3], v[68:71], v[200:203], v[0:3]
  ds_read_b128 v[64:67], v240 offset:55296
  ds_write_b128 v104, v[108:111]
  s_cmp_ge_u32 s3, 3
  s_cbranch_scc1 CT_141
  ds_write_b128 v104, v[124:127] offset:256
CT_141:
  s_waitcnt vmcnt(8)
  v_mfma_f32_16x16x32_bf16 v[4:7], v[68:71], v[204:207], v[4:7]
  s_waitcnt lgkmcnt(5)
  v_mfma_f32_16x16x32_bf16 v[8:11], v[72:75], v[200:203], v[8:11]
  ds_read_b128 v[68:71], v240 offset:56320
  v_mfma_f32_16x16x32_bf16 v[12:15], v[72:75], v[204:207], v[12:15]
  s_waitcnt lgkmcnt(5)
  v_mfma_f32_16x16x32_bf16 v[16:19], v[76:79], v[200:203], v[16:19]
  ds_read_b128 v[72:75], v240 offset:57344
  v_mfma_f32_16x16x32_bf16 v[20:23], v[76:79], v[204:207], v[20:23]
  s_waitcnt lgkmcnt(5)
  v_mfma_f32_16x16x32_bf16 v[24:27], v[56:59], v[200:203], v[24:27]
  ds_read_b128 v[76:79], v240 offset:58368
  v_mfma_f32_16x16x32_bf16 v[28:31], v[56:59], v[204:207], v[28:31]
  s_waitcnt lgkmcnt(5)
  v_mfma_f32_16x16x32_bf16 v[32:35], v[60:63], v[200:203], v[32:35]
  ds_read_b128 v[56:59], v240 offset:59392
  v_mfma_f32_16x16x32_bf16 v[36:39], v[60:63], v[204:207], v[36:39]
  s_waitcnt lgkmcnt(5)
  v_mfma_f32_16x16x32_bf16 v[40:43], v[64:67], v[200:203], v[40:43]
  ds_read_b128 v[60:63], v240 offset:60416
  v_mfma_f32_16x16x32_bf16 v[44:47], v[64:67], v[204:207], v[44:47]
  s_waitcnt lgkmcnt(4)
  v_mfma_f32_16x16x32_bf16 v[48:51], v[68:71], v[200:203], v[48:51]
  ds_read_b128 v[64:67], v240 offset:61440
  v_mfma_f32_16x16x32_bf16 v[52:55], v[68:71], v[204:207], v[52:55]
  s_waitcnt vmcnt(7) lgkmcnt(4)
  v_mfma_f32_16x16x32_bf16 v[0:3], v[72:75], v[208:211], v[0:3]
  ds_read_b128 v[68:71], v240 offset:62464
  s_waitcnt vmcnt(6)
  v_mfma_f32_16x16x32_bf16 v[4:7], v[72:75], v[212:215], v[4:7]
  s_waitcnt lgkmcnt(4)
  v_mfma_f32_16x16x32_bf16 v[8:11], v[76:79], v[208:211], v[8:11]
  ds_read_b128 v[72:75], v240 offset:63488
  v_mfma_f32_16x16x32_bf16 v[12:15], v[76:79], v[212:215], v[12:15]
  s_waitcnt lgkmcnt(4)
  v_mfma_f32_16x16x32_bf16 v[16:19], v[56:59], v[208:211], v[16:19]
  ds_read_b128 v[76:79], v240 offset:64512
  v_mfma_f32_16x16x32_bf16 v[20:23], v[56:59], v[212:215], v[20:23]
  s_waitcnt lgkmcnt(4)
  v_mfma_f32_16x16x32_bf16 v[24:27], v[60:63], v[208:211], v[24:27]
  ds_read_b128 v[56:59], v241 offset:0
  v_mfma_f32_16x16x32_bf16 v[28:31], v[60:63], v[212:215], v[28:31]
  s_waitcnt lgkmcnt(4)
  v_mfma_f32_16x16x32_bf16 v[32:35], v[64:67], v[208:211], v[32:35]
  ds_read_b128 v[60:63], v241 offset:1024
  v_mfma_f32_16x16x32_bf16 v[36:39], v[64:67], v[212:215], v[36:39]
  s_waitcnt lgkmcnt(4)
  v_mfma_f32_16x16x32_bf16 v[40:43], v[68:71], v[208:211], v[40:43]
  ds_read_b128 v[64:67], v241 offset:2048
  v_mfma_f32_16x16x32_bf16 v[44:47], v[68:71], v[212:215], v[44:47]
  s_waitcnt lgkmcnt(4)
  v_mfma_f32_16x16x32_bf16 v[48:51], v[72:75], v[208:211], v[48:51]
  ds_read_b128 v[68:71], v241 offset:3072
  v_mfma_f32_16x16x32_bf16 v[52:55], v[72:75], v[212:215], v[52:55]
  s_waitcnt vmcnt(5) lgkmcnt(4)
  v_mfma_f32_16x16x32_bf16 v[0:3], v[76:79], v[216:219], v[0:3]
  ds_read_b128 v[72:75], v241 offset:4096
  s_waitcnt vmcnt(4)
  v_mfma_f32_16x16x32_bf16 v[4:7], v[76:79], v[220:223], v[4:7]
  s_waitcnt lgkmcnt(4)
  v_mfma_f32_16x16x32_bf16 v[8:11], v[56:59], v[216:219], v[8:11]
  ds_read_b128 v[76:79], v241 offset:5120
  v_mfma_f32_16x16x32_bf16 v[12:15], v[56:59], v[220:223], v[12:15]
  s_waitcnt lgkmcnt(4)
  v_mfma_f32_16x16x32_bf16 v[16:19], v[60:63], v[216:219], v[16:19]
  ds_read_b128 v[56:59], v241 offset:6144
  v_mfma_f32_16x16x32_bf16 v[20:23], v[60:63], v[220:223], v[20:23]
  s_waitcnt lgkmcnt(4)
  v_mfma_f32_16x16x32_bf16 v[24:27], v[64:67], v[216:219], v[24:27]
  ds_read_b128 v[60:63], v241 offset:7168
  v_mfma_f32_16x16x32_bf16 v[28:31], v[64:67], v[220:223], v[28:31]
  s_waitcnt lgkmcnt(4)
  v_mfma_f32_16x16x32_bf16 v[32:35], v[68:71], v[216:219], v[32:35]
  ds_read_b128 v[64:67], v241 offset:8192
  v_mfma_f32_16x16x32_bf16 v[36:39], v[68:71], v[220:223], v[36:39]
  s_waitcnt lgkmcnt(4)
  v_mfma_f32_16x16x32_bf16 v[40:43], v[72:75], v[216:219], v[40:43]
  ds_read_b128 v[68:71], v241 offset:9216
  v_mfma_f32_16x16x32_bf16 v[44:47], v[72:75], v[220:223], v[44:47]
  s_waitcnt lgkmcnt(4)
  v_mfma_f32_16x16x32_bf16 v[48:51], v[76:79], v[216:219], v[48:51]
  ds_read_b128 v[72:75], v241 offset:10240
  v_mfma_f32_16x16x32_bf16 v[52:55], v[76:79], v[220:223], v[52:55]
  s_waitcnt vmcnt(3) lgkmcnt(4)
  v_mfma_f32_16x16x32_bf16 v[0:3], v[56:59], v[224:227], v[0:3]
  ds_read_b128 v[76:79], v241 offset:11264
  s_waitcnt vmcnt(2)
  v_mfma_f32_16x16x32_bf16 v[4:7], v[56:59], v[228:231], v[4:7]
  s_waitcnt lgkmcnt(4)
  v_mfma_f32_16x16x32_bf16 v[8:11], v[60:63], v[224:227], v[8:11]
  ds_read_b128 v[56:59], v241 offset:12288
  v_mfma_f32_16x16x32_bf16 v[12:15], v[60:63], v[228:231], v[12:15]
  s_waitcnt lgkmcnt(4)
  v_mfma_f32_16x16x32_bf16 v[16:19], v[64:67], v[224:227], v[16:19]
  ds_read_b128 v[60:63], v241 offset:13312
  v_mfma_f32_16x16x32_bf16 v[20:23], v[64:67], v[228:231], v[20:23]
  s_waitcnt lgkmcnt(4)
  v_mfma_f32_16x16x32_bf16 v[24:27], v[68:71], v[224:227], v[24:27]
  ds_read_b128 v[64:67], v241 offset:14336
  v_mfma_f32_16x16x32_bf16 v[28:31], v[68:71], v[228:231], v[28:31]
  s_waitcnt lgkmcnt(4)
  v_mfma_f32_16x16x32_bf16 v[32:35], v[72:75], v[224:227], v[32:35]
  ds_read_b128 v[68:71], v241 offset:15360
  v_mfma_f32_16x16x32_bf16 v[36:39], v[72:75], v[228:231], v[36:39]
  s_waitcnt lgkmcnt(4)
  v_mfma_f32_16x16x32_bf16 v[40:43], v[76:79], v[224:227], v[40:43]
  ds_read_b128 v[72:75], v241 offset:16384
  v_mfma_f32_16x16x32_bf16 v[44:47], v[76:79], v[228:231], v[44:47]
  s_waitcnt lgkmcnt(4)
  v_mfma_f32_16x16x32_bf16 v[48:51], v[56:59], v[224:227], v[48:51]
  ds_read_b128 v[76:79], v241 offset:17408
  v_mfma_f32_16x16x32_bf16 v[52:55], v[56:59], v[228:231], v[52:55]
  s_waitcnt vmcnt(1) lgkmcnt(4)
  v_mfma_f32_16x16x32_bf16 v[0:3], v[60:63], v[232:235], v[0:3]
  ds_read_b128 v[56:59], v241 offset:18432
  s_waitcnt vmcnt(0)
  v_mfma_f32_16x16x32_bf16 v[4:7], v[60:63], v[236:239], v[4:7]
  s_waitcnt lgkmcnt(4)
  v_mfma_f32_16x16x32_bf16 v[8:11], v[64:67], v[232:235], v[8:11]
  ds_read_b128 v[60:63], v241 offset:19456
  v_mfma_f32_16x16x32_bf16 v[12:15], v[64:67], v[236:239], v[12:15]
  s_waitcnt lgkmcnt(4)
  v_mfma_f32_16x16x32_bf16 v[16:19], v[68:71], v[232:235], v[16:19]
  v_mfma_f32_16x16x32_bf16 v[20:23], v[68:71], v[236:239], v[20:23]
  s_waitcnt lgkmcnt(3)
  v_mfma_f32_16x16x32_bf16 v[24:27], v[72:75], v[232:235], v[24:27]
  v_mfma_f32_16x16x32_bf16 v[28:31], v[72:75], v[236:239], v[28:31]
  s_waitcnt lgkmcnt(2)
  v_mfma_f32_16x16x32_bf16 v[32:35], v[76:79], v[232:235], v[32:35]
  v_mfma_f32_16x16x32_bf16 v[36:39], v[76:79], v[236:239], v[36:39]
  s_waitcnt lgkmcnt(1)
  v_mfma_f32_16x16x32_bf16 v[40:43], v[56:59], v[232:235], v[40:43]
  v_mfma_f32_16x16x32_bf16 v[44:47], v[56:59], v[236:239], v[44:47]
  s_waitcnt lgkmcnt(0)
  v_mfma_f32_16x16x32_bf16 v[48:51], v[60:63], v[232:235], v[48:51]
  v_mfma_f32_16x16x32_bf16 v[52:55], v[60:63], v[236:239], v[52:55]
  s_waitcnt lgkmcnt(0)
  s_barrier
  v_lshrrev_b32 v104, 4, v254
  v_lshlrev_b32 v104, 4, v104
  v_add_u32 v105, 162048, v104
  v_add_u32 v106, 162496, v104
  ds_read_b128 v[112:115], v105 offset:0
  ds_read_b128 v[116:119], v105 offset:64
  ds_read_b128 v[120:123], v105 offset:128
  ds_read_b128 v[124:127], v105 offset:192
  ds_read_b128 v[128:131], v105 offset:256
  ds_read_b128 v[132:135], v105 offset:320
  ds_read_b128 v[136:139], v105 offset:384
  ds_read_b128 v[140:143], v106 offset:0
  ds_read_b128 v[144:147], v106 offset:64
  ds_read_b128 v[148:151], v106 offset:128
  ds_read_b128 v[152:155], v106 offset:192
  ds_read_b128 v[156:159], v106 offset:256
  ds_read_b128 v[160:163], v106 offset:320
  ds_read_b128 v[164:167], v106 offset:384
  s_add_u32 s89, s94, 0
  s_mul_i32 s54, s89, 55296
  s_add_u32 s54, s54, s48
  s_add_u32 s89, s94, 1
  s_mul_i32 s55, s89, 55296
  s_add_u32 s55, s55, s48
  v_mov_b32 v108, 1.0
  v_mov_b32 v109, 1.0
  s_waitcnt lgkmcnt(0)
  v_pk_fma_f32 v[0:1], v[112:113], v[80:81], v[0:1] neg_lo:[0,1,0] neg_hi:[0,1,0]
  v_pk_fma_f32 v[2:3], v[114:115], v[80:81], v[2:3] neg_lo:[0,1,0] neg_hi:[0,1,0]
  v_pk_fma_f32 v[8:9], v[116:117], v[80:81], v[8:9] neg_lo:[0,1,0] neg_hi:[0,1,0]
  v_pk_fma_f32 v[10:11], v[118:119], v[80:81], v[10:11] neg_lo:[0,1,0] neg_hi:[0,1,0]
  v_pk_fma_f32 v[16:17], v[120:121], v[80:81], v[16:17] neg_lo:[0,1,0] neg_hi:[0,1,0]
  v_pk_fma_f32 v[18:19], v[122:123], v[80:81], v[18:19] neg_lo:[0,1,0] neg_hi:[0,1,0]
  v_pk_fma_f32 v[24:25], v[124:125], v[80:81], v[24:25] neg_lo:[0,1,0] neg_hi:[0,1,0]
  v_pk_fma_f32 v[26:27], v[126:127], v[80:81], v[26:27] neg_lo:[0,1,0] neg_hi:[0,1,0]
  v_pk_fma_f32 v[32:33], v[128:129], v[80:81], v[32:33] neg_lo:[0,1,0] neg_hi:[0,1,0]
  v_pk_fma_f32 v[34:35], v[130:131], v[80:81], v[34:35] neg_lo:[0,1,0] neg_hi:[0,1,0]
  v_pk_fma_f32 v[40:41], v[132:133], v[80:81], v[40:41] neg_lo:[0,1,0] neg_hi:[0,1,0]
  v_pk_fma_f32 v[42:43], v[134:135], v[80:81], v[42:43] neg_lo:[0,1,0] neg_hi:[0,1,0]
  v_pk_fma_f32 v[48:49], v[136:137], v[80:81], v[48:49] neg_lo:[0,1,0] neg_hi:[0,1,0]
  v_pk_fma_f32 v[50:51], v[138:139], v[80:81], v[50:51] neg_lo:[0,1,0] neg_hi:[0,1,0]
  v_pk_fma_f32 v[0:1], v[140:141], v[82:83], v[0:1]
  v_pk_fma_f32 v[2:3], v[142:143], v[82:83], v[2:3]
  v_pk_fma_f32 v[8:9], v[144:145], v[82:83], v[8:9]
  v_pk_fma_f32 v[10:11], v[146:147], v[82:83], v[10:11]
  v_pk_fma_f32 v[16:17], v[148:149], v[82:83], v[16:17]
  v_pk_fma_f32 v[18:19], v[150:151], v[82:83], v[18:19]
  v_pk_fma_f32 v[24:25], v[152:153], v[82:83], v[24:25]
  v_pk_fma_f32 v[26:27], v[154:155], v[82:83], v[26:27]
  v_pk_fma_f32 v[32:33], v[156:157], v[82:83], v[32:33]
  v_pk_fma_f32 v[34:35], v[158:159], v[82:83], v[34:35]
  v_pk_fma_f32 v[40:41], v[160:161], v[82:83], v[40:41]
  v_pk_fma_f32 v[42:43], v[162:163], v[82:83], v[42:43]
  v_pk_fma_f32 v[48:49], v[164:165], v[82:83], v[48:49]
  v_pk_fma_f32 v[50:51], v[166:167], v[82:83], v[50:51]
  v_pk_mul_f32 v[196:197], v[0:1], v[0:1]
  v_pk_mul_f32 v[198:199], v[2:3], v[2:3]
  v_pk_mul_f32 v[200:201], v[8:9], v[8:9]
  v_pk_mul_f32 v[202:203], v[10:11], v[10:11]
  v_pk_mul_f32 v[204:205], v[16:17], v[16:17]
  v_pk_mul_f32 v[206:207], v[18:19], v[18:19]
  v_pk_mul_f32 v[208:209], v[24:25], v[24:25]
  v_pk_mul_f32 v[210:211], v[26:27], v[26:27]
  v_pk_mul_f32 v[212:213], v[32:33], v[32:33]
  v_pk_mul_f32 v[214:215], v[34:35], v[34:35]
  v_pk_mul_f32 v[216:217], v[40:41], v[40:41]
  v_pk_mul_f32 v[218:219], v[42:43], v[42:43]
  v_pk_mul_f32 v[220:221], v[48:49], v[48:49]
  v_pk_mul_f32 v[222:223], v[50:51], v[50:51]
  v_pk_fma_f32 v[196:197], v[196:197], v[86:87], v[84:85]
  v_pk_fma_f32 v[198:199], v[198:199], v[86:87], v[84:85]
  v_pk_fma_f32 v[200:201], v[200:201], v[86:87], v[84:85]
  v_pk_fma_f32 v[202:203], v[202:203], v[86:87], v[84:85]
  v_pk_fma_f32 v[204:205], v[204:205], v[86:87], v[84:85]
  v_pk_fma_f32 v[206:207], v[206:207], v[86:87], v[84:85]
  v_pk_fma_f32 v[208:209], v[208:209], v[86:87], v[84:85]
  v_pk_fma_f32 v[210:211], v[210:211], v[86:87], v[84:85]
  v_pk_fma_f32 v[212:213], v[212:213], v[86:87], v[84:85]
  v_pk_fma_f32 v[214:215], v[214:215], v[86:87], v[84:85]
  v_pk_fma_f32 v[216:217], v[216:217], v[86:87], v[84:85]
  v_pk_fma_f32 v[218:219], v[218:219], v[86:87], v[84:85]
  v_pk_fma_f32 v[220:221], v[220:221], v[86:87], v[84:85]
  v_pk_fma_f32 v[222:223], v[222:223], v[86:87], v[84:85]
  v_pk_mul_f32 v[196:197], v[196:197], v[0:1]
  v_pk_mul_f32 v[198:199], v[198:199], v[2:3]
  v_pk_mul_f32 v[200:201], v[200:201], v[8:9]
  v_pk_mul_f32 v[202:203], v[202:203], v[10:11]
  v_pk_mul_f32 v[204:205], v[204:205], v[16:17]
  v_pk_mul_f32 v[206:207], v[206:207], v[18:19]
  v_pk_mul_f32 v[208:209], v[208:209], v[24:25]
  v_pk_mul_f32 v[210:211], v[210:211], v[26:27]
  v_pk_mul_f32 v[212:213], v[212:213], v[32:33]
  v_pk_mul_f32 v[214:215], v[214:215], v[34:35]
  v_pk_mul_f32 v[216:217], v[216:217], v[40:41]
  v_pk_mul_f32 v[218:219], v[218:219], v[42:43]
  v_pk_mul_f32 v[220:221], v[220:221], v[48:49]
  v_pk_mul_f32 v[222:223], v[222:223], v[50:51]
  v_exp_f32 v196, v196
  v_exp_f32 v197, v197
  v_exp_f32 v198, v198
  v_exp_f32 v199, v199
  v_exp_f32 v200, v200
  v_exp_f32 v201, v201
  v_exp_f32 v202, v202
  v_exp_f32 v203, v203
  v_exp_f32 v204, v204
  v_exp_f32 v205, v205
  v_exp_f32 v206, v206
  v_exp_f32 v207, v207
  v_exp_f32 v208, v208
  v_exp_f32 v209, v209
  v_exp_f32 v210, v210
  v_exp_f32 v211, v211
  v_exp_f32 v212, v212
  v_exp_f32 v213, v213
  v_exp_f32 v214, v214
  v_exp_f32 v215, v215
  v_exp_f32 v216, v216
  v_exp_f32 v217, v217
  v_exp_f32 v218, v218
  v_exp_f32 v219, v219
  v_exp_f32 v220, v220
  v_exp_f32 v221, v221
  v_exp_f32 v222, v222
  v_exp_f32 v223, v223
  v_pk_add_f32 v[196:197], v[196:197], v[108:109]
  v_pk_add_f32 v[198:199], v[198:199], v[108:109]
  v_pk_add_f32 v[200:201], v[200:201], v[108:109]
  v_pk_add_f32 v[202:203], v[202:203], v[108:109]
  v_pk_add_f32 v[204:205], v[204:205], v[108:109]
  v_pk_add_f32 v[206:207], v[206:207], v[108:109]
  v_pk_add_f32 v[208:209], v[208:209], v[108:109]
  v_pk_add_f32 v[210:211], v[210:211], v[108:109]
  v_pk_add_f32 v[212:213], v[212:213], v[108:109]
  v_pk_add_f32 v[214:215], v[214:215], v[108:109]
  v_pk_add_f32 v[216:217], v[216:217], v[108:109]
  v_pk_add_f32 v[218:219], v[218:219], v[108:109]
  v_pk_add_f32 v[220:221], v[220:221], v[108:109]
  v_pk_add_f32 v[222:223], v[222:223], v[108:109]
  v_rcp_f32 v196, v196
  v_rcp_f32 v197, v197
  v_rcp_f32 v198, v198
  v_rcp_f32 v199, v199
  v_rcp_f32 v200, v200
  v_rcp_f32 v201, v201
  v_rcp_f32 v202, v202
  v_rcp_f32 v203, v203
  v_rcp_f32 v204, v204
  v_rcp_f32 v205, v205
  v_rcp_f32 v206, v206
  v_rcp_f32 v207, v207
  v_rcp_f32 v208, v208
  v_rcp_f32 v209, v209
  v_rcp_f32 v210, v210
  v_rcp_f32 v211, v211
  v_rcp_f32 v212, v212
  v_rcp_f32 v213, v213
  v_rcp_f32 v214, v214
  v_rcp_f32 v215, v215
  v_rcp_f32 v216, v216
  v_rcp_f32 v217, v217
  v_rcp_f32 v218, v218
  v_rcp_f32 v219, v219
  v_rcp_f32 v220, v220
  v_rcp_f32 v221, v221
  v_rcp_f32 v222, v222
  v_rcp_f32 v223, v223
  v_pk_mul_f32 v[0:1], v[0:1], v[196:197]
  v_pk_mul_f32 v[2:3], v[2:3], v[198:199]
  v_pk_mul_f32 v[8:9], v[8:9], v[200:201]
  v_pk_mul_f32 v[10:11], v[10:11], v[202:203]
  v_pk_mul_f32 v[16:17], v[16:17], v[204:205]
  v_pk_mul_f32 v[18:19], v[18:19], v[206:207]
  v_pk_mul_f32 v[24:25], v[24:25], v[208:209]
  v_pk_mul_f32 v[26:27], v[26:27], v[210:211]
  v_pk_mul_f32 v[32:33], v[32:33], v[212:213]
  v_pk_mul_f32 v[34:35], v[34:35], v[214:215]
  v_pk_mul_f32 v[40:41], v[40:41], v[216:217]
  v_pk_mul_f32 v[42:43], v[42:43], v[218:219]
  v_pk_mul_f32 v[48:49], v[48:49], v[220:221]
  v_pk_mul_f32 v[50:51], v[50:51], v[222:223]
  v_cvt_pk_bf16_f32 v168, v0, v1
  v_cvt_pk_bf16_f32 v169, v2, v3
  v_cvt_pk_bf16_f32 v170, v8, v9
  v_cvt_pk_bf16_f32 v171, v10, v11
  v_cvt_pk_bf16_f32 v172, v16, v17
  v_cvt_pk_bf16_f32 v173, v18, v19
  v_cvt_pk_bf16_f32 v174, v24, v25
  v_cvt_pk_bf16_f32 v175, v26, v27
  v_cvt_pk_bf16_f32 v176, v32, v33
  v_cvt_pk_bf16_f32 v177, v34, v35
  v_cvt_pk_bf16_f32 v178, v40, v41
  v_cvt_pk_bf16_f32 v179, v42, v43
  v_cvt_pk_bf16_f32 v180, v48, v49
  v_cvt_pk_bf16_f32 v181, v50, v51
  v_pk_fma_f32 v[4:5], v[112:113], v[92:93], v[4:5] neg_lo:[0,1,0] neg_hi:[0,1,0]
  v_pk_fma_f32 v[6:7], v[114:115], v[92:93], v[6:7] neg_lo:[0,1,0] neg_hi:[0,1,0]
  v_pk_fma_f32 v[12:13], v[116:117], v[92:93], v[12:13] neg_lo:[0,1,0] neg_hi:[0,1,0]
  v_pk_fma_f32 v[14:15], v[118:119], v[92:93], v[14:15] neg_lo:[0,1,0] neg_hi:[0,1,0]
  v_pk_fma_f32 v[20:21], v[120:121], v[92:93], v[20:21] neg_lo:[0,1,0] neg_hi:[0,1,0]
  v_pk_fma_f32 v[22:23], v[122:123], v[92:93], v[22:23] neg_lo:[0,1,0] neg_hi:[0,1,0]
  v_pk_fma_f32 v[28:29], v[124:125], v[92:93], v[28:29] neg_lo:[0,1,0] neg_hi:[0,1,0]
  v_pk_fma_f32 v[30:31], v[126:127], v[92:93], v[30:31] neg_lo:[0,1,0] neg_hi:[0,1,0]
  v_pk_fma_f32 v[36:37], v[128:129], v[92:93], v[36:37] neg_lo:[0,1,0] neg_hi:[0,1,0]
  v_pk_fma_f32 v[38:39], v[130:131], v[92:93], v[38:39] neg_lo:[0,1,0] neg_hi:[0,1,0]
  v_pk_fma_f32 v[44:45], v[132:133], v[92:93], v[44:45] neg_lo:[0,1,0] neg_hi:[0,1,0]
  v_pk_fma_f32 v[46:47], v[134:135], v[92:93], v[46:47] neg_lo:[0,1,0] neg_hi:[0,1,0]
  v_pk_fma_f32 v[52:53], v[136:137], v[92:93], v[52:53] neg_lo:[0,1,0] neg_hi:[0,1,0]
  v_pk_fma_f32 v[54:55], v[138:139], v[92:93], v[54:55] neg_lo:[0,1,0] neg_hi:[0,1,0]
  v_pk_fma_f32 v[4:5], v[140:141], v[94:95], v[4:5]
  v_pk_fma_f32 v[6:7], v[142:143], v[94:95], v[6:7]
  v_pk_fma_f32 v[12:13], v[144:145], v[94:95], v[12:13]
  v_pk_fma_f32 v[14:15], v[146:147], v[94:95], v[14:15]
  v_pk_fma_f32 v[20:21], v[148:149], v[94:95], v[20:21]
  v_pk_fma_f32 v[22:23], v[150:151], v[94:95], v[22:23]
  v_pk_fma_f32 v[28:29], v[152:153], v[94:95], v[28:29]
  v_pk_fma_f32 v[30:31], v[154:155], v[94:95], v[30:31]
  v_pk_fma_f32 v[36:37], v[156:157], v[94:95], v[36:37]
  v_pk_fma_f32 v[38:39], v[158:159], v[94:95], v[38:39]
  v_pk_fma_f32 v[44:45], v[160:161], v[94:95], v[44:45]
  v_pk_fma_f32 v[46:47], v[162:163], v[94:95], v[46:47]
  v_pk_fma_f32 v[52:53], v[164:165], v[94:95], v[52:53]
  v_pk_fma_f32 v[54:55], v[166:167], v[94:95], v[54:55]
  v_pk_mul_f32 v[196:197], v[4:5], v[4:5]
  v_pk_mul_f32 v[198:199], v[6:7], v[6:7]
  v_pk_mul_f32 v[200:201], v[12:13], v[12:13]
  v_pk_mul_f32 v[202:203], v[14:15], v[14:15]
  v_pk_mul_f32 v[204:205], v[20:21], v[20:21]
  v_pk_mul_f32 v[206:207], v[22:23], v[22:23]
  v_pk_mul_f32 v[208:209], v[28:29], v[28:29]
  v_pk_mul_f32 v[210:211], v[30:31], v[30:31]
  v_pk_mul_f32 v[212:213], v[36:37], v[36:37]
  v_pk_mul_f32 v[214:215], v[38:39], v[38:39]
  v_pk_mul_f32 v[216:217], v[44:45], v[44:45]
  v_pk_mul_f32 v[218:219], v[46:47], v[46:47]
  v_pk_mul_f32 v[220:221], v[52:53], v[52:53]
  v_pk_mul_f32 v[222:223], v[54:55], v[54:55]
  v_pk_fma_f32 v[196:197], v[196:197], v[98:99], v[96:97]
  v_pk_fma_f32 v[198:199], v[198:199], v[98:99], v[96:97]
  v_pk_fma_f32 v[200:201], v[200:201], v[98:99], v[96:97]
  v_pk_fma_f32 v[202:203], v[202:203], v[98:99], v[96:97]
  v_pk_fma_f32 v[204:205], v[204:205], v[98:99], v[96:97]
  v_pk_fma_f32 v[206:207], v[206:207], v[98:99], v[96:97]
  v_pk_fma_f32 v[208:209], v[208:209], v[98:99], v[96:97]
  v_pk_fma_f32 v[210:211], v[210:211], v[98:99], v[96:97]
  v_pk_fma_f32 v[212:213], v[212:213], v[98:99], v[96:97]
  v_pk_fma_f32 v[214:215], v[214:215], v[98:99], v[96:97]
  v_pk_fma_f32 v[216:217], v[216:217], v[98:99], v[96:97]
  v_pk_fma_f32 v[218:219], v[218:219], v[98:99], v[96:97]
  v_pk_fma_f32 v[220:221], v[220:221], v[98:99], v[96:97]
  v_pk_fma_f32 v[222:223], v[222:223], v[98:99], v[96:97]
  v_pk_mul_f32 v[196:197], v[196:197], v[4:5]
  v_pk_mul_f32 v[198:199], v[198:199], v[6:7]
  v_pk_mul_f32 v[200:201], v[200:201], v[12:13]
  v_pk_mul_f32 v[202:203], v[202:203], v[14:15]
  v_pk_mul_f32 v[204:205], v[204:205], v[20:21]
  v_pk_mul_f32 v[206:207], v[206:207], v[22:23]
  v_pk_mul_f32 v[208:209], v[208:209], v[28:29]
  v_pk_mul_f32 v[210:211], v[210:211], v[30:31]
  v_pk_mul_f32 v[212:213], v[212:213], v[36:37]
  v_pk_mul_f32 v[214:215], v[214:215], v[38:39]
  v_pk_mul_f32 v[216:217], v[216:217], v[44:45]
  v_pk_mul_f32 v[218:219], v[218:219], v[46:47]
  v_pk_mul_f32 v[220:221], v[220:221], v[52:53]
  v_pk_mul_f32 v[222:223], v[222:223], v[54:55]
  v_exp_f32 v196, v196
  v_exp_f32 v197, v197
  v_exp_f32 v198, v198
  v_exp_f32 v199, v199
  v_exp_f32 v200, v200
  v_exp_f32 v201, v201
  v_exp_f32 v202, v202
  v_exp_f32 v203, v203
  v_exp_f32 v204, v204
  v_exp_f32 v205, v205
  v_exp_f32 v206, v206
  v_exp_f32 v207, v207
  v_exp_f32 v208, v208
  v_exp_f32 v209, v209
  v_exp_f32 v210, v210
  v_exp_f32 v211, v211
  v_exp_f32 v212, v212
  v_exp_f32 v213, v213
  v_exp_f32 v214, v214
  v_exp_f32 v215, v215
  v_exp_f32 v216, v216
  v_exp_f32 v217, v217
  v_exp_f32 v218, v218
  v_exp_f32 v219, v219
  v_exp_f32 v220, v220
  v_exp_f32 v221, v221
  v_exp_f32 v222, v222
  v_exp_f32 v223, v223
  v_pk_add_f32 v[196:197], v[196:197], v[108:109]
  v_pk_add_f32 v[198:199], v[198:199], v[108:109]
  v_pk_add_f32 v[200:201], v[200:201], v[108:109]
  v_pk_add_f32 v[202:203], v[202:203], v[108:109]
  v_pk_add_f32 v[204:205], v[204:205], v[108:109]
  v_pk_add_f32 v[206:207], v[206:207], v[108:109]
  v_pk_add_f32 v[208:209], v[208:209], v[108:109]
  v_pk_add_f32 v[210:211], v[210:211], v[108:109]
  v_pk_add_f32 v[212:213], v[212:213], v[108:109]
  v_pk_add_f32 v[214:215], v[214:215], v[108:109]
  v_pk_add_f32 v[216:217], v[216:217], v[108:109]
  v_pk_add_f32 v[218:219], v[218:219], v[108:109]
  v_pk_add_f32 v[220:221], v[220:221], v[108:109]
  v_pk_add_f32 v[222:223], v[222:223], v[108:109]
  v_rcp_f32 v196, v196
  v_rcp_f32 v197, v197
  v_rcp_f32 v198, v198
  v_rcp_f32 v199, v199
  v_rcp_f32 v200, v200
  v_rcp_f32 v201, v201
  v_rcp_f32 v202, v202
  v_rcp_f32 v203, v203
  v_rcp_f32 v204, v204
  v_rcp_f32 v205, v205
  v_rcp_f32 v206, v206
  v_rcp_f32 v207, v207
  v_rcp_f32 v208, v208
  v_rcp_f32 v209, v209
  v_rcp_f32 v210, v210
  v_rcp_f32 v211, v211
  v_rcp_f32 v212, v212
  v_rcp_f32 v213, v213
  v_rcp_f32 v214, v214
  v_rcp_f32 v215, v215
  v_rcp_f32 v216, v216
  v_rcp_f32 v217, v217
  v_rcp_f32 v218, v218
  v_rcp_f32 v219, v219
  v_rcp_f32 v220, v220
  v_rcp_f32 v221, v221
  v_rcp_f32 v222, v222
  v_rcp_f32 v223, v223
  v_pk_mul_f32 v[4:5], v[4:5], v[196:197]
  v_pk_mul_f32 v[6:7], v[6:7], v[198:199]
  v_pk_mul_f32 v[12:13], v[12:13], v[200:201]
  v_pk_mul_f32 v[14:15], v[14:15], v[202:203]
  v_pk_mul_f32 v[20:21], v[20:21], v[204:205]
  v_pk_mul_f32 v[22:23], v[22:23], v[206:207]
  v_pk_mul_f32 v[28:29], v[28:29], v[208:209]
  v_pk_mul_f32 v[30:31], v[30:31], v[210:211]
  v_pk_mul_f32 v[36:37], v[36:37], v[212:213]
  v_pk_mul_f32 v[38:39], v[38:39], v[214:215]
  v_pk_mul_f32 v[44:45], v[44:45], v[216:217]
  v_pk_mul_f32 v[46:47], v[46:47], v[218:219]
  v_pk_mul_f32 v[52:53], v[52:53], v[220:221]
  v_pk_mul_f32 v[54:55], v[54:55], v[222:223]
  v_cvt_pk_bf16_f32 v182, v4, v5
  v_cvt_pk_bf16_f32 v183, v6, v7
  v_cvt_pk_bf16_f32 v184, v12, v13
  v_cvt_pk_bf16_f32 v185, v14, v15
  v_cvt_pk_bf16_f32 v186, v20, v21
  v_cvt_pk_bf16_f32 v187, v22, v23
  v_cvt_pk_bf16_f32 v188, v28, v29
  v_cvt_pk_bf16_f32 v189, v30, v31
  v_cvt_pk_bf16_f32 v190, v36, v37
  v_cvt_pk_bf16_f32 v191, v38, v39
  v_cvt_pk_bf16_f32 v192, v44, v45
  v_cvt_pk_bf16_f32 v193, v46, v47
  v_cvt_pk_bf16_f32 v194, v52, v53
  v_cvt_pk_bf16_f32 v195, v54, v55
  s_bitcmp1_b32 s95, 0
  s_cbranch_scc1 PO_142
  s_nop 3
  s_cmp_lg_u32 s6, 0
  s_cbranch_scc1 HS_144
  s_add_u32 s92, s63, s54
  buffer_store_dwordx4 v[168:171], v255, s[8:11], s92 offen
  s_add_u32 s92, s65, s54
  buffer_store_dwordx4 v[172:175], v255, s[8:11], s92 offen
  s_add_u32 s92, s67, s54
  buffer_store_dwordx4 v[176:179], v255, s[8:11], s92 offen
  s_add_u32 s92, s57, s54
  buffer_store_dwordx2 v[180:181], v255, s[8:11], s92 offen
  s_add_u32 s92, s63, s55
  buffer_store_dwordx4 v[182:185], v255, s[8:11], s92 offen
  s_add_u32 s92, s65, s55
  buffer_store_dwordx4 v[186:189], v255, s[8:11], s92 offen
  s_add_u32 s92, s67, s55
  buffer_store_dwordx4 v[190:193], v255, s[8:11], s92 offen
  s_add_u32 s92, s57, s55
  buffer_store_dwordx2 v[194:195], v255, s[8:11], s92 offen
  s_branch HE_145
HS_144:
  s_add_u32 s92, s63, s54
  buffer_store_dwordx4 v[168:171], v255, s[8:11], s92 offen sc1
  s_add_u32 s92, s65, s54
  buffer_store_dwordx4 v[172:175], v255, s[8:11], s92 offen sc1
  s_add_u32 s92, s67, s54
  buffer_store_dwordx4 v[176:179], v255, s[8:11], s92 offen sc1
  s_add_u32 s92, s57, s54
  buffer_store_dwordx2 v[180:181], v255, s[8:11], s92 offen sc1
  s_add_u32 s92, s63, s55
  buffer_store_dwordx4 v[182:185], v255, s[8:11], s92 offen sc1
  s_add_u32 s92, s65, s55
  buffer_store_dwordx4 v[186:189], v255, s[8:11], s92 offen sc1
  s_add_u32 s92, s67, s55
  buffer_store_dwordx4 v[190:193], v255, s[8:11], s92 offen sc1
  s_add_u32 s92, s57, s55
  buffer_store_dwordx2 v[194:195], v255, s[8:11], s92 offen sc1
HE_145:
  s_nop 1
  s_branch PE_143
PO_142:
  s_nop 3
  s_cmp_lg_u32 s6, 0
  s_cbranch_scc1 HS_146
  s_add_u32 s92, s63, s54
  buffer_store_dwordx2 v[168:169], v255, s[8:11], s92 offen
  s_add_u32 s92, s64, s54
  buffer_store_dwordx4 v[170:173], v255, s[8:11], s92 offen
  s_add_u32 s92, s66, s54
  buffer_store_dwordx4 v[174:177], v255, s[8:11], s92 offen
  s_add_u32 s92, s56, s54
  buffer_store_dwordx4 v[178:181], v255, s[8:11], s92 offen
  s_add_u32 s92, s63, s55
  buffer_store_dwordx2 v[182:183], v255, s[8:11], s92 offen
  s_add_u32 s92, s64, s55
  buffer_store_dwordx4 v[184:187], v255, s[8:11], s92 offen
  s_add_u32 s92, s66, s55
  buffer_store_dwordx4 v[188:191], v255, s[8:11], s92 offen
  s_add_u32 s92, s56, s55
  buffer_store_dwordx4 v[192:195], v255, s[8:11], s92 offen
  s_branch HE_147
HS_146:
  s_add_u32 s92, s63, s54
  buffer_store_dwordx2 v[168:169], v255, s[8:11], s92 offen sc1
  s_add_u32 s92, s64, s54
  buffer_store_dwordx4 v[170:173], v255, s[8:11], s92 offen sc1
  s_add_u32 s92, s66, s54
  buffer_store_dwordx4 v[174:177], v255, s[8:11], s92 offen sc1
  s_add_u32 s92, s56, s54
  buffer_store_dwordx4 v[178:181], v255, s[8:11], s92 offen sc1
  s_add_u32 s92, s63, s55
  buffer_store_dwordx2 v[182:183], v255, s[8:11], s92 offen sc1
  s_add_u32 s92, s64, s55
  buffer_store_dwordx4 v[184:187], v255, s[8:11], s92 offen sc1
  s_add_u32 s92, s66, s55
  buffer_store_dwordx4 v[188:191], v255, s[8:11], s92 offen sc1
  s_add_u32 s92, s56, s55
  buffer_store_dwordx4 v[192:195], v255, s[8:11], s92 offen sc1
HE_147:
  s_nop 1
PE_143:
  s_waitcnt vmcnt(0) lgkmcnt(0)
  s_lshl_b32 s54, s4, 9
  s_lshl_b32 s55, s5, 4
  s_add_u32 s54, s54, s55
  s_add_u32 s54, s54, s52
  s_add_u32 s54, s54, 12288
  s_lshl_b32 s55, s3, 2
  s_add_u32 s54, s54, s55
  v_mov_b32 v220, s7
  v_lshlrev_b32 v221, 2, v254
  s_mov_b64 exec, 1
  s_nop 3
  s_cmp_lg_u32 s6, 0
  s_cbranch_scc1 HS_148
  buffer_store_dword v220, v221, s[8:11], s54 offen
  s_branch HE_149
HS_148:
  buffer_store_dword v220, v221, s[8:11], s54 offen sc1
HE_149:
  s_nop 1
  s_mov_b64 exec, -1
  s_lshl_b32 s94, s4, 4
  s_lshr_b32 s87, s5, 3
  s_lshl_b32 s87, s87, 2
  s_add_u32 s94, s94, s87
  s_and_b32 s87, s3, 1
  s_lshl_b32 s87, s87, 1
  s_add_u32 s87, s87, s94
  s_lshr_b32 s93, s3, 1
  s_add_u32 s89, s87, 0
  s_mul_i32 s68, s89, 55296
  s_add_u32 s68, s68, s48
  s_mul_i32 s89, s93, 27648
  s_add_u32 s68, s68, s89
  s_add_u32 s89, s87, 1
  s_mul_i32 s69, s89, 55296
  s_add_u32 s69, s69, s48
  s_mul_i32 s89, s93, 27648
  s_add_u32 s69, s69, s89
  s_add_u32 s95, s87, s93
  s_and_b32 s96, s5, 7
  s_mul_i32 s90, s96, 5
  s_add_u32 s91, s90, 0
  s_lshr_b32 s92, s91, 1
  s_lshl_b32 s92, s92, 10
  s_and_b32 s91, s91, 1
  s_lshl_b32 s91, s91, 3
  s_add_u32 s63, s92, s91
  s_add_u32 s91, s90, 1
  s_lshr_b32 s92, s91, 1
  s_lshl_b32 s92, s92, 10
  s_and_b32 s91, s91, 1
  s_lshl_b32 s91, s91, 3
  s_add_u32 s64, s92, s91
  s_add_u32 s91, s90, 2
  s_lshr_b32 s92, s91, 1
  s_lshl_b32 s92, s92, 10
  s_and_b32 s91, s91, 1
  s_lshl_b32 s91, s91, 3
  s_add_u32 s65, s92, s91
  s_add_u32 s91, s90, 3
  s_lshr_b32 s92, s91, 1
  s_lshl_b32 s92, s92, 10
  s_and_b32 s91, s91, 1
  s_lshl_b32 s91, s91, 3
  s_add_u32 s66, s92, s91
  s_add_u32 s91, s90, 4
  s_lshr_b32 s92, s91, 1
  s_lshl_b32 s92, s92, 10
  s_and_b32 s91, s91, 1
  s_lshl_b32 s91, s91, 3
  s_add_u32 s67, s92, s91
  s_mul_i32 s91, s93, 5120
  v_add_u32 v246, s91, v255
  v_add_u32 v247, 65536, v246
  v_add_u32 v248, 131072, v246
  s_mul_i32 s91, s3, 5120
  s_add_u32 s91, s91, 102400
  v_add_u32 v249, s91, v255
  s_xor_b32 s92, s3, 2
  s_mul_i32 s92, s92, 5120
  s_add_u32 s92, s92, 102400
  v_add_u32 v250, s92, v255
  v_and_b32 v251, 15, v254
  v_lshlrev_b32 v251, 3, v251
  v_lshrrev_b32 v202, 4, v254
  v_lshlrev_b32 v202, 8, v202
  v_and_b32 v220, 15, v254
  v_lshlrev_b32 v220, 3, v220
  v_add_u32 v202, v202, v220
  s_mov_b32 s28, s36
  s_and_b32 s29, s37, 0xffff
  s_mov_b32 s30, 1280
  s_mov_b32 s31, 0x20000
  v_lshrrev_b32 v204, 4, v254
  v_lshlrev_b32 v204, 3, v204
  s_mul_i32 s91, s96, 160
  buffer_load_dwordx2 v[114:115], v204, s[28:31], s91 offen offset:0
  buffer_load_dwordx2 v[116:117], v204, s[28:31], s91 offen offset:32
  buffer_load_dwordx2 v[118:119], v204, s[28:31], s91 offen offset:64
  buffer_load_dwordx2 v[120:121], v204, s[28:31], s91 offen offset:96
  buffer_load_dwordx2 v[122:123], v204, s[28:31], s91 offen offset:128
  s_mul_i32 s89, s95, 20480
  s_add_u32 s89, s89, s45
  s_add_u32 s91, s63, s89
  buffer_load_dwordx2 v[100:101], v255, s[8:11], s91 offen sc1
  s_add_u32 s91, s64, s89
  buffer_load_dwordx2 v[102:103], v255, s[8:11], s91 offen sc1
  s_add_u32 s91, s65, s89
  buffer_load_dwordx2 v[104:105], v255, s[8:11], s91 offen sc1
  s_add_u32 s91, s66, s89
  buffer_load_dwordx2 v[106:107], v255, s[8:11], s91 offen sc1
  s_add_u32 s91, s67, s89
  buffer_load_dwordx2 v[108:109], v255, s[8:11], s91 offen sc1
  s_lshl_b32 s85, s95, 10
  s_add_u32 s85, s85, s46
  buffer_load_dwordx2 v[110:111], v202, s[8:11], s85 offen sc1
  buffer_load_dwordx2 v[112:113], v202, s[8:11], s85 offen offset:128 sc1
  s_waitcnt vmcnt(0)
  v_pk_add_f32 v[110:111], v[110:111], v[112:113]
  v_mov_b32 v126, v110
  v_mov_b32 v127, v111
  s_nop 0
  v_permlane16_swap_b32 v110, v126
  v_permlane16_swap_b32 v111, v127
  v_add_f32 v110, v110, v126
  v_add_f32 v111, v111, v127
  v_mov_b32 v126, v110
  v_mov_b32 v127, v111
  s_nop 0
  v_permlane32_swap_b32 v110, v126
  v_permlane32_swap_b32 v111, v127
  v_add_f32 v110, v110, v126
  v_add_f32 v111, v111, v127
  v_mul_f32 v124, 0x3acccccd, v110
  v_mul_f32 v111, 0x3acccccd, v111
  v_fma_f32 v111, -v124, v124, v111
  v_max_f32 v111, 0, v111
  v_add_f32 v126, 0x3727c5ac, v111
  v_rsq_f32 v125, v126
  s_nop 0
  v_mul_f32 v126, v125, v125
  v_mul_f32 v126, v126, v111
  v_add_f32 v126, 0x3727c5ac, v126
  v_rsq_f32 v126, v126
  s_nop 0
  v_mul_f32 v244, v125, v126
  s_nop 0
  v_mov_b32 v245, v244
  v_lshlrev_b32 v224, 16, v100
  v_and_b32 v225, 0xffff0000, v100
  v_lshlrev_b32 v226, 16, v101
  v_and_b32 v227, 0xffff0000, v101
  v_lshlrev_b32 v228, 16, v102
  v_and_b32 v229, 0xffff0000, v102
  v_lshlrev_b32 v230, 16, v103
  v_and_b32 v231, 0xffff0000, v103
  v_lshlrev_b32 v232, 16, v104
  v_and_b32 v233, 0xffff0000, v104
  v_lshlrev_b32 v234, 16, v105
  v_and_b32 v235, 0xffff0000, v105
  v_lshlrev_b32 v236, 16, v106
  v_and_b32 v237, 0xffff0000, v106
  v_lshlrev_b32 v238, 16, v107
  v_and_b32 v239, 0xffff0000, v107
  v_lshlrev_b32 v240, 16, v108
  v_and_b32 v241, 0xffff0000, v108
  v_lshlrev_b32 v242, 16, v109
  v_and_b32 v243, 0xffff0000, v109
  v_lshlrev_b32 v128, 16, v114
  v_and_b32 v129, 0xffff0000, v114
  v_lshlrev_b32 v130, 16, v115
  v_and_b32 v131, 0xffff0000, v115
  v_pk_add_f32 v[224:225], v[224:225], v[128:129]
  v_pk_add_f32 v[226:227], v[226:227], v[130:131]
  v_lshlrev_b32 v132, 16, v116
  v_and_b32 v133, 0xffff0000, v116
  v_lshlrev_b32 v134, 16, v117
  v_and_b32 v135, 0xffff0000, v117
  v_pk_add_f32 v[228:229], v[228:229], v[132:133]
  v_pk_add_f32 v[230:231], v[230:231], v[134:135]
  v_lshlrev_b32 v128, 16, v118
  v_and_b32 v129, 0xffff0000, v118
  v_lshlrev_b32 v130, 16, v119
  v_and_b32 v131, 0xffff0000, v119
  v_pk_add_f32 v[232:233], v[232:233], v[128:129]
  v_pk_add_f32 v[234:235], v[234:235], v[130:131]
  v_lshlrev_b32 v132, 16, v120
  v_and_b32 v133, 0xffff0000, v120
  v_lshlrev_b32 v134, 16, v121
  v_and_b32 v135, 0xffff0000, v121
  v_pk_add_f32 v[236:237], v[236:237], v[132:133]
  v_pk_add_f32 v[238:239], v[238:239], v[134:135]
  v_lshlrev_b32 v128, 16, v122
  v_and_b32 v129, 0xffff0000, v122
  v_lshlrev_b32 v130, 16, v123
  v_and_b32 v131, 0xffff0000, v123
  v_pk_add_f32 v[240:241], v[240:241], v[128:129]
  v_pk_add_f32 v[242:243], v[242:243], v[130:131]
  s_cmp_lg_u32 s3, 0
  s_cbranch_scc1 NS_157
  s_lshl_b32 s62, s4, 9
  s_add_u32 s62, s62, s52
  s_add_u32 s62, s62, 12288
  s_lshr_b32 s88, s5, 4
  s_lshl_b32 s88, s88, 8
  s_add_u32 s62, s62, s88
  v_lshlrev_b32 v221, 2, v254
  s_mov_b32 s58, 0
POLL_158:
  buffer_load_dword v220, v221, s[8:11], s62 offen sc1
  s_waitcnt vmcnt(0)
  v_cmp_ne_u32 vcc, s7, v220
  s_add_u32 s58, s58, 1
  s_cbranch_vccz POLLD_159
  s_cmp_lt_u32 s58, 0x200000
  s_cbranch_scc1 POLL_158
  v_mov_b32 v220, 14
  v_mov_b32 v221, 8
  s_mov_b32 s28, s40
  s_and_b32 s29, s41, 0xffff
  s_mov_b32 s30, 256
  s_mov_b32 s31, 0x20000
  s_mov_b64 exec, 1
  buffer_store_dword v220, v221, s[28:31], 0 offen
POLLD_159:
  s_mov_b64 exec, -1
NS_157:
  s_barrier
  s_add_u32 s58, s68, 0
  buffer_load_dwordx4 v[64:67], v255, s[8:11], s58 offen offset:0 sc1
  s_add_u32 s59, s69, 0
  buffer_load_dwordx4 v[68:71], v255, s[8:11], s59 offen offset:0 sc1
  buffer_load_dwordx4 v[72:75], v255, s[8:11], s58 offen offset:1024 sc1
  buffer_load_dwordx4 v[76:79], v255, s[8:11], s59 offen offset:1024 sc1
  buffer_load_dwordx4 v[80:83], v255, s[8:11], s58 offen offset:2048 sc1
  buffer_load_dwordx4 v[84:87], v255, s[8:11], s59 offen offset:2048 sc1
  buffer_load_dwordx4 v[88:91], v255, s[8:11], s58 offen offset:3072 sc1
  buffer_load_dwordx4 v[92:95], v255, s[8:11], s59 offen offset:3072 sc1
  s_add_u32 s58, s68, 4096
  buffer_load_dwordx4 v[96:99], v255, s[8:11], s58 offen offset:0 sc1
  s_add_u32 s59, s69, 4096
  buffer_load_dwordx4 v[100:103], v255, s[8:11], s59 offen offset:0 sc1
  buffer_load_dwordx4 v[104:107], v255, s[8:11], s58 offen offset:1024 sc1
  buffer_load_dwordx4 v[108:111], v255, s[8:11], s59 offen offset:1024 sc1
  ds_read_b128 v[40:43], v247 offset:20480
  ds_read_b128 v[44:47], v247 offset:21504
  ds_read_b128 v[48:51], v247 offset:22528
  ds_read_b128 v[52:55], v247 offset:23552
  ds_read_b128 v[56:59], v247 offset:24576
  s_mul_i32 s89, s95, 20480
  s_add_u32 s89, s89, s50
  s_lshl_b32 s90, s95, 10
  s_lshl_b32 s91, s96, 7
  s_add_u32 s90, s90, s91
  s_add_u32 s90, s90, s51
  buffer_load_dword v216, v251, s[8:11], s90 offen
  s_waitcnt vmcnt(12) lgkmcnt(4)
  v_mfma_f32_16x16x32_bf16 v[0:3], v[40:43], v[64:67], 0
  ds_read_b128 v[60:63], v247 offset:30720
  buffer_load_dwordx4 v[112:115], v255, s[8:11], s58 offen offset:2048 sc1
  s_waitcnt vmcnt(12)
  v_mfma_f32_16x16x32_bf16 v[4:7], v[40:43], v[68:71], 0
  s_waitcnt lgkmcnt(4)
  v_mfma_f32_16x16x32_bf16 v[8:11], v[44:47], v[64:67], 0
  ds_read_b128 v[40:43], v247 offset:31744
  v_mfma_f32_16x16x32_bf16 v[12:15], v[44:47], v[68:71], 0
  s_waitcnt lgkmcnt(4)
  v_mfma_f32_16x16x32_bf16 v[16:19], v[48:51], v[64:67], 0
  ds_read_b128 v[44:47], v247 offset:32768
  v_mfma_f32_16x16x32_bf16 v[20:23], v[48:51], v[68:71], 0
  buffer_load_dwordx4 v[116:119], v255, s[8:11], s59 offen offset:2048 sc1
  s_waitcnt lgkmcnt(4)
  v_mfma_f32_16x16x32_bf16 v[24:27], v[52:55], v[64:67], 0
  ds_read_b128 v[48:51], v247 offset:33792
  v_mfma_f32_16x16x32_bf16 v[28:31], v[52:55], v[68:71], 0
  s_waitcnt lgkmcnt(4)
  v_mfma_f32_16x16x32_bf16 v[32:35], v[56:59], v[64:67], 0
  ds_read_b128 v[52:55], v247 offset:34816
  v_mfma_f32_16x16x32_bf16 v[36:39], v[56:59], v[68:71], 0
  s_waitcnt vmcnt(12) lgkmcnt(4)
  v_mfma_f32_16x16x32_bf16 v[0:3], v[60:63], v[72:75], v[0:3]
  ds_read_b128 v[56:59], v247 offset:40960
  buffer_load_dwordx4 v[120:123], v255, s[8:11], s58 offen offset:3072 sc1
  s_waitcnt vmcnt(12)
  v_mfma_f32_16x16x32_bf16 v[4:7], v[60:63], v[76:79], v[4:7]
  s_waitcnt lgkmcnt(4)
  v_mfma_f32_16x16x32_bf16 v[8:11], v[40:43], v[72:75], v[8:11]
  ds_read_b128 v[60:63], v247 offset:41984
  v_mfma_f32_16x16x32_bf16 v[12:15], v[40:43], v[76:79], v[12:15]
  s_waitcnt lgkmcnt(4)
  v_mfma_f32_16x16x32_bf16 v[16:19], v[44:47], v[72:75], v[16:19]
  ds_read_b128 v[40:43], v247 offset:43008
  v_mfma_f32_16x16x32_bf16 v[20:23], v[44:47], v[76:79], v[20:23]
  buffer_load_dwordx4 v[124:127], v255, s[8:11], s59 offen offset:3072 sc1
  s_waitcnt lgkmcnt(4)
  v_mfma_f32_16x16x32_bf16 v[24:27], v[48:51], v[72:75], v[24:27]
  ds_read_b128 v[44:47], v247 offset:44032
  v_mfma_f32_16x16x32_bf16 v[28:31], v[48:51], v[76:79], v[28:31]
  s_waitcnt lgkmcnt(4)
  v_mfma_f32_16x16x32_bf16 v[32:35], v[52:55], v[72:75], v[32:35]
  ds_read_b128 v[48:51], v247 offset:45056
  v_mfma_f32_16x16x32_bf16 v[36:39], v[52:55], v[76:79], v[36:39]
  s_waitcnt vmcnt(12) lgkmcnt(4)
  v_mfma_f32_16x16x32_bf16 v[0:3], v[56:59], v[80:83], v[0:3]
  ds_read_b128 v[52:55], v247 offset:51200
  s_add_u32 s58, s68, 8192
  buffer_load_dwordx4 v[128:131], v255, s[8:11], s58 offen offset:0 sc1
  s_waitcnt vmcnt(12)
  v_mfma_f32_16x16x32_bf16 v[4:7], v[56:59], v[84:87], v[4:7]
  s_waitcnt lgkmcnt(4)
  v_mfma_f32_16x16x32_bf16 v[8:11], v[60:63], v[80:83], v[8:11]
  ds_read_b128 v[56:59], v247 offset:52224
  v_mfma_f32_16x16x32_bf16 v[12:15], v[60:63], v[84:87], v[12:15]
  s_waitcnt lgkmcnt(4)
  v_mfma_f32_16x16x32_bf16 v[16:19], v[40:43], v[80:83], v[16:19]
  ds_read_b128 v[60:63], v247 offset:53248
  v_mfma_f32_16x16x32_bf16 v[20:23], v[40:43], v[84:87], v[20:23]
  s_add_u32 s59, s69, 8192
  buffer_load_dwordx4 v[132:135], v255, s[8:11], s59 offen offset:0 sc1
  s_waitcnt lgkmcnt(4)
  v_mfma_f32_16x16x32_bf16 v[24:27], v[44:47], v[80:83], v[24:27]
  ds_read_b128 v[40:43], v247 offset:54272
  v_mfma_f32_16x16x32_bf16 v[28:31], v[44:47], v[84:87], v[28:31]
  s_waitcnt lgkmcnt(4)
  v_mfma_f32_16x16x32_bf16 v[32:35], v[48:51], v[80:83], v[32:35]
  ds_read_b128 v[44:47], v247 offset:55296
  v_mfma_f32_16x16x32_bf16 v[36:39], v[48:51], v[84:87], v[36:39]
  s_waitcnt vmcnt(12) lgkmcnt(4)
  v_mfma_f32_16x16x32_bf16 v[0:3], v[52:55], v[88:91], v[0:3]
  ds_read_b128 v[48:51], v247 offset:61440
  buffer_load_dwordx4 v[136:139], v255, s[8:11], s58 offen offset:1024 sc1
  s_waitcnt vmcnt(12)
  v_mfma_f32_16x16x32_bf16 v[4:7], v[52:55], v[92:95], v[4:7]
  s_waitcnt lgkmcnt(4)
  v_mfma_f32_16x16x32_bf16 v[8:11], v[56:59], v[88:91], v[8:11]
  ds_read_b128 v[52:55], v247 offset:62464
  v_mfma_f32_16x16x32_bf16 v[12:15], v[56:59], v[92:95], v[12:15]
  s_waitcnt lgkmcnt(4)
  v_mfma_f32_16x16x32_bf16 v[16:19], v[60:63], v[88:91], v[16:19]
  ds_read_b128 v[56:59], v247 offset:63488
  v_mfma_f32_16x16x32_bf16 v[20:23], v[60:63], v[92:95], v[20:23]
  buffer_load_dwordx4 v[140:143], v255, s[8:11], s59 offen offset:1024 sc1
  s_waitcnt lgkmcnt(4)
  v_mfma_f32_16x16x32_bf16 v[24:27], v[40:43], v[88:91], v[24:27]
  ds_read_b128 v[60:63], v247 offset:64512
  v_mfma_f32_16x16x32_bf16 v[28:31], v[40:43], v[92:95], v[28:31]
  s_waitcnt lgkmcnt(4)
  v_mfma_f32_16x16x32_bf16 v[32:35], v[44:47], v[88:91], v[32:35]
  ds_read_b128 v[40:43], v248 offset:0
  v_mfma_f32_16x16x32_bf16 v[36:39], v[44:47], v[92:95], v[36:39]
  s_waitcnt vmcnt(12) lgkmcnt(4)
  v_mfma_f32_16x16x32_bf16 v[0:3], v[48:51], v[96:99], v[0:3]
  ds_read_b128 v[44:47], v248 offset:6144
  buffer_load_dwordx4 v[144:147], v255, s[8:11], s58 offen offset:2048 sc1
  s_waitcnt vmcnt(12)
  v_mfma_f32_16x16x32_bf16 v[4:7], v[48:51], v[100:103], v[4:7]
  s_waitcnt lgkmcnt(4)
  v_mfma_f32_16x16x32_bf16 v[8:11], v[52:55], v[96:99], v[8:11]
  ds_read_b128 v[48:51], v248 offset:7168
  v_mfma_f32_16x16x32_bf16 v[12:15], v[52:55], v[100:103], v[12:15]
  s_waitcnt lgkmcnt(4)
  v_mfma_f32_16x16x32_bf16 v[16:19], v[56:59], v[96:99], v[16:19]
  ds_read_b128 v[52:55], v248 offset:8192
  v_mfma_f32_16x16x32_bf16 v[20:23], v[56:59], v[100:103], v[20:23]
  buffer_load_dwordx4 v[148:151], v255, s[8:11], s59 offen offset:2048 sc1
  s_waitcnt lgkmcnt(4)
  v_mfma_f32_16x16x32_bf16 v[24:27], v[60:63], v[96:99], v[24:27]
  ds_read_b128 v[56:59], v248 offset:9216
  v_mfma_f32_16x16x32_bf16 v[28:31], v[60:63], v[100:103], v[28:31]
  s_waitcnt lgkmcnt(4)
  v_mfma_f32_16x16x32_bf16 v[32:35], v[40:43], v[96:99], v[32:35]
  ds_read_b128 v[60:63], v248 offset:10240
  v_mfma_f32_16x16x32_bf16 v[36:39], v[40:43], v[100:103], v[36:39]
  s_waitcnt vmcnt(12) lgkmcnt(4)
  v_mfma_f32_16x16x32_bf16 v[0:3], v[44:47], v[104:107], v[0:3]
  ds_read_b128 v[40:43], v248 offset:16384
  buffer_load_dwordx4 v[152:155], v255, s[8:11], s58 offen offset:3072 sc1
  s_waitcnt vmcnt(12)
  v_mfma_f32_16x16x32_bf16 v[4:7], v[44:47], v[108:111], v[4:7]
  s_waitcnt lgkmcnt(4)
  v_mfma_f32_16x16x32_bf16 v[8:11], v[48:51], v[104:107], v[8:11]
  ds_read_b128 v[44:47], v248 offset:17408
  v_mfma_f32_16x16x32_bf16 v[12:15], v[48:51], v[108:111], v[12:15]
  s_waitcnt lgkmcnt(4)
  v_mfma_f32_16x16x32_bf16 v[16:19], v[52:55], v[104:107], v[16:19]
  ds_read_b128 v[48:51], v248 offset:18432
  v_mfma_f32_16x16x32_bf16 v[20:23], v[52:55], v[108:111], v[20:23]
  buffer_load_dwordx4 v[156:159], v255, s[8:11], s59 offen offset:3072 sc1
  s_waitcnt lgkmcnt(4)
  v_mfma_f32_16x16x32_bf16 v[24:27], v[56:59], v[104:107], v[24:27]
  ds_read_b128 v[52:55], v248 offset:19456
  v_mfma_f32_16x16x32_bf16 v[28:31], v[56:59], v[108:111], v[28:31]
  s_waitcnt lgkmcnt(4)
  v_mfma_f32_16x16x32_bf16 v[32:35], v[60:63], v[104:107], v[32:35]
  ds_read_b128 v[56:59], v248 offset:20480
  v_mfma_f32_16x16x32_bf16 v[36:39], v[60:63], v[108:111], v[36:39]
  s_waitcnt vmcnt(11) lgkmcnt(4)
  v_mfma_f32_16x16x32_bf16 v[0:3], v[40:43], v[112:115], v[0:3]
  s_barrier
  ds_read_b128 v[60:63], v246 offset:0
  s_add_u32 s58, s68, 12288
  buffer_load_dwordx4 v[160:163], v255, s[8:11], s58 offen offset:0 sc1
  s_waitcnt vmcnt(11)
  v_mfma_f32_16x16x32_bf16 v[4:7], v[40:43], v[116:119], v[4:7]
  s_waitcnt lgkmcnt(4)
  v_mfma_f32_16x16x32_bf16 v[8:11], v[44:47], v[112:115], v[8:11]
  ds_read_b128 v[40:43], v246 offset:1024
  v_mfma_f32_16x16x32_bf16 v[12:15], v[44:47], v[116:119], v[12:15]
  s_waitcnt lgkmcnt(4)
  v_mfma_f32_16x16x32_bf16 v[16:19], v[48:51], v[112:115], v[16:19]
  ds_read_b128 v[44:47], v246 offset:2048
  v_mfma_f32_16x16x32_bf16 v[20:23], v[48:51], v[116:119], v[20:23]
  s_add_u32 s59, s69, 12288
  buffer_load_dwordx4 v[164:167], v255, s[8:11], s59 offen offset:0 sc1
  s_waitcnt lgkmcnt(4)
  v_mfma_f32_16x16x32_bf16 v[24:27], v[52:55], v[112:115], v[24:27]
  ds_read_b128 v[48:51], v246 offset:3072
  v_mfma_f32_16x16x32_bf16 v[28:31], v[52:55], v[116:119], v[28:31]
  s_waitcnt lgkmcnt(4)
  v_mfma_f32_16x16x32_bf16 v[32:35], v[56:59], v[112:115], v[32:35]
  ds_read_b128 v[52:55], v246 offset:4096
  v_mfma_f32_16x16x32_bf16 v[36:39], v[56:59], v[116:119], v[36:39]
  s_waitcnt vmcnt(11) lgkmcnt(4)
  v_mfma_f32_16x16x32_bf16 v[0:3], v[60:63], v[120:123], v[0:3]
  ds_read_b128 v[56:59], v246 offset:10240
  buffer_load_dwordx4 v[168:171], v255, s[8:11], s58 offen offset:1024 sc1
  s_waitcnt vmcnt(11)
  v_mfma_f32_16x16x32_bf16 v[4:7], v[60:63], v[124:127], v[4:7]
  s_waitcnt lgkmcnt(4)
  v_mfma_f32_16x16x32_bf16 v[8:11], v[40:43], v[120:123], v[8:11]
  ds_read_b128 v[60:63], v246 offset:11264
  v_mfma_f32_16x16x32_bf16 v[12:15], v[40:43], v[124:127], v[12:15]
  s_waitcnt lgkmcnt(4)
  v_mfma_f32_16x16x32_bf16 v[16:19], v[44:47], v[120:123], v[16:19]
  ds_read_b128 v[40:43], v246 offset:12288
  v_mfma_f32_16x16x32_bf16 v[20:23], v[44:47], v[124:127], v[20:23]
  buffer_load_dwordx4 v[172:175], v255, s[8:11], s59 offen offset:1024 sc1
  s_waitcnt lgkmcnt(4)
  v_mfma_f32_16x16x32_bf16 v[24:27], v[48:51], v[120:123], v[24:27]
  ds_read_b128 v[44:47], v246 offset:13312
  v_mfma_f32_16x16x32_bf16 v[28:31], v[48:51], v[124:127], v[28:31]
  s_waitcnt lgkmcnt(4)
  v_mfma_f32_16x16x32_bf16 v[32:35], v[52:55], v[120:123], v[32:35]
  ds_read_b128 v[48:51], v246 offset:14336
  v_mfma_f32_16x16x32_bf16 v[36:39], v[52:55], v[124:127], v[36:39]
  s_waitcnt vmcnt(11) lgkmcnt(4)
  v_mfma_f32_16x16x32_bf16 v[0:3], v[56:59], v[128:131], v[0:3]
  ds_read_b128 v[52:55], v246 offset:20480
  buffer_load_dwordx4 v[176:179], v255, s[8:11], s58 offen offset:2048 sc1
  s_waitcnt vmcnt(11)
  v_mfma_f32_16x16x32_bf16 v[4:7], v[56:59], v[132:135], v[4:7]
  s_waitcnt lgkmcnt(4)
  v_mfma_f32_16x16x32_bf16 v[8:11], v[60:63], v[128:131], v[8:11]
  ds_read_b128 v[56:59], v246 offset:21504
  v_mfma_f32_16x16x32_bf16 v[12:15], v[60:63], v[132:135], v[12:15]
  s_waitcnt lgkmcnt(4)
  v_mfma_f32_16x16x32_bf16 v[16:19], v[40:43], v[128:131], v[16:19]
  ds_read_b128 v[60:63], v246 offset:22528
  v_mfma_f32_16x16x32_bf16 v[20:23], v[40:43], v[132:135], v[20:23]
  buffer_load_dwordx4 v[180:183], v255, s[8:11], s59 offen offset:2048 sc1
  s_waitcnt lgkmcnt(4)
  v_mfma_f32_16x16x32_bf16 v[24:27], v[44:47], v[128:131], v[24:27]
  ds_read_b128 v[40:43], v246 offset:23552
  v_mfma_f32_16x16x32_bf16 v[28:31], v[44:47], v[132:135], v[28:31]
  s_waitcnt lgkmcnt(4)
  v_mfma_f32_16x16x32_bf16 v[32:35], v[48:51], v[128:131], v[32:35]
  ds_read_b128 v[44:47], v246 offset:24576
  v_mfma_f32_16x16x32_bf16 v[36:39], v[48:51], v[132:135], v[36:39]
  s_waitcnt vmcnt(11) lgkmcnt(4)
  v_mfma_f32_16x16x32_bf16 v[0:3], v[52:55], v[136:139], v[0:3]
  ds_read_b128 v[48:51], v246 offset:30720
  buffer_load_dwordx4 v[184:187], v255, s[8:11], s58 offen offset:3072 sc1
  s_waitcnt vmcnt(11)
  v_mfma_f32_16x16x32_bf16 v[4:7], v[52:55], v[140:143], v[4:7]
  s_waitcnt lgkmcnt(4)
  v_mfma_f32_16x16x32_bf16 v[8:11], v[56:59], v[136:139], v[8:11]
  ds_read_b128 v[52:55], v246 offset:31744
  v_mfma_f32_16x16x32_bf16 v[12:15], v[56:59], v[140:143], v[12:15]
  s_waitcnt lgkmcnt(4)
  v_mfma_f32_16x16x32_bf16 v[16:19], v[60:63], v[136:139], v[16:19]
  ds_read_b128 v[56:59], v246 offset:32768
  v_mfma_f32_16x16x32_bf16 v[20:23], v[60:63], v[140:143], v[20:23]
  buffer_load_dwordx4 v[188:191], v255, s[8:11], s59 offen offset:3072 sc1
  s_waitcnt lgkmcnt(4)
  v_mfma_f32_16x16x32_bf16 v[24:27], v[40:43], v[136:139], v[24:27]
  ds_read_b128 v[60:63], v246 offset:33792
  v_mfma_f32_16x16x32_bf16 v[28:31], v[40:43], v[140:143], v[28:31]
  s_waitcnt lgkmcnt(4)
  v_mfma_f32_16x16x32_bf16 v[32:35], v[44:47], v[136:139], v[32:35]
  ds_read_b128 v[40:43], v246 offset:34816
  v_mfma_f32_16x16x32_bf16 v[36:39], v[44:47], v[140:143], v[36:39]
  s_waitcnt vmcnt(11) lgkmcnt(4)
  v_mfma_f32_16x16x32_bf16 v[0:3], v[48:51], v[144:147], v[0:3]
  ds_read_b128 v[44:47], v246 offset:40960
  s_add_u32 s58, s68, 16384
  buffer_load_dwordx4 v[192:195], v255, s[8:11], s58 offen offset:0 sc1
  s_waitcnt vmcnt(11)
  v_mfma_f32_16x16x32_bf16 v[4:7], v[48:51], v[148:151], v[4:7]
  s_waitcnt lgkmcnt(4)
  v_mfma_f32_16x16x32_bf16 v[8:11], v[52:55], v[144:147], v[8:11]
  ds_read_b128 v[48:51], v246 offset:41984
  v_mfma_f32_16x16x32_bf16 v[12:15], v[52:55], v[148:151], v[12:15]
  s_waitcnt lgkmcnt(4)
  v_mfma_f32_16x16x32_bf16 v[16:19], v[56:59], v[144:147], v[16:19]
  ds_read_b128 v[52:55], v246 offset:43008
  v_mfma_f32_16x16x32_bf16 v[20:23], v[56:59], v[148:151], v[20:23]
  s_add_u32 s59, s69, 16384
  buffer_load_dwordx4 v[196:199], v255, s[8:11], s59 offen offset:0 sc1
  s_waitcnt lgkmcnt(4)
  v_mfma_f32_16x16x32_bf16 v[24:27], v[60:63], v[144:147], v[24:27]
  ds_read_b128 v[56:59], v246 offset:44032
  v_mfma_f32_16x16x32_bf16 v[28:31], v[60:63], v[148:151], v[28:31]
  s_waitcnt lgkmcnt(4)
  v_mfma_f32_16x16x32_bf16 v[32:35], v[40:43], v[144:147], v[32:35]
  ds_read_b128 v[60:63], v246 offset:45056
  v_mfma_f32_16x16x32_bf16 v[36:39], v[40:43], v[148:151], v[36:39]
  s_waitcnt vmcnt(11) lgkmcnt(4)
  v_mfma_f32_16x16x32_bf16 v[0:3], v[44:47], v[152:155], v[0:3]
  ds_read_b128 v[40:43], v246 offset:51200
  buffer_load_dwordx4 v[200:203], v255, s[8:11], s58 offen offset:1024 sc1
  s_waitcnt vmcnt(11)
  v_mfma_f32_16x16x32_bf16 v[4:7], v[44:47], v[156:159], v[4:7]
  s_waitcnt lgkmcnt(4)
  v_mfma_f32_16x16x32_bf16 v[8:11], v[48:51], v[152:155], v[8:11]
  ds_read_b128 v[44:47], v246 offset:52224
  v_mfma_f32_16x16x32_bf16 v[12:15], v[48:51], v[156:159], v[12:15]
  s_waitcnt lgkmcnt(4)
  v_mfma_f32_16x16x32_bf16 v[16:19], v[52:55], v[152:155], v[16:19]
  ds_read_b128 v[48:51], v246 offset:53248
  v_mfma_f32_16x16x32_bf16 v[20:23], v[52:55], v[156:159], v[20:23]
  buffer_load_dwordx4 v[204:207], v255, s[8:11], s59 offen offset:1024 sc1
  s_waitcnt lgkmcnt(4)
  v_mfma_f32_16x16x32_bf16 v[24:27], v[56:59], v[152:155], v[24:27]
  ds_read_b128 v[52:55], v246 offset:54272
  v_mfma_f32_16x16x32_bf16 v[28:31], v[56:59], v[156:159], v[28:31]
  s_waitcnt lgkmcnt(4)
  v_mfma_f32_16x16x32_bf16 v[32:35], v[60:63], v[152:155], v[32:35]
  ds_read_b128 v[56:59], v246 offset:55296
  v_mfma_f32_16x16x32_bf16 v[36:39], v[60:63], v[156:159], v[36:39]
  s_waitcnt vmcnt(11) lgkmcnt(4)
  v_mfma_f32_16x16x32_bf16 v[0:3], v[40:43], v[160:163], v[0:3]
  s_barrier
  ds_read_b128 v[60:63], v246 offset:61440
  buffer_load_dwordx4 v[208:211], v255, s[8:11], s58 offen offset:2048 sc1
  s_waitcnt vmcnt(11)
  v_mfma_f32_16x16x32_bf16 v[4:7], v[40:43], v[164:167], v[4:7]
  s_waitcnt lgkmcnt(4)
  v_mfma_f32_16x16x32_bf16 v[8:11], v[44:47], v[160:163], v[8:11]
  ds_read_b128 v[40:43], v246 offset:62464
  v_mfma_f32_16x16x32_bf16 v[12:15], v[44:47], v[164:167], v[12:15]
  s_waitcnt lgkmcnt(4)
  v_mfma_f32_16x16x32_bf16 v[16:19], v[48:51], v[160:163], v[16:19]
  ds_read_b128 v[44:47], v246 offset:63488
  v_mfma_f32_16x16x32_bf16 v[20:23], v[48:51], v[164:167], v[20:23]
  buffer_load_dwordx4 v[212:215], v255, s[8:11], s59 offen offset:2048 sc1
  s_waitcnt lgkmcnt(4)
  v_mfma_f32_16x16x32_bf16 v[24:27], v[52:55], v[160:163], v[24:27]
  ds_read_b128 v[48:51], v246 offset:64512
  v_mfma_f32_16x16x32_bf16 v[28:31], v[52:55], v[164:167], v[28:31]
  s_waitcnt lgkmcnt(4)
  v_mfma_f32_16x16x32_bf16 v[32:35], v[56:59], v[160:163], v[32:35]
  ds_read_b128 v[52:55], v247 offset:0
  v_mfma_f32_16x16x32_bf16 v[36:39], v[56:59], v[164:167], v[36:39]
  s_waitcnt vmcnt(11) lgkmcnt(4)
  v_mfma_f32_16x16x32_bf16 v[0:3], v[60:63], v[168:171], v[0:3]
  ds_read_b128 v[56:59], v247 offset:6144
  buffer_load_dwordx4 v[64:67], v255, s[8:11], s58 offen offset:3072 sc1
  s_waitcnt vmcnt(11)
  v_mfma_f32_16x16x32_bf16 v[4:7], v[60:63], v[172:175], v[4:7]
  s_waitcnt lgkmcnt(4)
  v_mfma_f32_16x16x32_bf16 v[8:11], v[40:43], v[168:171], v[8:11]
  ds_read_b128 v[60:63], v247 offset:7168
  v_mfma_f32_16x16x32_bf16 v[12:15], v[40:43], v[172:175], v[12:15]
  s_waitcnt lgkmcnt(4)
  v_mfma_f32_16x16x32_bf16 v[16:19], v[44:47], v[168:171], v[16:19]
  ds_read_b128 v[40:43], v247 offset:8192
  v_mfma_f32_16x16x32_bf16 v[20:23], v[44:47], v[172:175], v[20:23]
  buffer_load_dwordx4 v[68:71], v255, s[8:11], s59 offen offset:3072 sc1
  s_waitcnt lgkmcnt(4)
  v_mfma_f32_16x16x32_bf16 v[24:27], v[48:51], v[168:171], v[24:27]
  ds_read_b128 v[44:47], v247 offset:9216
  v_mfma_f32_16x16x32_bf16 v[28:31], v[48:51], v[172:175], v[28:31]
  s_waitcnt lgkmcnt(4)
  v_mfma_f32_16x16x32_bf16 v[32:35], v[52:55], v[168:171], v[32:35]
  ds_read_b128 v[48:51], v247 offset:10240
  v_mfma_f32_16x16x32_bf16 v[36:39], v[52:55], v[172:175], v[36:39]
  s_waitcnt vmcnt(11) lgkmcnt(4)
  v_mfma_f32_16x16x32_bf16 v[0:3], v[56:59], v[176:179], v[0:3]
  ds_read_b128 v[52:55], v247 offset:20480
  s_add_u32 s58, s68, 20480
  buffer_load_dwordx4 v[72:75], v255, s[8:11], s58 offen offset:0 sc1
  s_waitcnt vmcnt(11)
  v_mfma_f32_16x16x32_bf16 v[4:7], v[56:59], v[180:183], v[4:7]
  s_waitcnt lgkmcnt(4)
  v_mfma_f32_16x16x32_bf16 v[8:11], v[60:63], v[176:179], v[8:11]
  ds_read_b128 v[56:59], v247 offset:21504
  v_mfma_f32_16x16x32_bf16 v[12:15], v[60:63], v[180:183], v[12:15]
  s_waitcnt lgkmcnt(4)
  v_mfma_f32_16x16x32_bf16 v[16:19], v[40:43], v[176:179], v[16:19]
  ds_read_b128 v[60:63], v247 offset:22528
  v_mfma_f32_16x16x32_bf16 v[20:23], v[40:43], v[180:183], v[20:23]
  s_add_u32 s59, s69, 20480
  buffer_load_dwordx4 v[76:79], v255, s[8:11], s59 offen offset:0 sc1
  s_waitcnt lgkmcnt(4)
  v_mfma_f32_16x16x32_bf16 v[24:27], v[44:47], v[176:179], v[24:27]
  ds_read_b128 v[40:43], v247 offset:23552
  v_mfma_f32_16x16x32_bf16 v[28:31], v[44:47], v[180:183], v[28:31]
  s_waitcnt lgkmcnt(4)
  v_mfma_f32_16x16x32_bf16 v[32:35], v[48:51], v[176:179], v[32:35]
  ds_read_b128 v[44:47], v247 offset:24576
  v_mfma_f32_16x16x32_bf16 v[36:39], v[48:51], v[180:183], v[36:39]
  s_waitcnt vmcnt(11) lgkmcnt(4)
  v_mfma_f32_16x16x32_bf16 v[0:3], v[52:55], v[184:187], v[0:3]
  ds_read_b128 v[48:51], v247 offset:30720
  buffer_load_dwordx4 v[80:83], v255, s[8:11], s58 offen offset:1024 sc1
  s_waitcnt vmcnt(11)
  v_mfma_f32_16x16x32_bf16 v[4:7], v[52:55], v[188:191], v[4:7]
  s_waitcnt lgkmcnt(4)
  v_mfma_f32_16x16x32_bf16 v[8:11], v[56:59], v[184:187], v[8:11]
  ds_read_b128 v[52:55], v247 offset:31744
  v_mfma_f32_16x16x32_bf16 v[12:15], v[56:59], v[188:191], v[12:15]
  s_waitcnt lgkmcnt(4)
  v_mfma_f32_16x16x32_bf16 v[16:19], v[60:63], v[184:187], v[16:19]
  ds_read_b128 v[56:59], v247 offset:32768
  v_mfma_f32_16x16x32_bf16 v[20:23], v[60:63], v[188:191], v[20:23]
  buffer_load_dwordx4 v[84:87], v255, s[8:11], s59 offen offset:1024 sc1
  s_waitcnt lgkmcnt(4)
  v_mfma_f32_16x16x32_bf16 v[24:27], v[40:43], v[184:187], v[24:27]
  ds_read_b128 v[60:63], v247 offset:33792
  v_mfma_f32_16x16x32_bf16 v[28:31], v[40:43], v[188:191], v[28:31]
  s_waitcnt lgkmcnt(4)
  v_mfma_f32_16x16x32_bf16 v[32:35], v[44:47], v[184:187], v[32:35]
  ds_read_b128 v[40:43], v247 offset:34816
  v_mfma_f32_16x16x32_bf16 v[36:39], v[44:47], v[188:191], v[36:39]
  s_waitcnt vmcnt(11) lgkmcnt(4)
  v_mfma_f32_16x16x32_bf16 v[0:3], v[48:51], v[192:195], v[0:3]
  ds_read_b128 v[44:47], v247 offset:40960
  buffer_load_dwordx4 v[88:91], v255, s[8:11], s58 offen offset:2048 sc1
  s_waitcnt vmcnt(11)
  v_mfma_f32_16x16x32_bf16 v[4:7], v[48:51], v[196:199], v[4:7]
  s_waitcnt lgkmcnt(4)
  v_mfma_f32_16x16x32_bf16 v[8:11], v[52:55], v[192:195], v[8:11]
  ds_read_b128 v[48:51], v247 offset:41984
  v_mfma_f32_16x16x32_bf16 v[12:15], v[52:55], v[196:199], v[12:15]
  s_waitcnt lgkmcnt(4)
  v_mfma_f32_16x16x32_bf16 v[16:19], v[56:59], v[192:195], v[16:19]
  ds_read_b128 v[52:55], v247 offset:43008
  v_mfma_f32_16x16x32_bf16 v[20:23], v[56:59], v[196:199], v[20:23]
  buffer_load_dwordx4 v[92:95], v255, s[8:11], s59 offen offset:2048 sc1
  s_waitcnt lgkmcnt(4)
  v_mfma_f32_16x16x32_bf16 v[24:27], v[60:63], v[192:195], v[24:27]
  ds_read_b128 v[56:59], v247 offset:44032
  v_mfma_f32_16x16x32_bf16 v[28:31], v[60:63], v[196:199], v[28:31]
  s_waitcnt lgkmcnt(4)
  v_mfma_f32_16x16x32_bf16 v[32:35], v[40:43], v[192:195], v[32:35]
  ds_read_b128 v[60:63], v247 offset:45056
  v_mfma_f32_16x16x32_bf16 v[36:39], v[40:43], v[196:199], v[36:39]
  s_waitcnt vmcnt(11) lgkmcnt(4)
  v_mfma_f32_16x16x32_bf16 v[0:3], v[44:47], v[200:203], v[0:3]
  ds_read_b128 v[40:43], v247 offset:51200
  buffer_load_dwordx4 v[96:99], v255, s[8:11], s58 offen offset:3072 sc1
  s_waitcnt vmcnt(11)
  v_mfma_f32_16x16x32_bf16 v[4:7], v[44:47], v[204:207], v[4:7]
  s_waitcnt lgkmcnt(4)
  v_mfma_f32_16x16x32_bf16 v[8:11], v[48:51], v[200:203], v[8:11]
  ds_read_b128 v[44:47], v247 offset:52224
  v_mfma_f32_16x16x32_bf16 v[12:15], v[48:51], v[204:207], v[12:15]
  s_waitcnt lgkmcnt(4)
  v_mfma_f32_16x16x32_bf16 v[16:19], v[52:55], v[200:203], v[16:19]
  ds_read_b128 v[48:51], v247 offset:53248
  v_mfma_f32_16x16x32_bf16 v[20:23], v[52:55], v[204:207], v[20:23]
  buffer_load_dwordx4 v[100:103], v255, s[8:11], s59 offen offset:3072 sc1
  s_waitcnt lgkmcnt(4)
  v_mfma_f32_16x16x32_bf16 v[24:27], v[56:59], v[200:203], v[24:27]
  ds_read_b128 v[52:55], v247 offset:54272
  v_mfma_f32_16x16x32_bf16 v[28:31], v[56:59], v[204:207], v[28:31]
  s_waitcnt lgkmcnt(4)
  v_mfma_f32_16x16x32_bf16 v[32:35], v[60:63], v[200:203], v[32:35]
  ds_read_b128 v[56:59], v247 offset:55296
  v_mfma_f32_16x16x32_bf16 v[36:39], v[60:63], v[204:207], v[36:39]
  s_waitcnt vmcnt(11) lgkmcnt(4)
  v_mfma_f32_16x16x32_bf16 v[0:3], v[40:43], v[208:211], v[0:3]
  s_barrier
  ds_read_b128 v[60:63], v247 offset:61440
  s_add_u32 s58, s68, 24576
  buffer_load_dwordx4 v[104:107], v255, s[8:11], s58 offen offset:0 sc1
  s_waitcnt vmcnt(11)
  v_mfma_f32_16x16x32_bf16 v[4:7], v[40:43], v[212:215], v[4:7]
  s_waitcnt lgkmcnt(4)
  v_mfma_f32_16x16x32_bf16 v[8:11], v[44:47], v[208:211], v[8:11]
  ds_read_b128 v[40:43], v247 offset:62464
  v_mfma_f32_16x16x32_bf16 v[12:15], v[44:47], v[212:215], v[12:15]
  s_waitcnt lgkmcnt(4)
  v_mfma_f32_16x16x32_bf16 v[16:19], v[48:51], v[208:211], v[16:19]
  ds_read_b128 v[44:47], v247 offset:63488
  v_mfma_f32_16x16x32_bf16 v[20:23], v[48:51], v[212:215], v[20:23]
  s_add_u32 s59, s69, 24576
  buffer_load_dwordx4 v[108:111], v255, s[8:11], s59 offen offset:0 sc1
  s_waitcnt lgkmcnt(4)
  v_mfma_f32_16x16x32_bf16 v[24:27], v[52:55], v[208:211], v[24:27]
  ds_read_b128 v[48:51], v247 offset:64512
  v_mfma_f32_16x16x32_bf16 v[28:31], v[52:55], v[212:215], v[28:31]
  s_waitcnt lgkmcnt(4)
  v_mfma_f32_16x16x32_bf16 v[32:35], v[56:59], v[208:211], v[32:35]
  ds_read_b128 v[52:55], v248 offset:0
  v_mfma_f32_16x16x32_bf16 v[36:39], v[56:59], v[212:215], v[36:39]
  s_waitcnt vmcnt(11) lgkmcnt(4)
  v_mfma_f32_16x16x32_bf16 v[0:3], v[60:63], v[64:67], v[0:3]
  ds_read_b128 v[56:59], v248 offset:6144
  buffer_load_dwordx4 v[112:115], v255, s[8:11], s58 offen offset:1024 sc1
  s_waitcnt vmcnt(11)
  v_mfma_f32_16x16x32_bf16 v[4:7], v[60:63], v[68:71], v[4:7]
  s_waitcnt lgkmcnt(4)
  v_mfma_f32_16x16x32_bf16 v[8:11], v[40:43], v[64:67], v[8:11]
  ds_read_b128 v[60:63], v248 offset:7168
  v_mfma_f32_16x16x32_bf16 v[12:15], v[40:43], v[68:71], v[12:15]
  s_waitcnt lgkmcnt(4)
  v_mfma_f32_16x16x32_bf16 v[16:19], v[44:47], v[64:67], v[16:19]
  ds_read_b128 v[40:43], v248 offset:8192
  v_mfma_f32_16x16x32_bf16 v[20:23], v[44:47], v[68:71], v[20:23]
  buffer_load_dwordx4 v[116:119], v255, s[8:11], s59 offen offset:1024 sc1
  s_waitcnt lgkmcnt(4)
  v_mfma_f32_16x16x32_bf16 v[24:27], v[48:51], v[64:67], v[24:27]
  ds_read_b128 v[44:47], v248 offset:9216
  v_mfma_f32_16x16x32_bf16 v[28:31], v[48:51], v[68:71], v[28:31]
  s_waitcnt lgkmcnt(4)
  v_mfma_f32_16x16x32_bf16 v[32:35], v[52:55], v[64:67], v[32:35]
  ds_read_b128 v[48:51], v248 offset:10240
  v_mfma_f32_16x16x32_bf16 v[36:39], v[52:55], v[68:71], v[36:39]
  s_waitcnt vmcnt(11) lgkmcnt(4)
  v_mfma_f32_16x16x32_bf16 v[0:3], v[56:59], v[72:75], v[0:3]
  ds_read_b128 v[52:55], v248 offset:16384
  buffer_load_dwordx4 v[120:123], v255, s[8:11], s58 offen offset:2048 sc1
  s_waitcnt vmcnt(11)
  v_mfma_f32_16x16x32_bf16 v[4:7], v[56:59], v[76:79], v[4:7]
  s_waitcnt lgkmcnt(4)
  v_mfma_f32_16x16x32_bf16 v[8:11], v[60:63], v[72:75], v[8:11]
  ds_read_b128 v[56:59], v248 offset:17408
  v_mfma_f32_16x16x32_bf16 v[12:15], v[60:63], v[76:79], v[12:15]
  s_waitcnt lgkmcnt(4)
  v_mfma_f32_16x16x32_bf16 v[16:19], v[40:43], v[72:75], v[16:19]
  ds_read_b128 v[60:63], v248 offset:18432
  v_mfma_f32_16x16x32_bf16 v[20:23], v[40:43], v[76:79], v[20:23]
  buffer_load_dwordx4 v[124:127], v255, s[8:11], s59 offen offset:2048 sc1
  s_waitcnt lgkmcnt(4)
  v_mfma_f32_16x16x32_bf16 v[24:27], v[44:47], v[72:75], v[24:27]
  ds_read_b128 v[40:43], v248 offset:19456
  v_mfma_f32_16x16x32_bf16 v[28:31], v[44:47], v[76:79], v[28:31]
  s_waitcnt lgkmcnt(4)
  v_mfma_f32_16x16x32_bf16 v[32:35], v[48:51], v[72:75], v[32:35]
  ds_read_b128 v[44:47], v248 offset:20480
  v_mfma_f32_16x16x32_bf16 v[36:39], v[48:51], v[76:79], v[36:39]
  s_waitcnt vmcnt(11) lgkmcnt(4)
  v_mfma_f32_16x16x32_bf16 v[0:3], v[52:55], v[80:83], v[0:3]
  ds_read_b128 v[48:51], v246 offset:0
  s_waitcnt vmcnt(10)
  v_mfma_f32_16x16x32_bf16 v[4:7], v[52:55], v[84:87], v[4:7]
  s_waitcnt lgkmcnt(4)
  v_mfma_f32_16x16x32_bf16 v[8:11], v[56:59], v[80:83], v[8:11]
  ds_read_b128 v[52:55], v246 offset:1024
  v_mfma_f32_16x16x32_bf16 v[12:15], v[56:59], v[84:87], v[12:15]
  s_waitcnt lgkmcnt(4)
  v_mfma_f32_16x16x32_bf16 v[16:19], v[60:63], v[80:83], v[16:19]
  ds_read_b128 v[56:59], v246 offset:2048
  v_mfma_f32_16x16x32_bf16 v[20:23], v[60:63], v[84:87], v[20:23]
  s_waitcnt lgkmcnt(4)
  v_mfma_f32_16x16x32_bf16 v[24:27], v[40:43], v[80:83], v[24:27]
  ds_read_b128 v[60:63], v246 offset:3072
  v_mfma_f32_16x16x32_bf16 v[28:31], v[40:43], v[84:87], v[28:31]
  s_waitcnt lgkmcnt(4)
  v_mfma_f32_16x16x32_bf16 v[32:35], v[44:47], v[80:83], v[32:35]
  ds_read_b128 v[40:43], v246 offset:4096
  v_mfma_f32_16x16x32_bf16 v[36:39], v[44:47], v[84:87], v[36:39]
  s_waitcnt vmcnt(9) lgkmcnt(4)
  v_mfma_f32_16x16x32_bf16 v[0:3], v[48:51], v[88:91], v[0:3]
  ds_read_b128 v[44:47], v246 offset:10240
  s_waitcnt vmcnt(8)
  v_mfma_f32_16x16x32_bf16 v[4:7], v[48:51], v[92:95], v[4:7]
  s_waitcnt lgkmcnt(4)
  v_mfma_f32_16x16x32_bf16 v[8:11], v[52:55], v[88:91], v[8:11]
  ds_read_b128 v[48:51], v246 offset:11264
  v_mfma_f32_16x16x32_bf16 v[12:15], v[52:55], v[92:95], v[12:15]
  s_waitcnt lgkmcnt(4)
  v_mfma_f32_16x16x32_bf16 v[16:19], v[56:59], v[88:91], v[16:19]
  ds_read_b128 v[52:55], v246 offset:12288
  v_mfma_f32_16x16x32_bf16 v[20:23], v[56:59], v[92:95], v[20:23]
  s_waitcnt lgkmcnt(4)
  v_mfma_f32_16x16x32_bf16 v[24:27], v[60:63], v[88:91], v[24:27]
  ds_read_b128 v[56:59], v246 offset:13312
  v_mfma_f32_16x16x32_bf16 v[28:31], v[60:63], v[92:95], v[28:31]
  s_waitcnt lgkmcnt(4)
  v_mfma_f32_16x16x32_bf16 v[32:35], v[40:43], v[88:91], v[32:35]
  ds_read_b128 v[60:63], v246 offset:14336
  v_mfma_f32_16x16x32_bf16 v[36:39], v[40:43], v[92:95], v[36:39]
  s_waitcnt vmcnt(7) lgkmcnt(4)
  v_mfma_f32_16x16x32_bf16 v[0:3], v[44:47], v[96:99], v[0:3]
  ds_read_b128 v[40:43], v246 offset:20480
  s_waitcnt vmcnt(6)
  v_mfma_f32_16x16x32_bf16 v[4:7], v[44:47], v[100:103], v[4:7]
  s_waitcnt lgkmcnt(4)
  v_mfma_f32_16x16x32_bf16 v[8:11], v[48:51], v[96:99], v[8:11]
  ds_read_b128 v[44:47], v246 offset:21504
  v_mfma_f32_16x16x32_bf16 v[12:15], v[48:51], v[100:103], v[12:15]
  s_waitcnt lgkmcnt(4)
  v_mfma_f32_16x16x32_bf16 v[16:19], v[52:55], v[96:99], v[16:19]
  ds_read_b128 v[48:51], v246 offset:22528
  v_mfma_f32_16x16x32_bf16 v[20:23], v[52:55], v[100:103], v[20:23]
  s_waitcnt lgkmcnt(4)
  v_mfma_f32_16x16x32_bf16 v[24:27], v[56:59], v[96:99], v[24:27]
  ds_read_b128 v[52:55], v246 offset:23552
  v_mfma_f32_16x16x32_bf16 v[28:31], v[56:59], v[100:103], v[28:31]
  s_waitcnt lgkmcnt(4)
  v_mfma_f32_16x16x32_bf16 v[32:35], v[60:63], v[96:99], v[32:35]
  ds_read_b128 v[56:59], v246 offset:24576
  v_mfma_f32_16x16x32_bf16 v[36:39], v[60:63], v[100:103], v[36:39]
  s_waitcnt vmcnt(5) lgkmcnt(4)
  v_mfma_f32_16x16x32_bf16 v[0:3], v[40:43], v[104:107], v[0:3]
  ds_read_b128 v[60:63], v246 offset:30720
  s_waitcnt vmcnt(4)
  v_mfma_f32_16x16x32_bf16 v[4:7], v[40:43], v[108:111], v[4:7]
  s_waitcnt lgkmcnt(4)
  v_mfma_f32_16x16x32_bf16 v[8:11], v[44:47], v[104:107], v[8:11]
  ds_read_b128 v[40:43], v246 offset:31744
  v_mfma_f32_16x16x32_bf16 v[12:15], v[44:47], v[108:111], v[12:15]
  s_waitcnt lgkmcnt(4)
  v_mfma_f32_16x16x32_bf16 v[16:19], v[48:51], v[104:107], v[16:19]
  ds_read_b128 v[44:47], v246 offset:32768
  v_mfma_f32_16x16x32_bf16 v[20:23], v[48:51], v[108:111], v[20:23]
  s_waitcnt lgkmcnt(4)
  v_mfma_f32_16x16x32_bf16 v[24:27], v[52:55], v[104:107], v[24:27]
  ds_read_b128 v[48:51], v246 offset:33792
  v_mfma_f32_16x16x32_bf16 v[28:31], v[52:55], v[108:111], v[28:31]
  s_waitcnt lgkmcnt(4)
  v_mfma_f32_16x16x32_bf16 v[32:35], v[56:59], v[104:107], v[32:35]
  ds_read_b128 v[52:55], v246 offset:34816
  v_mfma_f32_16x16x32_bf16 v[36:39], v[56:59], v[108:111], v[36:39]
  s_waitcnt vmcnt(3) lgkmcnt(4)
  v_mfma_f32_16x16x32_bf16 v[0:3], v[60:63], v[112:115], v[0:3]
  ds_read_b128 v[56:59], v246 offset:40960
  s_waitcnt vmcnt(2)
  v_mfma_f32_16x16x32_bf16 v[4:7], v[60:63], v[116:119], v[4:7]
  s_waitcnt lgkmcnt(4)
  v_mfma_f32_16x16x32_bf16 v[8:11], v[40:43], v[112:115], v[8:11]
  ds_read_b128 v[60:63], v246 offset:41984
  v_mfma_f32_16x16x32_bf16 v[12:15], v[40:43], v[116:119], v[12:15]
  s_waitcnt lgkmcnt(4)
  v_mfma_f32_16x16x32_bf16 v[16:19], v[44:47], v[112:115], v[16:19]
  ds_read_b128 v[40:43], v246 offset:43008
  v_mfma_f32_16x16x32_bf16 v[20:23], v[44:47], v[116:119], v[20:23]
  s_waitcnt lgkmcnt(4)
  v_mfma_f32_16x16x32_bf16 v[24:27], v[48:51], v[112:115], v[24:27]
  ds_read_b128 v[44:47], v246 offset:44032
  v_mfma_f32_16x16x32_bf16 v[28:31], v[48:51], v[116:119], v[28:31]
  s_waitcnt lgkmcnt(4)
  v_mfma_f32_16x16x32_bf16 v[32:35], v[52:55], v[112:115], v[32:35]
  ds_read_b128 v[48:51], v246 offset:45056
  v_mfma_f32_16x16x32_bf16 v[36:39], v[52:55], v[116:119], v[36:39]
  s_waitcnt vmcnt(1) lgkmcnt(4)
  v_mfma_f32_16x16x32_bf16 v[0:3], v[56:59], v[120:123], v[0:3]
  s_waitcnt vmcnt(0)
  v_mfma_f32_16x16x32_bf16 v[4:7], v[56:59], v[124:127], v[4:7]
  s_waitcnt lgkmcnt(3)
  v_mfma_f32_16x16x32_bf16 v[8:11], v[60:63], v[120:123], v[8:11]
  v_mfma_f32_16x16x32_bf16 v[12:15], v[60:63], v[124:127], v[12:15]
  s_waitcnt lgkmcnt(2)
  v_mfma_f32_16x16x32_bf16 v[16:19], v[40:43], v[120:123], v[16:19]
  v_mfma_f32_16x16x32_bf16 v[20:23], v[40:43], v[124:127], v[20:23]
  s_waitcnt lgkmcnt(1)
  v_mfma_f32_16x16x32_bf16 v[24:27], v[44:47], v[120:123], v[24:27]
  v_mfma_f32_16x16x32_bf16 v[28:31], v[44:47], v[124:127], v[28:31]
  s_waitcnt lgkmcnt(0)
  v_mfma_f32_16x16x32_bf16 v[32:35], v[48:51], v[120:123], v[32:35]
  v_mfma_f32_16x16x32_bf16 v[36:39], v[48:51], v[124:127], v[36:39]
  s_barrier
  s_cmp_eq_u32 s93, 1
  s_cbranch_scc1 RK_160
  s_nop 5
  ds_write_b128 v249, v[4:7] offset:0
  ds_write_b128 v249, v[12:15] offset:1024
  ds_write_b128 v249, v[20:23] offset:2048
  ds_write_b128 v249, v[28:31] offset:3072
  ds_write_b128 v249, v[36:39] offset:4096
  s_branch RD_161
RK_160:
  s_nop 5
  ds_write_b128 v249, v[0:3] offset:0
  ds_write_b128 v249, v[8:11] offset:1024
  ds_write_b128 v249, v[16:19] offset:2048
  ds_write_b128 v249, v[24:27] offset:3072
  ds_write_b128 v249, v[32:35] offset:4096
  s_waitcnt lgkmcnt(0)
  v_mov_b32 v0, v4
  v_mov_b32 v1, v5
  v_mov_b32 v2, v6
  v_mov_b32 v3, v7
  v_mov_b32 v8, v12
  v_mov_b32 v9, v13
  v_mov_b32 v10, v14
  v_mov_b32 v11, v15
  v_mov_b32 v16, v20
  v_mov_b32 v17, v21
  v_mov_b32 v18, v22
  v_mov_b32 v19, v23
  v_mov_b32 v24, v28
  v_mov_b32 v25, v29
  v_mov_b32 v26, v30
  v_mov_b32 v27, v31
  v_mov_b32 v32, v36
  v_mov_b32 v33, v37
  v_mov_b32 v34, v38
  v_mov_b32 v35, v39
RD_161:
  s_waitcnt lgkmcnt(0)
  s_barrier
  ds_read_b128 v[40:43], v250 offset:0
  ds_read_b128 v[44:47], v250 offset:1024
  ds_read_b128 v[48:51], v250 offset:2048
  ds_read_b128 v[52:55], v250 offset:3072
  ds_read_b128 v[56:59], v250 offset:4096
  v_pk_fma_f32 v[0:1], v[0:1], v[244:245], v[224:225]
  v_pk_fma_f32 v[2:3], v[2:3], v[244:245], v[226:227]
  v_pk_fma_f32 v[8:9], v[8:9], v[244:245], v[228:229]
  v_pk_fma_f32 v[10:11], v[10:11], v[244:245], v[230:231]
  v_pk_fma_f32 v[16:17], v[16:17], v[244:245], v[232:233]
  v_pk_fma_f32 v[18:19], v[18:19], v[244:245], v[234:235]
  v_pk_fma_f32 v[24:25], v[24:25], v[244:245], v[236:237]
  v_pk_fma_f32 v[26:27], v[26:27], v[244:245], v[238:239]
  v_pk_fma_f32 v[32:33], v[32:33], v[244:245], v[240:241]
  v_pk_fma_f32 v[34:35], v[34:35], v[244:245], v[242:243]
  s_waitcnt lgkmcnt(4)
  v_pk_fma_f32 v[0:1], v[40:41], v[244:245], v[0:1]
  v_pk_fma_f32 v[2:3], v[42:43], v[244:245], v[2:3]
  s_waitcnt lgkmcnt(3)
  v_pk_fma_f32 v[8:9], v[44:45], v[244:245], v[8:9]
  v_pk_fma_f32 v[10:11], v[46:47], v[244:245], v[10:11]
  s_waitcnt lgkmcnt(2)
  v_pk_fma_f32 v[16:17], v[48:49], v[244:245], v[16:17]
  v_pk_fma_f32 v[18:19], v[50:51], v[244:245], v[18:19]
  s_waitcnt lgkmcnt(1)
  v_pk_fma_f32 v[24:25], v[52:53], v[244:245], v[24:25]
  v_pk_fma_f32 v[26:27], v[54:55], v[244:245], v[26:27]
  s_waitcnt lgkmcnt(0)
  v_pk_fma_f32 v[32:33], v[56:57], v[244:245], v[32:33]
  v_pk_fma_f32 v[34:35], v[58:59], v[244:245], v[34:35]
  v_cvt_pk_bf16_f32 v70, v0, v1
  v_cvt_pk_bf16_f32 v71, v2, v3
  v_cvt_pk_bf16_f32 v72, v8, v9
  v_cvt_pk_bf16_f32 v73, v10, v11
  v_cvt_pk_bf16_f32 v74, v16, v17
  v_cvt_pk_bf16_f32 v75, v18, v19
  v_cvt_pk_bf16_f32 v76, v24, v25
  v_cvt_pk_bf16_f32 v77, v26, v27
  v_cvt_pk_bf16_f32 v78, v32, v33
  v_cvt_pk_bf16_f32 v79, v34, v35
  s_mul_i32 s89, s95, 20480
  s_add_u32 s89, s89, s50
  s_lshl_b32 s90, s95, 10
  s_lshl_b32 s91, s96, 7
  s_add_u32 s90, s90, s91
  s_add_u32 s90, s90, s51
  s_cmp_eq_u32 s42, 1
  s_cbranch_scc1 FO_162
  s_bitcmp1_b32 s96, 0
  s_cbranch_scc1 XO_164
  s_nop 3
  s_cmp_lg_u32 s6, 0
  s_cbranch_scc1 HS_166
  s_add_u32 s91, s63, s89
  buffer_store_dwordx4 v[70:73], v255, s[8:11], s91 offen
  s_add_u32 s91, s65, s89
  buffer_store_dwordx4 v[74:77], v255, s[8:11], s91 offen
  s_add_u32 s91, s67, s89
  buffer_store_dwordx2 v[78:79], v255, s[8:11], s91 offen
  s_branch HE_167
HS_166:
  s_add_u32 s91, s63, s89
  buffer_store_dwordx4 v[70:73], v255, s[8:11], s91 offen sc1
  s_add_u32 s91, s65, s89
  buffer_store_dwordx4 v[74:77], v255, s[8:11], s91 offen sc1
  s_add_u32 s91, s67, s89
  buffer_store_dwordx2 v[78:79], v255, s[8:11], s91 offen sc1
HE_167:
  s_nop 1
  s_branch XE_165
XO_164:
  s_nop 3
  s_cmp_lg_u32 s6, 0
  s_cbranch_scc1 HS_168
  s_add_u32 s91, s63, s89
  buffer_store_dwordx2 v[70:71], v255, s[8:11], s91 offen
  s_add_u32 s91, s64, s89
  buffer_store_dwordx4 v[72:75], v255, s[8:11], s91 offen
  s_add_u32 s91, s66, s89
  buffer_store_dwordx4 v[76:79], v255, s[8:11], s91 offen
  s_branch HE_169
HS_168:
  s_add_u32 s91, s63, s89
  buffer_store_dwordx2 v[70:71], v255, s[8:11], s91 offen sc1
  s_add_u32 s91, s64, s89
  buffer_store_dwordx4 v[72:75], v255, s[8:11], s91 offen sc1
  s_add_u32 s91, s66, s89
  buffer_store_dwordx4 v[76:79], v255, s[8:11], s91 offen sc1
HE_169:
  s_nop 1
XE_165:
  s_mov_b32 s91, 0x3f803f80
  v_mov_b32 v80, 0
  v_mov_b32 v81, 0
  v_mov_b32 v82, 0
  v_mov_b32 v83, 0
  v_dot2_f32_bf16 v80, v70, s91, v80
  v_dot2_f32_bf16 v81, v70, v70, v81
  v_dot2_f32_bf16 v82, v71, s91, v82
  v_dot2_f32_bf16 v83, v71, v71, v83
  v_dot2_f32_bf16 v80, v72, s91, v80
  v_dot2_f32_bf16 v81, v72, v72, v81
  v_dot2_f32_bf16 v82, v73, s91, v82
  v_dot2_f32_bf16 v83, v73, v73, v83
  v_dot2_f32_bf16 v80, v74, s91, v80
  v_dot2_f32_bf16 v81, v74, v74, v81
  v_dot2_f32_bf16 v82, v75, s91, v82
  v_dot2_f32_bf16 v83, v75, v75, v83
  v_dot2_f32_bf16 v80, v76, s91, v80
  v_dot2_f32_bf16 v81, v76, v76, v81
  v_dot2_f32_bf16 v82, v77, s91, v82
  v_dot2_f32_bf16 v83, v77, v77, v83
  v_dot2_f32_bf16 v80, v78, s91, v80
  v_dot2_f32_bf16 v81, v78, v78, v81
  v_dot2_f32_bf16 v82, v79, s91, v82
  v_dot2_f32_bf16 v83, v79, v79, v83
  s_nop 2
  v_pk_add_f32 v[80:81], v[80:81], v[82:83]
  v_mov_b32 v82, v80
  v_mov_b32 v83, v81
  s_nop 0
  v_permlane16_swap_b32 v80, v82
  v_permlane16_swap_b32 v81, v83
  v_add_f32 v80, v80, v82
  v_add_f32 v81, v81, v83
  v_mov_b32 v82, v80
  v_mov_b32 v83, v81
  s_nop 0
  v_permlane32_swap_b32 v80, v82
  v_permlane32_swap_b32 v81, v83
  v_add_f32 v80, v80, v82
  v_add_f32 v81, v81, v83
  s_nop 3
  s_cmp_lg_u32 s6, 0
  s_cbranch_scc1 HS_170
  s_mov_b64 exec, 0xffff
  buffer_store_dwordx2 v[80:81], v251, s[8:11], s90 offen
  s_mov_b64 exec, -1
  s_branch HE_171
HS_170:
  s_mov_b64 exec, 0xffff
  buffer_store_dwordx2 v[80:81], v251, s[8:11], s90 offen sc1
  s_mov_b64 exec, -1
HE_171:
  s_nop 1
  s_waitcnt vmcnt(0) lgkmcnt(0)
  s_lshl_b32 s54, s4, 9
  s_lshl_b32 s55, s5, 4
  s_add_u32 s54, s54, s55
  s_add_u32 s54, s54, s52
  s_add_u32 s54, s54, 32768
  s_lshl_b32 s55, s3, 2
  s_add_u32 s54, s54, s55
  v_mov_b32 v220, s7
  v_lshlrev_b32 v221, 2, v254
  s_mov_b64 exec, 1
  s_nop 3
  s_cmp_lg_u32 s6, 0
  s_cbranch_scc1 HS_172
  buffer_store_dword v220, v221, s[8:11], s54 offen
  s_branch HE_173
HS_172:
  buffer_store_dword v220, v221, s[8:11], s54 offen sc1
HE_173:
  s_nop 1
  s_mov_b64 exec, -1
  s_branch FD_163
FO_162:
  s_mov_b32 s28, s38
  s_and_b32 s29, s39, 0xffff
  s_mov_b32 s30, 2621440
  s_mov_b32 s31, 0x20000
  v_and_b32 v84, 15, v254
  v_mul_u32_u24 v84, 1280, v84
  v_lshrrev_b32 v85, 4, v254
  v_lshlrev_b32 v85, 3, v85
  v_add_u32 v84, v84, v85
  s_mul_i32 s89, s95, 20480
  s_mul_i32 s90, s96, 160
  s_add_u32 s89, s89, s90
  buffer_store_dwordx2 v[70:71], v84, s[28:31], s89 offen offset:0
  buffer_store_dwordx2 v[72:73], v84, s[28:31], s89 offen offset:32
  buffer_store_dwordx2 v[74:75], v84, s[28:31], s89 offen offset:64
  buffer_store_dwordx2 v[76:77], v84, s[28:31], s89 offen offset:96
  buffer_store_dwordx2 v[78:79], v84, s[28:31], s89 offen offset:128
FD_163:
  s_cmp_eq_u32 s42, 1
  s_cbranch_scc1 CE_179
  s_mov_b32 s42, 1
  s_cmp_eq_u32 s42, 0
  s_mov_b32 s84, 3145728
  s_cselect_b32 s43, 0, s84
  s_mov_b32 s84, 46268416
  s_cselect_b32 s44, 46137344, s84
  s_mov_b32 s84, 9437184
  s_cselect_b32 s45, 6291456, s84
  s_mov_b32 s84, 46530560
  s_cselect_b32 s46, 46399488, s84
  s_mov_b32 s84, 15728640
  s_cselect_b32 s47, 12582912, s84
  s_mov_b32 s84, 26214400
  s_cselect_b32 s48, 18874368, s84
  s_mov_b32 s84, 39845888
  s_cselect_b32 s49, 33554432, s84
  s_mov_b32 s84, 3145728
  s_cselect_b32 s50, 3145728, s84
  s_mov_b32 s84, 46268416
  s_cselect_b32 s51, 46268416, s84
  s_mov_b32 s84, 47218688
  s_cselect_b32 s52, 47185920, s84
  s_cmp_eq_u32 s6, 0
  s_cselect_b32 s43, 0, s43
  s_branch L_LOOP
CE_179:
EE_180:
  s_waitcnt vmcnt(0)
  s_endpgm
L_H0:
  s_sub_u32 s70, s3, 4
  s_mov_b32 s71, 0
L_P0H:
  s_mul_i32 s84, s70, 5120
  s_mul_i32 s85, s70, 122880
  s_mul_i32 s86, s5, 40
  s_add_u32 s85, s85, s86
  s_add_u32 s88, s85, 0
  s_add_u32 m0, s84, 0
  s_nop 0
  buffer_load_dwordx4 v224, s[12:15], s88 offen lds
  s_add_u32 m0, s84, 1024
  s_nop 0
  buffer_load_dwordx4 v225, s[12:15], s88 offen lds
  s_add_u32 m0, s84, 2048
  s_nop 0
  buffer_load_dwordx4 v226, s[12:15], s88 offen lds
  s_add_u32 m0, s84, 3072
  s_nop 0
  buffer_load_dwordx4 v227, s[12:15], s88 offen lds
  s_add_u32 m0, s84, 4096
  s_nop 0
  buffer_load_dwordx4 v228, s[12:15], s88 offen lds
  s_add_u32 s88, s85, 491520
  s_add_u32 m0, s84, 20480
  s_nop 0
  buffer_load_dwordx4 v224, s[12:15], s88 offen lds
  s_add_u32 m0, s84, 21504
  s_nop 0
  buffer_load_dwordx4 v225, s[12:15], s88 offen lds
  s_add_u32 m0, s84, 22528
  s_nop 0
  buffer_load_dwordx4 v226, s[12:15], s88 offen lds
  s_add_u32 m0, s84, 23552
  s_nop 0
  buffer_load_dwordx4 v227, s[12:15], s88 offen lds
  s_add_u32 m0, s84, 24576
  s_nop 0
  buffer_load_dwordx4 v228, s[12:15], s88 offen lds
  s_add_u32 s88, s85, 983040
  s_add_u32 m0, s84, 40960
  s_nop 0
  buffer_load_dwordx4 v224, s[12:15], s88 offen lds
  s_add_u32 m0, s84, 41984
  s_nop 0
  buffer_load_dwordx4 v225, s[12:15], s88 offen lds
  s_add_u32 m0, s84, 43008
  s_nop 0
  buffer_load_dwordx4 v226, s[12:15], s88 offen lds
  s_add_u32 m0, s84, 44032
  s_nop 0
  buffer_load_dwordx4 v227, s[12:15], s88 offen lds
  s_add_u32 m0, s84, 45056
  s_nop 0
  buffer_load_dwordx4 v228, s[12:15], s88 offen lds
  s_add_u32 s88, s85, 1474560
  s_add_u32 m0, s84, 61440
  s_nop 0
  buffer_load_dwordx4 v224, s[12:15], s88 offen lds
  s_add_u32 m0, s84, 62464
  s_nop 0
  buffer_load_dwordx4 v225, s[12:15], s88 offen lds
  s_add_u32 m0, s84, 63488
  s_nop 0
  buffer_load_dwordx4 v226, s[12:15], s88 offen lds
  s_add_u32 m0, s84, 64512
  s_nop 0
  buffer_load_dwordx4 v227, s[12:15], s88 offen lds
  s_add_u32 m0, s84, 65536
  s_nop 0
  buffer_load_dwordx4 v228, s[12:15], s88 offen lds
  s_add_u32 s88, s85, 1966080
  s_add_u32 m0, s84, 81920
  s_nop 0
  buffer_load_dwordx4 v224, s[12:15], s88 offen lds
  s_add_u32 m0, s84, 82944
  s_nop 0
  buffer_load_dwordx4 v225, s[12:15], s88 offen lds
  s_add_u32 m0, s84, 83968
  s_nop 0
  buffer_load_dwordx4 v226, s[12:15], s88 offen lds
  s_add_u32 m0, s84, 84992
  s_nop 0
  buffer_load_dwordx4 v227, s[12:15], s88 offen lds
  s_add_u32 m0, s84, 86016
  s_nop 0
  buffer_load_dwordx4 v228, s[12:15], s88 offen lds
  s_mov_b32 s92, 161808
  s_mov_b32 s93, 1
  v_mov_b32 v220, s92
  s_mov_b32 s90, 0
LW_31:
  ds_read_b32 v216, v220
  s_waitcnt lgkmcnt(0)
  v_readfirstlane_b32 s91, v216
  s_add_u32 s90, s90, 1
  s_cmp_ge_u32 s91, s93
  s_cbranch_scc1 LWD_32
  s_sleep 1
  s_cmp_lt_u32 s90, 0x400000
  s_cbranch_scc1 LW_31
LWD_32:
  v_mov_b32 v40, 161792
  ds_read_b128 v[44:47], v40
  s_waitcnt lgkmcnt(0)
  v_readfirstlane_b32 s4, v44
  v_readfirstlane_b32 s5, v45
  v_readfirstlane_b32 s7, v46
  v_readfirstlane_b32 s6, v47
  s_cmp_lt_u32 s91, 2
  s_cbranch_scc1 RD_33
  s_cmp_lg_u32 s71, 0
  s_cbranch_scc1 RD_33
  s_mov_b32 s71, 1
  s_branch L_P0H
RD_33:
  s_waitcnt vmcnt(0)
  s_branch L_CS1
L_HATT:
  s_sub_u32 s70, s3, 4
  v_add_u32 v2, 0, v254
  v_mul_u32_u24 v3, 6554, v2
  v_lshrrev_b32 v3, 16, v3
  v_mul_u32_u24 v4, 10, v3
  v_sub_u32 v4, v2, v4
  v_mul_u32_u24 v5, 1280, v3
  v_lshlrev_b32 v6, 4, v4
  v_add_u32 v239, v5, v6
  v_add_u32 v2, 64, v254
  v_mul_u32_u24 v3, 6554, v2
  v_lshrrev_b32 v3, 16, v3
  v_mul_u32_u24 v4, 10, v3
  v_sub_u32 v4, v2, v4
  v_mul_u32_u24 v5, 1280, v3
  v_lshlrev_b32 v6, 4, v4
  v_add_u32 v240, v5, v6
  v_add_u32 v2, 128, v254
  v_mul_u32_u24 v3, 6554, v2
  v_lshrrev_b32 v3, 16, v3
  v_mul_u32_u24 v4, 10, v3
  v_sub_u32 v4, v2, v4
  v_mul_u32_u24 v5, 1280, v3
  v_lshlrev_b32 v6, 4, v4
  v_add_u32 v241, v5, v6
  v_add_u32 v2, 192, v254
  v_mul_u32_u24 v3, 6554, v2
  v_lshrrev_b32 v3, 16, v3
  v_mul_u32_u24 v4, 10, v3
  v_sub_u32 v4, v2, v4
  v_mul_u32_u24 v5, 1280, v3
  v_lshlrev_b32 v6, 4, v4
  v_add_u32 v242, v5, v6
  v_add_u32 v2, 256, v254
  v_mul_u32_u24 v3, 6554, v2
  v_lshrrev_b32 v3, 16, v3
  v_mul_u32_u24 v4, 10, v3
  v_sub_u32 v4, v2, v4
  v_mul_u32_u24 v5, 1280, v3
  v_lshlrev_b32 v6, 4, v4
  v_add_u32 v243, v5, v6
  v_add_u32 v2, 0, v254
  v_mul_u32_u24 v3, 4682, v2
  v_lshrrev_b32 v3, 16, v3
  v_mul_u32_u24 v4, 14, v3
  v_sub_u32 v4, v2, v4
  v_mul_u32_u24 v5, 3456, v3
  v_lshlrev_b32 v6, 4, v4
  v_add_u32 v244, v5, v6
  v_add_u32 v2, 64, v254
  v_mul_u32_u24 v3, 4682, v2
  v_lshrrev_b32 v3, 16, v3
  v_mul_u32_u24 v4, 14, v3
  v_sub_u32 v4, v2, v4
  v_mul_u32_u24 v5, 3456, v3
  v_lshlrev_b32 v6, 4, v4
  v_add_u32 v245, v5, v6
  v_add_u32 v2, 128, v254
  v_mul_u32_u24 v3, 4682, v2
  v_lshrrev_b32 v3, 16, v3
  v_mul_u32_u24 v4, 14, v3
  v_sub_u32 v4, v2, v4
  v_mul_u32_u24 v5, 3456, v3
  v_lshlrev_b32 v6, 4, v4
  v_add_u32 v246, v5, v6
  v_add_u32 v2, 192, v254
  v_mul_u32_u24 v3, 4682, v2
  v_lshrrev_b32 v3, 16, v3
  v_mul_u32_u24 v4, 14, v3
  v_sub_u32 v4, v2, v4
  v_mul_u32_u24 v5, 3456, v3
  v_lshlrev_b32 v6, 4, v4
  v_add_u32 v247, v5, v6
  v_add_u32 v2, 256, v254
  v_mul_u32_u24 v3, 4682, v2
  v_lshrrev_b32 v3, 16, v3
  v_mul_u32_u24 v4, 14, v3
  v_sub_u32 v4, v2, v4
  v_mul_u32_u24 v5, 3456, v3
  v_lshlrev_b32 v6, 4, v4
  v_add_u32 v248, v5, v6
  v_add_u32 v2, 320, v254
  v_mul_u32_u24 v3, 4682, v2
  v_lshrrev_b32 v3, 16, v3
  v_mul_u32_u24 v4, 14, v3
  v_sub_u32 v4, v2, v4
  v_mul_u32_u24 v5, 3456, v3
  v_lshlrev_b32 v6, 4, v4
  v_add_u32 v249, v5, v6
  v_add_u32 v2, 384, v254
  v_mul_u32_u24 v3, 4682, v2
  v_lshrrev_b32 v3, 16, v3
  v_mul_u32_u24 v4, 14, v3
  v_sub_u32 v4, v2, v4
  v_mul_u32_u24 v5, 3456, v3
  v_lshlrev_b32 v6, 4, v4
  v_add_u32 v250, v5, v6
  s_barrier
  s_add_u32 s87, s70, 0
  s_mul_i32 s84, s87, 7168
  s_add_u32 s84, s84, 102400
  s_and_b32 s86, s5, 15
  s_mul_i32 s86, s86, 27
  s_lshr_b32 s86, s86, 2
  s_mul_i32 s85, s87, 108
  s_add_u32 s85, s85, s86
  s_lshl_b32 s85, s85, 10
  s_add_u32 s85, s85, 50331648
  s_add_u32 s88, s85, 0
  s_add_u32 m0, s84, 0
  s_nop 0
  buffer_load_dwordx4 v255, s[8:11], s88 offen offset:0 sc1 lds
  buffer_load_dwordx4 v255, s[8:11], s88 offen offset:1024 sc1 lds
  buffer_load_dwordx4 v255, s[8:11], s88 offen offset:2048 sc1 lds
  buffer_load_dwordx4 v255, s[8:11], s88 offen offset:3072 sc1 lds
  s_add_u32 s88, s88, 4096
  s_add_u32 m0, s84, 4096
  s_nop 0
  buffer_load_dwordx4 v255, s[8:11], s88 offen offset:0 sc1 lds
  buffer_load_dwordx4 v255, s[8:11], s88 offen offset:1024 sc1 lds
  buffer_load_dwordx4 v255, s[8:11], s88 offen offset:2048 sc1 lds
  s_add_u32 s87, s70, 4
  s_mul_i32 s84, s87, 7168
  s_add_u32 s84, s84, 102400
  s_and_b32 s86, s5, 15
  s_mul_i32 s86, s86, 27
  s_lshr_b32 s86, s86, 2
  s_mul_i32 s85, s87, 108
  s_add_u32 s85, s85, s86
  s_lshl_b32 s85, s85, 10
  s_add_u32 s85, s85, 50331648
  s_add_u32 s88, s85, 0
  s_add_u32 m0, s84, 0
  s_nop 0
  buffer_load_dwordx4 v255, s[8:11], s88 offen offset:0 sc1 lds
  buffer_load_dwordx4 v255, s[8:11], s88 offen offset:1024 sc1 lds
  buffer_load_dwordx4 v255, s[8:11], s88 offen offset:2048 sc1 lds
  buffer_load_dwordx4 v255, s[8:11], s88 offen offset:3072 sc1 lds
  s_add_u32 s88, s88, 4096
  s_add_u32 m0, s84, 4096
  s_nop 0
  buffer_load_dwordx4 v255, s[8:11], s88 offen offset:0 sc1 lds
  buffer_load_dwordx4 v255, s[8:11], s88 offen offset:1024 sc1 lds
  buffer_load_dwordx4 v255, s[8:11], s88 offen offset:2048 sc1 lds
  s_waitcnt vmcnt(14)
  s_barrier
  s_add_u32 s87, s70, 8
  s_mul_i32 s84, s87, 7168
  s_add_u32 s84, s84, 4294909952
  s_and_b32 s86, s5, 15
  s_mul_i32 s86, s86, 27
  s_lshr_b32 s86, s86, 2
  s_mul_i32 s85, s87, 108
  s_add_u32 s85, s85, s86
  s_lshl_b32 s85, s85, 10
  s_add_u32 s85, s85, 50331648
  s_add_u32 s88, s85, 0
  s_add_u32 m0, s84, 0
  s_nop 0
  buffer_load_dwordx4 v255, s[8:11], s88 offen offset:0 sc1 lds
  buffer_load_dwordx4 v255, s[8:11], s88 offen offset:1024 sc1 lds
  buffer_load_dwordx4 v255, s[8:11], s88 offen offset:2048 sc1 lds
  buffer_load_dwordx4 v255, s[8:11], s88 offen offset:3072 sc1 lds
  s_add_u32 s88, s88, 4096
  s_add_u32 m0, s84, 4096
  s_nop 0
  buffer_load_dwordx4 v255, s[8:11], s88 offen offset:0 sc1 lds
  buffer_load_dwordx4 v255, s[8:11], s88 offen offset:1024 sc1 lds
  buffer_load_dwordx4 v255, s[8:11], s88 offen offset:2048 sc1 lds
  s_barrier
  s_barrier
  s_add_u32 s87, s70, 12
  s_mul_i32 s84, s87, 7168
  s_add_u32 s84, s84, 4294909952
  s_and_b32 s86, s5, 15
  s_mul_i32 s86, s86, 27
  s_lshr_b32 s86, s86, 2
  s_mul_i32 s85, s87, 108
  s_add_u32 s85, s85, s86
  s_lshl_b32 s85, s85, 10
  s_add_u32 s85, s85, 50331648
  s_add_u32 s88, s85, 0
  s_add_u32 m0, s84, 0
  s_nop 0
  buffer_load_dwordx4 v255, s[8:11], s88 offen offset:0 sc1 lds
  buffer_load_dwordx4 v255, s[8:11], s88 offen offset:1024 sc1 lds
  buffer_load_dwordx4 v255, s[8:11], s88 offen offset:2048 sc1 lds
  buffer_load_dwordx4 v255, s[8:11], s88 offen offset:3072 sc1 lds
  s_add_u32 s88, s88, 4096
  s_add_u32 m0, s84, 4096
  s_nop 0
  buffer_load_dwordx4 v255, s[8:11], s88 offen offset:0 sc1 lds
  buffer_load_dwordx4 v255, s[8:11], s88 offen offset:1024 sc1 lds
  buffer_load_dwordx4 v255, s[8:11], s88 offen offset:2048 sc1 lds
  s_add_u32 s89, s87, 4
  s_cmp_ge_u32 s89, 19
  s_cbranch_scc1 CL_136
  s_add_u32 s88, s85, 442368
  s_add_u32 m0, s84, 28672
  s_nop 0
  buffer_load_dwordx4 v255, s[8:11], s88 offen offset:0 sc1 lds
  buffer_load_dwordx4 v255, s[8:11], s88 offen offset:1024 sc1 lds
  buffer_load_dwordx4 v255, s[8:11], s88 offen offset:2048 sc1 lds
  buffer_load_dwordx4 v255, s[8:11], s88 offen offset:3072 sc1 lds
  s_add_u32 s88, s88, 4096
  s_add_u32 m0, s84, 32768
  s_nop 0
  buffer_load_dwordx4 v255, s[8:11], s88 offen offset:0 sc1 lds
  buffer_load_dwordx4 v255, s[8:11], s88 offen offset:1024 sc1 lds
  buffer_load_dwordx4 v255, s[8:11], s88 offen offset:2048 sc1 lds
CL_136:
  v_mov_b32 v176, 0x3f803f80
  v_mov_b32 v177, 0x3f803f80
  v_mov_b32 v178, 0x3f803f80
  v_mov_b32 v179, 0x3f803f80
  s_mul_i32 s84, s70, 7168
  v_add_u32 v208, s84, v255
  v_add_u32 v209, 65536, v208
  v_add_u32 v210, 131072, v208
  v_lshrrev_b32 v200, 4, v254
  v_lshlrev_b32 v200, 4, v200
  s_mul_i32 s84, s70, 448
  s_add_u32 s84, s84, 159744
  v_add_u32 v200, s84, v200
  s_waitcnt vmcnt(14)
  s_cmp_lg_u32 s70, 3
  s_cbranch_scc1 L7_150
  s_waitcnt vmcnt(7)
L7_150:
  s_barrier
  s_cmp_lg_u32 s70, 3
  s_cbranch_scc1 C19_151
  s_mov_b32 s70, 0
  s_add_u32 s87, s70, 19
  s_mul_i32 s84, s87, 7168
  s_add_u32 s84, s84, 4294909952
  s_and_b32 s86, s5, 15
  s_mul_i32 s86, s86, 27
  s_lshr_b32 s86, s86, 2
  s_mul_i32 s85, s87, 108
  s_add_u32 s85, s85, s86
  s_lshl_b32 s85, s85, 10
  s_add_u32 s85, s85, 50331648
  s_add_u32 s89, s87, 0
  s_cmp_ge_u32 s89, 20
  s_cbranch_scc1 CL_152
  s_add_u32 s88, s85, 0
  s_add_u32 m0, s84, 0
  s_nop 0
  buffer_load_dwordx4 v255, s[8:11], s88 offen offset:0 sc1 lds
  buffer_load_dwordx4 v255, s[8:11], s88 offen offset:1024 sc1 lds
  buffer_load_dwordx4 v255, s[8:11], s88 offen offset:2048 sc1 lds
  buffer_load_dwordx4 v255, s[8:11], s88 offen offset:3072 sc1 lds
  s_add_u32 s88, s88, 4096
  s_add_u32 m0, s84, 4096
  s_nop 0
  buffer_load_dwordx4 v255, s[8:11], s88 offen offset:0 sc1 lds
  buffer_load_dwordx4 v255, s[8:11], s88 offen offset:1024 sc1 lds
  buffer_load_dwordx4 v255, s[8:11], s88 offen offset:2048 sc1 lds
CL_152:
  s_mov_b32 s70, 3
C19_151:
  s_lshl_b32 s84, s4, 4
  s_lshr_b32 s85, s5, 4
  s_lshl_b32 s85, s85, 3
  s_add_u32 s84, s84, s85
  s_lshl_b32 s85, s70, 1
  s_add_u32 s84, s84, s85
  s_and_b32 s85, s5, 15
  s_mul_i32 s85, s85, 27
  s_lshr_b32 s85, s85, 3
  s_lshl_b32 s85, s85, 10
  s_add_u32 s86, s84, 0
  s_mul_i32 s86, s86, 55296
  s_add_u32 s86, s86, s48
  s_add_u32 s86, s86, s85
  s_add_u32 s87, s86, 0
  buffer_load_dword v222, v255, s[8:11], s87 offen
  s_add_u32 s87, s86, 1024
  buffer_load_dword v222, v255, s[8:11], s87 offen
  s_add_u32 s87, s86, 2048
  buffer_load_dword v222, v255, s[8:11], s87 offen
  s_add_u32 s87, s86, 3072
  buffer_load_dword v222, v255, s[8:11], s87 offen
  s_add_u32 s86, s84, 1
  s_mul_i32 s86, s86, 55296
  s_add_u32 s86, s86, s48
  s_add_u32 s86, s86, s85
  s_add_u32 s87, s86, 0
  buffer_load_dword v222, v255, s[8:11], s87 offen
  s_add_u32 s87, s86, 1024
  buffer_load_dword v222, v255, s[8:11], s87 offen
  s_add_u32 s87, s86, 2048
  buffer_load_dword v222, v255, s[8:11], s87 offen
  s_add_u32 s87, s86, 3072
  buffer_load_dword v222, v255, s[8:11], s87 offen
  s_cmp_lg_u32 s42, 1
  s_cbranch_scc1 EU_153
  s_cmp_lg_u32 s3, 4
  s_cbranch_scc1 EU_153
  s_lshl_b32 s84, s4, 5
  s_add_u32 s84, s84, s5
  s_cmp_lg_u32 s84, 255
  s_cbranch_scc1 EU_153
  s_add_u32 s84, s52, 0x4000
  s_mov_b32 s85, 0
EL_154:
  s_add_u32 s86, s84, 0
  buffer_load_dwordx4 v[0:3], v255, s[8:11], s86 offen sc1
  s_add_u32 s86, s84, 1024
  buffer_load_dwordx4 v[4:7], v255, s[8:11], s86 offen sc1
  s_add_u32 s86, s84, 2048
  buffer_load_dwordx4 v[8:11], v255, s[8:11], s86 offen sc1
  s_add_u32 s86, s84, 3072
  buffer_load_dwordx4 v[12:15], v255, s[8:11], s86 offen sc1
  s_add_u32 s86, s84, 4096
  buffer_load_dwordx4 v[16:19], v255, s[8:11], s86 offen sc1
  s_add_u32 s86, s84, 5120
  buffer_load_dwordx4 v[20:23], v255, s[8:11], s86 offen sc1
  s_add_u32 s86, s84, 6144
  buffer_load_dwordx4 v[24:27], v255, s[8:11], s86 offen sc1
  s_add_u32 s86, s84, 7168
  buffer_load_dwordx4 v[28:31], v255, s[8:11], s86 offen sc1
  s_waitcnt vmcnt(0)
  s_mov_b64 s[92:93], 0
  v_cmp_ne_u32 vcc, s7, v0
  s_nop 1
  s_or_b64 s[92:93], s[92:93], vcc
  v_cmp_ne_u32 vcc, s7, v1
  s_nop 1
  s_or_b64 s[92:93], s[92:93], vcc
  v_cmp_ne_u32 vcc, s7, v2
  s_nop 1
  s_or_b64 s[92:93], s[92:93], vcc
  v_cmp_ne_u32 vcc, s7, v3
  s_nop 1
  s_or_b64 s[92:93], s[92:93], vcc
  v_cmp_ne_u32 vcc, s7, v4
  s_nop 1
  s_or_b64 s[92:93], s[92:93], vcc
  v_cmp_ne_u32 vcc, s7, v5
  s_nop 1
  s_or_b64 s[92:93], s[92:93], vcc
  v_cmp_ne_u32 vcc, s7, v6
  s_nop 1
  s_or_b64 s[92:93], s[92:93], vcc
  v_cmp_ne_u32 vcc, s7, v7
  s_nop 1
  s_or_b64 s[92:93], s[92:93], vcc
  v_cmp_ne_u32 vcc, s7, v8
  s_nop 1
  s_or_b64 s[92:93], s[92:93], vcc
  v_cmp_ne_u32 vcc, s7, v9
  s_nop 1
  s_or_b64 s[92:93], s[92:93], vcc
  v_cmp_ne_u32 vcc, s7, v10
  s_nop 1
  s_or_b64 s[92:93], s[92:93], vcc
  v_cmp_ne_u32 vcc, s7, v11
  s_nop 1
  s_or_b64 s[92:93], s[92:93], vcc
  v_cmp_ne_u32 vcc, s7, v12
  s_nop 1
  s_or_b64 s[92:93], s[92:93], vcc
  v_cmp_ne_u32 vcc, s7, v13
  s_nop 1
  s_or_b64 s[92:93], s[92:93], vcc
  v_cmp_ne_u32 vcc, s7, v14
  s_nop 1
  s_or_b64 s[92:93], s[92:93], vcc
  v_cmp_ne_u32 vcc, s7, v15
  s_nop 1
  s_or_b64 s[92:93], s[92:93], vcc
  v_cmp_ne_u32 vcc, s7, v16
  s_nop 1
  s_or_b64 s[92:93], s[92:93], vcc
  v_cmp_ne_u32 vcc, s7, v17
  s_nop 1
  s_or_b64 s[92:93], s[92:93], vcc
  v_cmp_ne_u32 vcc, s7, v18
  s_nop 1
  s_or_b64 s[92:93], s[92:93], vcc
  v_cmp_ne_u32 vcc, s7, v19
  s_nop 1
  s_or_b64 s[92:93], s[92:93], vcc
  v_cmp_ne_u32 vcc, s7, v20
  s_nop 1
  s_or_b64 s[92:93], s[92:93], vcc
  v_cmp_ne_u32 vcc, s7, v21
  s_nop 1
  s_or_b64 s[92:93], s[92:93], vcc
  v_cmp_ne_u32 vcc, s7, v22
  s_nop 1
  s_or_b64 s[92:93], s[92:93], vcc
  v_cmp_ne_u32 vcc, s7, v23
  s_nop 1
  s_or_b64 s[92:93], s[92:93], vcc
  v_cmp_ne_u32 vcc, s7, v24
  s_nop 1
  s_or_b64 s[92:93], s[92:93], vcc
  v_cmp_ne_u32 vcc, s7, v25
  s_nop 1
  s_or_b64 s[92:93], s[92:93], vcc
  v_cmp_ne_u32 vcc, s7, v26
  s_nop 1
  s_or_b64 s[92:93], s[92:93], vcc
  v_cmp_ne_u32 vcc, s7, v27
  s_nop 1
  s_or_b64 s[92:93], s[92:93], vcc
  v_cmp_ne_u32 vcc, s7, v28
  s_nop 1
  s_or_b64 s[92:93], s[92:93], vcc
  v_cmp_ne_u32 vcc, s7, v29
  s_nop 1
  s_or_b64 s[92:93], s[92:93], vcc
  v_cmp_ne_u32 vcc, s7, v30
  s_nop 1
  s_or_b64 s[92:93], s[92:93], vcc
  v_cmp_ne_u32 vcc, s7, v31
  s_nop 1
  s_or_b64 s[92:93], s[92:93], vcc
  s_add_u32 s85, s85, 1
  s_cmp_eq_u64 s[92:93], 0
  s_cbranch_scc1 EL_154_d
  s_cmp_lt_u32 s85, 0x40000
  s_cbranch_scc1 EL_154
EL_154_d:
  v_mov_b32 v3, s7
  v_mov_b32 v2, 0
  s_mov_b32 s84, 47316992
  s_mov_b64 exec, 1
  buffer_store_dword v3, v2, s[8:11], s84 offen sc1
  s_mov_b64 exec, -1
EU_153:
  s_cmp_eq_u32 s42, 1
  s_cbranch_scc1 NCS_155
  ds_read_b128 v[148:151], v209 offset:36864
  ds_read_b128 v[152:155], v209 offset:37888
  ds_read_b128 v[156:159], v209 offset:38912
  ds_read_b128 v[160:163], v209 offset:39936
  ds_read_b128 v[164:167], v209 offset:40960
  ds_read_b128 v[168:171], v209 offset:41984
  ds_read_b128 v[172:175], v209 offset:43008
  s_waitcnt lgkmcnt(6)
  v_mfma_f32_16x16x32_bf16 v[120:123], v[148:151], v[176:179], 0
  s_waitcnt lgkmcnt(5)
  v_mfma_f32_16x16x32_bf16 v[124:127], v[152:155], v[176:179], 0
  s_waitcnt lgkmcnt(4)
  v_mfma_f32_16x16x32_bf16 v[128:131], v[156:159], v[176:179], 0
  s_waitcnt lgkmcnt(3)
  v_mfma_f32_16x16x32_bf16 v[132:135], v[160:163], v[176:179], 0
  s_waitcnt lgkmcnt(2)
  v_mfma_f32_16x16x32_bf16 v[136:139], v[164:167], v[176:179], 0
  s_waitcnt lgkmcnt(1)
  v_mfma_f32_16x16x32_bf16 v[140:143], v[168:171], v[176:179], 0
  s_waitcnt lgkmcnt(0)
  v_mfma_f32_16x16x32_bf16 v[144:147], v[172:175], v[176:179], 0
  ds_read_b128 v[148:151], v210 offset:0
  ds_read_b128 v[152:155], v210 offset:1024
  ds_read_b128 v[156:159], v210 offset:2048
  ds_read_b128 v[160:163], v210 offset:3072
  ds_read_b128 v[164:167], v210 offset:4096
  ds_read_b128 v[168:171], v210 offset:5120
  ds_read_b128 v[172:175], v210 offset:6144
  s_waitcnt lgkmcnt(6)
  v_mfma_f32_16x16x32_bf16 v[120:123], v[148:151], v[176:179], v[120:123]
  s_waitcnt lgkmcnt(5)
  v_mfma_f32_16x16x32_bf16 v[124:127], v[152:155], v[176:179], v[124:127]
  s_waitcnt lgkmcnt(4)
  v_mfma_f32_16x16x32_bf16 v[128:131], v[156:159], v[176:179], v[128:131]
  s_waitcnt lgkmcnt(3)
  v_mfma_f32_16x16x32_bf16 v[132:135], v[160:163], v[176:179], v[132:135]
  s_waitcnt lgkmcnt(2)
  v_mfma_f32_16x16x32_bf16 v[136:139], v[164:167], v[176:179], v[136:139]
  s_waitcnt lgkmcnt(1)
  v_mfma_f32_16x16x32_bf16 v[140:143], v[168:171], v[176:179], v[140:143]
  s_waitcnt lgkmcnt(0)
  v_mfma_f32_16x16x32_bf16 v[144:147], v[172:175], v[176:179], v[144:147]
  ds_read_b128 v[148:151], v208 offset:0
  ds_read_b128 v[152:155], v208 offset:1024
  ds_read_b128 v[156:159], v208 offset:2048
  ds_read_b128 v[160:163], v208 offset:3072
  ds_read_b128 v[164:167], v208 offset:4096
  ds_read_b128 v[168:171], v208 offset:5120
  ds_read_b128 v[172:175], v208 offset:6144
  s_waitcnt lgkmcnt(6)
  v_mfma_f32_16x16x32_bf16 v[120:123], v[148:151], v[176:179], v[120:123]
  s_waitcnt lgkmcnt(5)
  v_mfma_f32_16x16x32_bf16 v[124:127], v[152:155], v[176:179], v[124:127]
  s_waitcnt lgkmcnt(4)
  v_mfma_f32_16x16x32_bf16 v[128:131], v[156:159], v[176:179], v[128:131]
  s_waitcnt lgkmcnt(3)
  v_mfma_f32_16x16x32_bf16 v[132:135], v[160:163], v[176:179], v[132:135]
  s_waitcnt lgkmcnt(2)
  v_mfma_f32_16x16x32_bf16 v[136:139], v[164:167], v[176:179], v[136:139]
  s_waitcnt lgkmcnt(1)
  v_mfma_f32_16x16x32_bf16 v[140:143], v[168:171], v[176:179], v[140:143]
  s_waitcnt lgkmcnt(0)
  v_mfma_f32_16x16x32_bf16 v[144:147], v[172:175], v[176:179], v[144:147]
  s_waitcnt vmcnt(0)
  ds_read_b128 v[148:151], v208 offset:28672
  ds_read_b128 v[152:155], v208 offset:29696
  ds_read_b128 v[156:159], v208 offset:30720
  ds_read_b128 v[160:163], v208 offset:31744
  ds_read_b128 v[164:167], v208 offset:32768
  ds_read_b128 v[168:171], v208 offset:33792
  ds_read_b128 v[172:175], v208 offset:34816
  s_waitcnt lgkmcnt(6)
  v_mfma_f32_16x16x32_bf16 v[120:123], v[148:151], v[176:179], v[120:123]
  s_waitcnt lgkmcnt(5)
  v_mfma_f32_16x16x32_bf16 v[124:127], v[152:155], v[176:179], v[124:127]
  s_waitcnt lgkmcnt(4)
  v_mfma_f32_16x16x32_bf16 v[128:131], v[156:159], v[176:179], v[128:131]
  s_waitcnt lgkmcnt(3)
  v_mfma_f32_16x16x32_bf16 v[132:135], v[160:163], v[176:179], v[132:135]
  s_waitcnt lgkmcnt(2)
  v_mfma_f32_16x16x32_bf16 v[136:139], v[164:167], v[176:179], v[136:139]
  s_waitcnt lgkmcnt(1)
  v_mfma_f32_16x16x32_bf16 v[140:143], v[168:171], v[176:179], v[140:143]
  s_waitcnt lgkmcnt(0)
  v_mfma_f32_16x16x32_bf16 v[144:147], v[172:175], v[176:179], v[144:147]
  ds_read_b128 v[148:151], v208 offset:57344
  ds_read_b128 v[152:155], v208 offset:58368
  ds_read_b128 v[156:159], v208 offset:59392
  ds_read_b128 v[160:163], v208 offset:60416
  ds_read_b128 v[164:167], v208 offset:61440
  ds_read_b128 v[168:171], v208 offset:62464
  ds_read_b128 v[172:175], v208 offset:63488
  s_waitcnt lgkmcnt(6)
  v_mfma_f32_16x16x32_bf16 v[120:123], v[148:151], v[176:179], v[120:123]
  s_waitcnt lgkmcnt(5)
  v_mfma_f32_16x16x32_bf16 v[124:127], v[152:155], v[176:179], v[124:127]
  s_waitcnt lgkmcnt(4)
  v_mfma_f32_16x16x32_bf16 v[128:131], v[156:159], v[176:179], v[128:131]
  s_waitcnt lgkmcnt(3)
  v_mfma_f32_16x16x32_bf16 v[132:135], v[160:163], v[176:179], v[132:135]
  s_waitcnt lgkmcnt(2)
  v_mfma_f32_16x16x32_bf16 v[136:139], v[164:167], v[176:179], v[136:139]
  s_waitcnt lgkmcnt(1)
  v_mfma_f32_16x16x32_bf16 v[140:143], v[168:171], v[176:179], v[140:143]
  s_waitcnt lgkmcnt(0)
  v_mfma_f32_16x16x32_bf16 v[144:147], v[172:175], v[176:179], v[144:147]
  s_nop 7
  v_and_b32 v201, 15, v254
  v_cmp_eq_u32 vcc, 0, v201
  s_nop 0
  s_and_saveexec_b64 s[92:93], vcc
  ds_write_b128 v200, v[120:123] offset:0
  ds_write_b128 v200, v[124:127] offset:64
  ds_write_b128 v200, v[128:131] offset:128
  ds_write_b128 v200, v[132:135] offset:192
  ds_write_b128 v200, v[136:139] offset:256
  ds_write_b128 v200, v[140:143] offset:320
  ds_write_b128 v200, v[144:147] offset:384
  s_mov_b64 exec, s[92:93]
NCS_155:
  s_waitcnt vmcnt(0) lgkmcnt(0)
  s_barrier
  s_lshr_b32 s87, s70, 1
  s_add_u32 s87, s87, 0
  s_and_b32 s86, s70, 1
  s_lshr_b32 s84, s70, 1
  s_mul_i32 s84, s84, 10240
  s_mul_i32 s85, s86, 5120
  s_add_u32 s84, s84, s85
  s_add_u32 s84, s84, 86016
  s_mul_i32 s85, s86, 27
  s_add_u32 s85, s85, s87
  s_mul_i32 s85, s85, 40
  s_and_b32 s86, s5, 7
  s_mul_i32 s86, s86, 5
  s_add_u32 s85, s85, s86
  s_lshl_b32 s85, s85, 10
  s_add_u32 s85, s85, 53477376
  s_add_u32 s88, s85, 0
  s_add_u32 m0, s84, 0
  s_nop 0
  buffer_load_dwordx4 v255, s[8:11], s88 offen offset:0 sc1 lds
  buffer_load_dwordx4 v255, s[8:11], s88 offen offset:1024 sc1 lds
  buffer_load_dwordx4 v255, s[8:11], s88 offen offset:2048 sc1 lds
  buffer_load_dwordx4 v255, s[8:11], s88 offen offset:3072 sc1 lds
  s_add_u32 s88, s88, 4096
  s_add_u32 m0, s84, 4096
  s_nop 0
  buffer_load_dwordx4 v255, s[8:11], s88 offen offset:0 sc1 lds
  s_add_u32 s88, s85, 81920
  s_add_u32 m0, s84, 20480
  s_nop 0
  buffer_load_dwordx4 v255, s[8:11], s88 offen offset:0 sc1 lds
  buffer_load_dwordx4 v255, s[8:11], s88 offen offset:1024 sc1 lds
  buffer_load_dwordx4 v255, s[8:11], s88 offen offset:2048 sc1 lds
  buffer_load_dwordx4 v255, s[8:11], s88 offen offset:3072 sc1 lds
  s_add_u32 s88, s88, 4096
  s_add_u32 m0, s84, 24576
  s_nop 0
  buffer_load_dwordx4 v255, s[8:11], s88 offen offset:0 sc1 lds
  s_add_u32 s88, s85, 163840
  s_add_u32 m0, s84, 40960
  s_nop 0
  buffer_load_dwordx4 v255, s[8:11], s88 offen offset:0 sc1 lds
  buffer_load_dwordx4 v255, s[8:11], s88 offen offset:1024 sc1 lds
  buffer_load_dwordx4 v255, s[8:11], s88 offen offset:2048 sc1 lds
  buffer_load_dwordx4 v255, s[8:11], s88 offen offset:3072 sc1 lds
  s_add_u32 s88, s88, 4096
  s_add_u32 m0, s84, 45056
  s_nop 0
  buffer_load_dwordx4 v255, s[8:11], s88 offen offset:0 sc1 lds
  s_add_u32 s89, s87, 6
  s_cmp_ge_u32 s89, 7
  s_cbranch_scc1 CL_156
  s_add_u32 s88, s85, 245760
  s_add_u32 m0, s84, 61440
  s_nop 0
  buffer_load_dwordx4 v255, s[8:11], s88 offen offset:0 sc1 lds
  buffer_load_dwordx4 v255, s[8:11], s88 offen offset:1024 sc1 lds
  buffer_load_dwordx4 v255, s[8:11], s88 offen offset:2048 sc1 lds
  buffer_load_dwordx4 v255, s[8:11], s88 offen offset:3072 sc1 lds
  s_add_u32 s88, s88, 4096
  s_add_u32 m0, s84, 65536
  s_nop 0
  buffer_load_dwordx4 v255, s[8:11], s88 offen offset:0 sc1 lds
CL_156:
  s_lshr_b32 s87, s70, 1
  s_add_u32 s87, s87, 15
  s_and_b32 s86, s70, 1
  s_lshr_b32 s84, s70, 1
  s_mul_i32 s84, s84, 10240
  s_mul_i32 s85, s86, 5120
  s_add_u32 s84, s84, s85
  s_add_u32 s84, s84, 86016
  s_mul_i32 s85, s86, 27
  s_add_u32 s85, s85, s87
  s_mul_i32 s85, s85, 40
  s_and_b32 s86, s5, 7
  s_mul_i32 s86, s86, 5
  s_add_u32 s85, s85, s86
  s_lshl_b32 s85, s85, 10
  s_add_u32 s85, s85, 53477376
  s_add_u32 s88, s85, 0
  buffer_load_dwordx4 v[0:3], v255, s[8:11], s88 offen offset:0 sc1
  buffer_load_dwordx4 v[4:7], v255, s[8:11], s88 offen offset:1024 sc1
  buffer_load_dwordx4 v[8:11], v255, s[8:11], s88 offen offset:2048 sc1
  buffer_load_dwordx4 v[12:15], v255, s[8:11], s88 offen offset:3072 sc1
  s_add_u32 s88, s88, 4096
  buffer_load_dwordx4 v[16:19], v255, s[8:11], s88 offen offset:0 sc1
  s_add_u32 s88, s85, 81920
  buffer_load_dwordx4 v[20:23], v255, s[8:11], s88 offen offset:0 sc1
  buffer_load_dwordx4 v[24:27], v255, s[8:11], s88 offen offset:1024 sc1
  buffer_load_dwordx4 v[28:31], v255, s[8:11], s88 offen offset:2048 sc1
  buffer_load_dwordx4 v[32:35], v255, s[8:11], s88 offen offset:3072 sc1
  s_add_u32 s88, s88, 4096
  buffer_load_dwordx4 v[36:39], v255, s[8:11], s88 offen offset:0 sc1
  s_add_u32 s88, s85, 163840
  buffer_load_dwordx4 v[40:43], v255, s[8:11], s88 offen offset:0 sc1
  buffer_load_dwordx4 v[44:47], v255, s[8:11], s88 offen offset:1024 sc1
  buffer_load_dwordx4 v[48:51], v255, s[8:11], s88 offen offset:2048 sc1
  buffer_load_dwordx4 v[52:55], v255, s[8:11], s88 offen offset:3072 sc1
  s_add_u32 s88, s88, 4096
  buffer_load_dwordx4 v[56:59], v255, s[8:11], s88 offen offset:0 sc1
  s_barrier
  s_lshr_b32 s87, s70, 1
  s_add_u32 s87, s87, 7
  s_and_b32 s86, s70, 1
  s_lshr_b32 s84, s70, 1
  s_mul_i32 s84, s84, 10240
  s_mul_i32 s85, s86, 5120
  s_add_u32 s84, s84, s85
  s_add_u32 s84, s84, 0
  s_mul_i32 s85, s86, 27
  s_add_u32 s85, s85, s87
  s_mul_i32 s85, s85, 40
  s_and_b32 s86, s5, 7
  s_mul_i32 s86, s86, 5
  s_add_u32 s85, s85, s86
  s_lshl_b32 s85, s85, 10
  s_add_u32 s85, s85, 53477376
  s_add_u32 s88, s85, 0
  s_add_u32 m0, s84, 0
  s_nop 0
  buffer_load_dwordx4 v255, s[8:11], s88 offen offset:0 sc1 lds
  buffer_load_dwordx4 v255, s[8:11], s88 offen offset:1024 sc1 lds
  buffer_load_dwordx4 v255, s[8:11], s88 offen offset:2048 sc1 lds
  buffer_load_dwordx4 v255, s[8:11], s88 offen offset:3072 sc1 lds
  s_add_u32 s88, s88, 4096
  s_add_u32 m0, s84, 4096
  s_nop 0
  buffer_load_dwordx4 v255, s[8:11], s88 offen offset:0 sc1 lds
  s_add_u32 s88, s85, 81920
  s_add_u32 m0, s84, 20480
  s_nop 0
  buffer_load_dwordx4 v255, s[8:11], s88 offen offset:0 sc1 lds
  buffer_load_dwordx4 v255, s[8:11], s88 offen offset:1024 sc1 lds
  buffer_load_dwordx4 v255, s[8:11], s88 offen offset:2048 sc1 lds
  buffer_load_dwordx4 v255, s[8:11], s88 offen offset:3072 sc1 lds
  s_add_u32 s88, s88, 4096
  s_add_u32 m0, s84, 24576
  s_nop 0
  buffer_load_dwordx4 v255, s[8:11], s88 offen offset:0 sc1 lds
  s_add_u32 s88, s85, 163840
  s_add_u32 m0, s84, 40960
  s_nop 0
  buffer_load_dwordx4 v255, s[8:11], s88 offen offset:0 sc1 lds
  buffer_load_dwordx4 v255, s[8:11], s88 offen offset:1024 sc1 lds
  buffer_load_dwordx4 v255, s[8:11], s88 offen offset:2048 sc1 lds
  buffer_load_dwordx4 v255, s[8:11], s88 offen offset:3072 sc1 lds
  s_add_u32 s88, s88, 4096
  s_add_u32 m0, s84, 45056
  s_nop 0
  buffer_load_dwordx4 v255, s[8:11], s88 offen offset:0 sc1 lds
  s_add_u32 s88, s85, 245760
  s_add_u32 m0, s84, 61440
  s_nop 0
  buffer_load_dwordx4 v255, s[8:11], s88 offen offset:0 sc1 lds
  buffer_load_dwordx4 v255, s[8:11], s88 offen offset:1024 sc1 lds
  buffer_load_dwordx4 v255, s[8:11], s88 offen offset:2048 sc1 lds
  buffer_load_dwordx4 v255, s[8:11], s88 offen offset:3072 sc1 lds
  s_add_u32 s88, s88, 4096
  s_add_u32 m0, s84, 65536
  s_nop 0
  buffer_load_dwordx4 v255, s[8:11], s88 offen offset:0 sc1 lds
  s_waitcnt vmcnt(35)
  s_barrier
  s_waitcnt vmcnt(0)
  s_barrier
  s_lshr_b32 s87, s70, 1
  s_add_u32 s87, s87, 15
  s_and_b32 s86, s70, 1
  s_lshr_b32 s84, s70, 1
  s_mul_i32 s84, s84, 10240
  s_mul_i32 s85, s86, 5120
  s_add_u32 s84, s84, s85
  s_add_u32 s84, s84, 86016
  s_mul_i32 s85, s86, 27
  s_add_u32 s85, s85, s87
  s_mul_i32 s85, s85, 40
  s_and_b32 s86, s5, 7
  s_mul_i32 s86, s86, 5
  s_add_u32 s85, s85, s86
  s_lshl_b32 s85, s85, 10
  s_add_u32 s85, s85, 53477376
  s_add_u32 s88, s84, 0
  v_add_u32 v220, s88, v255
  ds_write_b128 v220, v[0:3] offset:0
  ds_write_b128 v220, v[4:7] offset:1024
  ds_write_b128 v220, v[8:11] offset:2048
  ds_write_b128 v220, v[12:15] offset:3072
  ds_write_b128 v220, v[16:19] offset:4096
  s_add_u32 s88, s84, 20480
  v_add_u32 v220, s88, v255
  ds_write_b128 v220, v[20:23] offset:0
  ds_write_b128 v220, v[24:27] offset:1024
  ds_write_b128 v220, v[28:31] offset:2048
  ds_write_b128 v220, v[32:35] offset:3072
  ds_write_b128 v220, v[36:39] offset:4096
  s_add_u32 s88, s84, 40960
  v_add_u32 v220, s88, v255
  ds_write_b128 v220, v[40:43] offset:0
  ds_write_b128 v220, v[44:47] offset:1024
  ds_write_b128 v220, v[48:51] offset:2048
  ds_write_b128 v220, v[52:55] offset:3072
  ds_write_b128 v220, v[56:59] offset:4096
  s_waitcnt lgkmcnt(0)
  s_barrier
  s_lshr_b32 s87, s70, 1
  s_add_u32 s87, s87, 21
  s_and_b32 s86, s70, 1
  s_lshr_b32 s84, s70, 1
  s_mul_i32 s84, s84, 10240
  s_mul_i32 s85, s86, 5120
  s_add_u32 s84, s84, s85
  s_add_u32 s84, s84, 147456
  s_mul_i32 s85, s86, 27
  s_add_u32 s85, s85, s87
  s_mul_i32 s85, s85, 40
  s_and_b32 s86, s5, 7
  s_mul_i32 s86, s86, 5
  s_add_u32 s85, s85, s86
  s_lshl_b32 s85, s85, 10
  s_add_u32 s85, s85, 53477376
  s_add_u32 s89, s87, 0
  s_cmp_ge_u32 s89, 22
  s_cbranch_scc1 CL_174
  s_add_u32 s88, s85, 0
  s_add_u32 m0, s84, 0
  s_nop 0
  buffer_load_dwordx4 v255, s[8:11], s88 offen offset:0 sc1 lds
  buffer_load_dwordx4 v255, s[8:11], s88 offen offset:1024 sc1 lds
  buffer_load_dwordx4 v255, s[8:11], s88 offen offset:2048 sc1 lds
  buffer_load_dwordx4 v255, s[8:11], s88 offen offset:3072 sc1 lds
  s_add_u32 s88, s88, 4096
  s_add_u32 m0, s84, 4096
  s_nop 0
  buffer_load_dwordx4 v255, s[8:11], s88 offen offset:0 sc1 lds
CL_174:
  s_lshr_b32 s87, s70, 1
  s_add_u32 s87, s87, 22
  s_and_b32 s86, s70, 1
  s_lshr_b32 s84, s70, 1
  s_mul_i32 s84, s84, 10240
  s_mul_i32 s85, s86, 5120
  s_add_u32 s84, s84, s85
  s_add_u32 s84, s84, 0
  s_mul_i32 s85, s86, 27
  s_add_u32 s85, s85, s87
  s_mul_i32 s85, s85, 40
  s_and_b32 s86, s5, 7
  s_mul_i32 s86, s86, 5
  s_add_u32 s85, s85, s86
  s_lshl_b32 s85, s85, 10
  s_add_u32 s85, s85, 53477376
  s_add_u32 s88, s85, 0
  s_add_u32 m0, s84, 0
  s_nop 0
  buffer_load_dwordx4 v255, s[8:11], s88 offen offset:0 sc1 lds
  buffer_load_dwordx4 v255, s[8:11], s88 offen offset:1024 sc1 lds
  buffer_load_dwordx4 v255, s[8:11], s88 offen offset:2048 sc1 lds
  buffer_load_dwordx4 v255, s[8:11], s88 offen offset:3072 sc1 lds
  s_add_u32 s88, s88, 4096
  s_add_u32 m0, s84, 4096
  s_nop 0
  buffer_load_dwordx4 v255, s[8:11], s88 offen offset:0 sc1 lds
  s_add_u32 s88, s85, 81920
  s_add_u32 m0, s84, 20480
  s_nop 0
  buffer_load_dwordx4 v255, s[8:11], s88 offen offset:0 sc1 lds
  buffer_load_dwordx4 v255, s[8:11], s88 offen offset:1024 sc1 lds
  buffer_load_dwordx4 v255, s[8:11], s88 offen offset:2048 sc1 lds
  buffer_load_dwordx4 v255, s[8:11], s88 offen offset:3072 sc1 lds
  s_add_u32 s88, s88, 4096
  s_add_u32 m0, s84, 24576
  s_nop 0
  buffer_load_dwordx4 v255, s[8:11], s88 offen offset:0 sc1 lds
  s_add_u32 s89, s87, 4
  s_cmp_ge_u32 s89, 27
  s_cbranch_scc1 CL_175
  s_add_u32 s88, s85, 163840
  s_add_u32 m0, s84, 40960
  s_nop 0
  buffer_load_dwordx4 v255, s[8:11], s88 offen offset:0 sc1 lds
  buffer_load_dwordx4 v255, s[8:11], s88 offen offset:1024 sc1 lds
  buffer_load_dwordx4 v255, s[8:11], s88 offen offset:2048 sc1 lds
  buffer_load_dwordx4 v255, s[8:11], s88 offen offset:3072 sc1 lds
  s_add_u32 s88, s88, 4096
  s_add_u32 m0, s84, 45056
  s_nop 0
  buffer_load_dwordx4 v255, s[8:11], s88 offen offset:0 sc1 lds
CL_175:
  s_waitcnt vmcnt(0)
  s_barrier
  s_cmp_eq_u32 s42, 1
  s_cbranch_scc1 NT_176
  s_mul_i32 s84, s70, 5120
  s_mul_i32 s85, s70, 122880
  s_mul_i32 s86, s5, 40
  s_add_u32 s85, s85, s86
  s_add_u32 s88, s85, 0
  buffer_load_dwordx4 v[120:123], v224, s[12:15], s88 offen
  buffer_load_dwordx4 v[124:127], v225, s[12:15], s88 offen
  buffer_load_dwordx4 v[128:131], v226, s[12:15], s88 offen
  buffer_load_dwordx4 v[132:135], v227, s[12:15], s88 offen
  buffer_load_dwordx4 v[136:139], v228, s[12:15], s88 offen
  s_add_u32 s88, s85, 491520
  buffer_load_dwordx4 v[140:143], v224, s[12:15], s88 offen
  buffer_load_dwordx4 v[144:147], v225, s[12:15], s88 offen
  buffer_load_dwordx4 v[148:151], v226, s[12:15], s88 offen
  buffer_load_dwordx4 v[152:155], v227, s[12:15], s88 offen
  buffer_load_dwordx4 v[156:159], v228, s[12:15], s88 offen
NT_176:
  s_barrier
  s_barrier
  s_cmp_eq_u32 s42, 1
  s_cbranch_scc1 NT_177
  s_mul_i32 s84, s70, 5120
  s_mul_i32 s85, s70, 122880
  s_mul_i32 s86, s5, 40
  s_add_u32 s85, s85, s86
  s_add_u32 s88, s85, 983040
  buffer_load_dwordx4 v[160:163], v224, s[12:15], s88 offen
  buffer_load_dwordx4 v[164:167], v225, s[12:15], s88 offen
  buffer_load_dwordx4 v[168:171], v226, s[12:15], s88 offen
  buffer_load_dwordx4 v[172:175], v227, s[12:15], s88 offen
  buffer_load_dwordx4 v[176:179], v228, s[12:15], s88 offen
  s_add_u32 s88, s85, 1474560
  buffer_load_dwordx4 v[180:183], v224, s[12:15], s88 offen
  buffer_load_dwordx4 v[184:187], v225, s[12:15], s88 offen
  buffer_load_dwordx4 v[188:191], v226, s[12:15], s88 offen
  buffer_load_dwordx4 v[192:195], v227, s[12:15], s88 offen
  buffer_load_dwordx4 v[196:199], v228, s[12:15], s88 offen
  s_add_u32 s88, s85, 1966080
  buffer_load_dwordx4 v[200:203], v224, s[12:15], s88 offen
  buffer_load_dwordx4 v[204:207], v225, s[12:15], s88 offen
  buffer_load_dwordx4 v[208:211], v226, s[12:15], s88 offen
  buffer_load_dwordx4 v[212:215], v227, s[12:15], s88 offen
  buffer_load_dwordx4 v[216:219], v228, s[12:15], s88 offen
NT_177:
  s_cmp_eq_u32 s42, 1
  s_cbranch_scc1 NB1_178
  s_waitcnt vmcnt(0)
  s_mul_i32 s84, s70, 5120
  s_mul_i32 s85, s70, 122880
  s_mul_i32 s86, s5, 40
  s_add_u32 s85, s85, s86
  s_add_u32 s88, s84, 0
  v_add_u32 v220, s88, v255
  ds_write_b128 v220, v[120:123] offset:0
  ds_write_b128 v220, v[124:127] offset:1024
  ds_write_b128 v220, v[128:131] offset:2048
  ds_write_b128 v220, v[132:135] offset:3072
  ds_write_b128 v220, v[136:139] offset:4096
  s_add_u32 s88, s84, 20480
  v_add_u32 v220, s88, v255
  ds_write_b128 v220, v[140:143] offset:0
  ds_write_b128 v220, v[144:147] offset:1024
  ds_write_b128 v220, v[148:151] offset:2048
  ds_write_b128 v220, v[152:155] offset:3072
  ds_write_b128 v220, v[156:159] offset:4096
  s_add_u32 s88, s84, 40960
  v_add_u32 v220, s88, v255
  ds_write_b128 v220, v[160:163] offset:0
  ds_write_b128 v220, v[164:167] offset:1024
  ds_write_b128 v220, v[168:171] offset:2048
  ds_write_b128 v220, v[172:175] offset:3072
  ds_write_b128 v220, v[176:179] offset:4096
  s_add_u32 s88, s84, 61440
  v_add_u32 v220, s88, v255
  ds_write_b128 v220, v[180:183] offset:0
  ds_write_b128 v220, v[184:187] offset:1024
  ds_write_b128 v220, v[188:191] offset:2048
  ds_write_b128 v220, v[192:195] offset:3072
  ds_write_b128 v220, v[196:199] offset:4096
  s_add_u32 s88, s84, 81920
  v_add_u32 v220, s88, v255
  ds_write_b128 v220, v[200:203] offset:0
  ds_write_b128 v220, v[204:207] offset:1024
  ds_write_b128 v220, v[208:211] offset:2048
  ds_write_b128 v220, v[212:215] offset:3072
  ds_write_b128 v220, v[216:219] offset:4096
  s_waitcnt lgkmcnt(0)
NB1_178:
  s_cmp_eq_u32 s42, 1
  s_cbranch_scc1 HEnd_181
  s_mov_b32 s42, 1
  s_cmp_eq_u32 s42, 0
  s_mov_b32 s84, 3145728
  s_cselect_b32 s43, 0, s84
  s_mov_b32 s84, 46268416
  s_cselect_b32 s44, 46137344, s84
  s_mov_b32 s84, 9437184
  s_cselect_b32 s45, 6291456, s84
  s_mov_b32 s84, 46530560
  s_cselect_b32 s46, 46399488, s84
  s_mov_b32 s84, 15728640
  s_cselect_b32 s47, 12582912, s84
  s_mov_b32 s84, 26214400
  s_cselect_b32 s48, 18874368, s84
  s_mov_b32 s84, 39845888
  s_cselect_b32 s49, 33554432, s84
  s_mov_b32 s84, 3145728
  s_cselect_b32 s50, 3145728, s84
  s_mov_b32 s84, 46268416
  s_cselect_b32 s51, 46268416, s84
  s_mov_b32 s84, 47218688
  s_cselect_b32 s52, 47185920, s84
  s_cmp_eq_u32 s6, 0
  s_cselect_b32 s43, 0, s43
  s_branch L_LOOP
HEnd_181:
  s_waitcnt vmcnt(0)
  s_endpgm
L_CS1:
  s_barrier
  s_cmp_ge_u32 s3, 4
  s_cbranch_scc1 P0F_34
  s_waitcnt vmcnt(0)
  s_lshl_b32 s54, s4, 9
  s_lshl_b32 s55, s5, 4
  s_add_u32 s54, s54, s55
  s_add_u32 s54, s54, s52
  s_add_u32 s54, s54, 0
  s_lshl_b32 s55, s3, 2
  s_add_u32 s54, s54, s55
  v_mov_b32 v220, s7
  v_lshlrev_b32 v221, 2, v254
  s_mov_b64 exec, 1
  buffer_store_dword v220, v221, s[8:11], s54 offen sc1
  s_mov_b64 exec, -1
P0F_34:
  s_mul_i32 s84, s3, 5120
  v_lshrrev_b32 v201, 2, v254
  v_mul_u32_u24 v201, 160, v201
  v_and_b32 v202, 3, v254
  v_mov_b32 v204, 40
  v_cmp_eq_u32 vcc, 1, v202
  v_mov_b32 v203, 96
  s_nop 0
  v_cndmask_b32 v204, v204, v203, vcc
  v_cmp_eq_u32 vcc, 2, v202
  v_mov_b32 v203, 104
  s_nop 0
  v_cndmask_b32 v204, v204, v203, vcc
  v_cmp_eq_u32 vcc, 3, v202
  v_mov_b32 v203, 112
  s_nop 0
  v_cndmask_b32 v204, v204, v203, vcc
  v_add_u32 v204, v204, v201
  v_mov_b32 v206, 88
  v_cmp_eq_u32 vcc, 1, v202
  v_mov_b32 v203, 120
  s_nop 0
  v_cndmask_b32 v206, v206, v203, vcc
  v_cmp_eq_u32 vcc, 2, v202
  v_mov_b32 v203, 136
  s_nop 0
  v_cndmask_b32 v206, v206, v203, vcc
  v_cmp_eq_u32 vcc, 3, v202
  v_mov_b32 v203, 144
  s_nop 0
  v_cndmask_b32 v206, v206, v203, vcc
  v_add_u32 v206, v206, v201
  v_mov_b32 v208, v253
  v_add_u32 v204, s84, v204
  v_add_u32 v206, s84, v206
  v_add_u32 v208, s84, v208
  v_add_u32 v205, 65536, v204
  v_add_u32 v207, 65536, v206
  v_add_u32 v209, 65536, v208
  v_mov_b32 v16, 0x3f803f80
  v_mov_b32 v17, 0x3f803f80
  v_mov_b32 v18, 0x3f803f80
  v_mov_b32 v19, 0x3f803f80
  ds_read_b64_tr_b16 v[32:33], v208 offset:0
  ds_read_b64_tr_b16 v[34:35], v208 offset:2560
  ds_read_b64_tr_b16 v[36:37], v204 offset:0
  ds_read_b64_tr_b16 v[38:39], v204 offset:2560
  ds_read_b64_tr_b16 v[40:41], v208 offset:48
  ds_read_b64_tr_b16 v[42:43], v208 offset:2608
  ds_read_b64_tr_b16 v[44:45], v206 offset:0
  ds_read_b64_tr_b16 v[46:47], v206 offset:2560
  s_waitcnt lgkmcnt(6)
  v_mfma_f32_16x16x32_bf16 v[0:3], v[32:35], v[16:19], 0
  s_waitcnt lgkmcnt(4)
  v_mfma_f32_16x16x32_bf16 v[4:7], v[36:39], v[16:19], 0
  s_waitcnt lgkmcnt(2)
  v_mfma_f32_16x16x32_bf16 v[8:11], v[40:43], v[16:19], 0
  s_waitcnt lgkmcnt(0)
  v_mfma_f32_16x16x32_bf16 v[12:15], v[44:47], v[16:19], 0
  ds_read_b64_tr_b16 v[48:49], v208 offset:40960
  ds_read_b64_tr_b16 v[50:51], v208 offset:43520
  ds_read_b64_tr_b16 v[52:53], v204 offset:40960
  ds_read_b64_tr_b16 v[54:55], v204 offset:43520
  ds_read_b64_tr_b16 v[56:57], v208 offset:41008
  ds_read_b64_tr_b16 v[58:59], v208 offset:43568
  ds_read_b64_tr_b16 v[60:61], v206 offset:40960
  ds_read_b64_tr_b16 v[62:63], v206 offset:43520
  s_waitcnt lgkmcnt(6)
  v_mfma_f32_16x16x32_bf16 v[0:3], v[48:51], v[16:19], v[0:3]
  s_waitcnt lgkmcnt(4)
  v_mfma_f32_16x16x32_bf16 v[4:7], v[52:55], v[16:19], v[4:7]
  s_waitcnt lgkmcnt(2)
  v_mfma_f32_16x16x32_bf16 v[8:11], v[56:59], v[16:19], v[8:11]
  s_waitcnt lgkmcnt(0)
  v_mfma_f32_16x16x32_bf16 v[12:15], v[60:63], v[16:19], v[12:15]
  s_cmp_ge_u32 s3, 4
  s_cbranch_scc1 CS_35
  ds_read_b64_tr_b16 v[32:33], v209 offset:16384
  ds_read_b64_tr_b16 v[34:35], v209 offset:18944
  ds_read_b64_tr_b16 v[36:37], v205 offset:16384
  ds_read_b64_tr_b16 v[38:39], v205 offset:18944
  ds_read_b64_tr_b16 v[40:41], v209 offset:16432
  ds_read_b64_tr_b16 v[42:43], v209 offset:18992
  ds_read_b64_tr_b16 v[44:45], v207 offset:16384
  ds_read_b64_tr_b16 v[46:47], v207 offset:18944
  s_waitcnt lgkmcnt(6)
  v_mfma_f32_16x16x32_bf16 v[0:3], v[32:35], v[16:19], v[0:3]
  s_waitcnt lgkmcnt(4)
  v_mfma_f32_16x16x32_bf16 v[4:7], v[36:39], v[16:19], v[4:7]
  s_waitcnt lgkmcnt(2)
  v_mfma_f32_16x16x32_bf16 v[8:11], v[40:43], v[16:19], v[8:11]
  s_waitcnt lgkmcnt(0)
  v_mfma_f32_16x16x32_bf16 v[12:15], v[44:47], v[16:19], v[12:15]
CS_35:
  s_nop 7
  v_lshrrev_b32 v200, 4, v254
  v_lshlrev_b32 v200, 4, v200
  s_lshl_b32 s84, s3, 8
  s_add_u32 s84, s84, 102400
  v_add_u32 v200, s84, v200
  v_and_b32 v201, 15, v254
  v_cmp_eq_u32 vcc, 0, v201
  s_nop 0
  s_and_saveexec_b64 s[86:87], vcc
  ds_write_b128 v200, v[0:3] offset:0
  ds_write_b128 v200, v[4:7] offset:64
  ds_write_b128 v200, v[8:11] offset:128
  ds_write_b128 v200, v[12:15] offset:192
  s_mov_b64 exec, s[86:87]
  s_waitcnt lgkmcnt(0)
  s_barrier
  s_cmp_lg_u32 s3, 0
  s_cbranch_scc1 CS_36
  v_lshlrev_b32 v200, 2, v254
  v_add_u32 v201, 102400, v200
  ds_read_b32 v8, v201 offset:0
  ds_read_b32 v9, v201 offset:256
  ds_read_b32 v10, v201 offset:512
  ds_read_b32 v11, v201 offset:768
  ds_read_b32 v12, v201 offset:1024
  ds_read_b32 v13, v201 offset:1280
  ds_read_b32 v14, v201 offset:1536
  ds_read_b32 v15, v201 offset:1792
  s_waitcnt lgkmcnt(0)
  v_add_f32 v8, v8, v9
  v_add_f32 v10, v10, v11
  v_add_f32 v12, v12, v13
  v_add_f32 v14, v14, v15
  v_add_f32 v8, v8, v10
  v_add_f32 v12, v12, v14
  v_add_f32 v8, v8, v12
  v_add_u32 v200, 161536, v200
  ds_write_b32 v200, v8
  s_waitcnt lgkmcnt(0)
CS_36:
L_LOOP:
  s_sub_u32 s64, 7, s3
  s_sub_u32 s84, s3, 4
  s_cmp_lt_u32 s3, 4
  s_cselect_b32 s64, s64, s84
  s_cselect_b32 s69, 1, 0
  s_add_u32 s65, s42, 1
  s_mov_b32 s66, 0x41000000
  s_lshl_b32 s94, s4, 4
  s_lshl_b32 s88, s64, 1
  s_add_u32 s94, s94, s88
  s_add_u32 s88, s94, 0
  s_mul_i32 s92, s88, 20480
  s_add_u32 s92, s92, s43
  s_add_u32 s88, s94, 1
  s_mul_i32 s93, s88, 20480
  s_add_u32 s93, s93, s43
  v_lshrrev_b32 v200, 4, v254
  v_lshlrev_b32 v200, 8, v200
  v_and_b32 v220, 15, v254
  v_lshlrev_b32 v220, 3, v220
  v_add_u32 v200, v200, v220
  v_lshrrev_b32 v201, 2, v254
  v_mul_u32_u24 v201, 160, v201
  v_and_b32 v202, 3, v254
  v_mov_b32 v204, 40
  v_cmp_eq_u32 vcc, 1, v202
  v_mov_b32 v203, 96
  s_nop 0
  v_cndmask_b32 v204, v204, v203, vcc
  v_cmp_eq_u32 vcc, 2, v202
  v_mov_b32 v203, 104
  s_nop 0
  v_cndmask_b32 v204, v204, v203, vcc
  v_cmp_eq_u32 vcc, 3, v202
  v_mov_b32 v203, 112
  s_nop 0
  v_cndmask_b32 v204, v204, v203, vcc
  v_add_u32 v204, v204, v201
  v_mov_b32 v206, 88
  v_cmp_eq_u32 vcc, 1, v202
  v_mov_b32 v203, 120
  s_nop 0
  v_cndmask_b32 v206, v206, v203, vcc
  v_cmp_eq_u32 vcc, 2, v202
  v_mov_b32 v203, 136
  s_nop 0
  v_cndmask_b32 v206, v206, v203, vcc
  v_cmp_eq_u32 vcc, 3, v202
  v_mov_b32 v203, 144
  s_nop 0
  v_cndmask_b32 v206, v206, v203, vcc
  v_add_u32 v206, v206, v201
  v_mov_b32 v208, v253
  v_add_u32 v205, 65536, v204
  v_add_u32 v207, 65536, v206
  v_add_u32 v209, 65536, v208
  v_cmp_gt_u32 s[72:73], 16, v254
  v_cmp_le_u32 s[74:75], 48, v254
  v_lshrrev_b32 v100, 4, v254
  v_lshlrev_b32 v100, 2, v100
  v_and_b32 v101, 15, v254
  v_add_u32 v102, 0, v100
  v_cmp_le_u32 s[76:77], v102, v101
  v_add_u32 v102, 1, v100
  v_cmp_le_u32 s[78:79], v102, v101
  v_add_u32 v102, 2, v100
  v_cmp_le_u32 s[80:81], v102, v101
  v_add_u32 v102, 3, v100
  v_cmp_le_u32 s[82:83], v102, v101
  s_lshl_b32 s88, s64, 1
  s_add_u32 s89, s88, 16
  s_mul_i32 s89, s89, 1536
  s_add_u32 s89, s89, 102400
  v_add_u32 v210, s89, v255
  v_lshlrev_b32 v213, 3, v254
  v_add_u32 v211, s89, v213
  s_lshl_b32 s95, s4, 5
  s_add_u32 s95, s95, s5
  s_mul_i32 s95, s95, 24576
  s_add_u32 s95, s95, s49
  s_mul_i32 s91, s64, 3072
  s_add_u32 s95, s95, s91
  v_lshrrev_b32 v214, 4, v254
  v_lshlrev_b32 v214, 4, v214
  v_add_u32 v214, 161536, v214
  v_add_u32 v100, 0, v254
  v_mul_u32_u24 v101, 6554, v100
  v_lshrrev_b32 v101, 16, v101
  v_mul_u32_u24 v102, 10, v101
  v_sub_u32 v102, v100, v102
  v_lshlrev_b32 v102, 4, v102
  v_lshrrev_b32 v103, 4, v101
  v_lshlrev_b32 v104, 2, v103
  v_add_u32 v104, v104, v101
  v_mul_u32_u24 v104, 1280, v104
  v_add_u32 v229, v104, v102
  v_mul_u32_u24 v103, 80, v103
  v_bfe_u32 v104, v101, 2, 2
  v_mul_u32_u24 v104, 20, v104
  v_and_b32 v105, 3, v101
  v_add3_u32 v103, v103, v104, v105
  v_add_u32 v103, 16, v103
  v_mul_u32_u24 v103, 1280, v103
  v_add_u32 v234, v103, v102
  v_add_u32 v100, 64, v254
  v_mul_u32_u24 v101, 6554, v100
  v_lshrrev_b32 v101, 16, v101
  v_mul_u32_u24 v102, 10, v101
  v_sub_u32 v102, v100, v102
  v_lshlrev_b32 v102, 4, v102
  v_lshrrev_b32 v103, 4, v101
  v_lshlrev_b32 v104, 2, v103
  v_add_u32 v104, v104, v101
  v_mul_u32_u24 v104, 1280, v104
  v_add_u32 v230, v104, v102
  v_mul_u32_u24 v103, 80, v103
  v_bfe_u32 v104, v101, 2, 2
  v_mul_u32_u24 v104, 20, v104
  v_and_b32 v105, 3, v101
  v_add3_u32 v103, v103, v104, v105
  v_add_u32 v103, 16, v103
  v_mul_u32_u24 v103, 1280, v103
  v_add_u32 v235, v103, v102
  v_add_u32 v100, 128, v254
  v_mul_u32_u24 v101, 6554, v100
  v_lshrrev_b32 v101, 16, v101
  v_mul_u32_u24 v102, 10, v101
  v_sub_u32 v102, v100, v102
  v_lshlrev_b32 v102, 4, v102
  v_lshrrev_b32 v103, 4, v101
  v_lshlrev_b32 v104, 2, v103
  v_add_u32 v104, v104, v101
  v_mul_u32_u24 v104, 1280, v104
  v_add_u32 v231, v104, v102
  v_mul_u32_u24 v103, 80, v103
  v_bfe_u32 v104, v101, 2, 2
  v_mul_u32_u24 v104, 20, v104
  v_and_b32 v105, 3, v101
  v_add3_u32 v103, v103, v104, v105
  v_add_u32 v103, 16, v103
  v_mul_u32_u24 v103, 1280, v103
  v_add_u32 v236, v103, v102
  v_add_u32 v100, 192, v254
  v_mul_u32_u24 v101, 6554, v100
  v_lshrrev_b32 v101, 16, v101
  v_mul_u32_u24 v102, 10, v101
  v_sub_u32 v102, v100, v102
  v_lshlrev_b32 v102, 4, v102
  v_lshrrev_b32 v103, 4, v101
  v_lshlrev_b32 v104, 2, v103
  v_add_u32 v104, v104, v101
  v_mul_u32_u24 v104, 1280, v104
  v_add_u32 v232, v104, v102
  v_mul_u32_u24 v103, 80, v103
  v_bfe_u32 v104, v101, 2, 2
  v_mul_u32_u24 v104, 20, v104
  v_and_b32 v105, 3, v101
  v_add3_u32 v103, v103, v104, v105
  v_add_u32 v103, 16, v103
  v_mul_u32_u24 v103, 1280, v103
  v_add_u32 v237, v103, v102
  v_add_u32 v100, 256, v254
  v_mul_u32_u24 v101, 6554, v100
  v_lshrrev_b32 v101, 16, v101
  v_mul_u32_u24 v102, 10, v101
  v_sub_u32 v102, v100, v102
  v_lshlrev_b32 v102, 4, v102
  v_lshrrev_b32 v103, 4, v101
  v_lshlrev_b32 v104, 2, v103
  v_add_u32 v104, v104, v101
  v_mul_u32_u24 v104, 1280, v104
  v_add_u32 v233, v104, v102
  v_mul_u32_u24 v103, 80, v103
  v_bfe_u32 v104, v101, 2, 2
  v_mul_u32_u24 v104, 20, v104
  v_and_b32 v105, 3, v101
  v_add3_u32 v103, v103, v104, v105
  v_add_u32 v103, 16, v103
  v_mul_u32_u24 v103, 1280, v103
  v_add_u32 v238, v103, v102
  v_lshrrev_b32 v100, 2, v254
  v_and_b32 v101, 3, v254
  v_add_u32 v102, 1, v101
  v_lshlrev_b32 v102, 4, v102
  v_add_u32 v102, v102, v100
  v_lshlrev_b32 v102, 3, v102
  v_add_u32 v102, 1024, v102
  v_add_u32 v103, 16, v100
  v_lshlrev_b32 v103, 4, v103
  v_add_u32 v103, 8, v103
  v_cmp_eq_u32 vcc, 3, v101
  s_nop 1
  v_cndmask_b32 v192, v102, v103, vcc
  v_add_u32 v102, 32, v100
  v_lshlrev_b32 v102, 4, v102
  v_add_u32 v102, 8, v102
  v_add_u32 v103, 256, v102
  v_cmp_eq_u32 vcc, 0, v101
  s_nop 1
  v_cndmask_b32 v193, v103, v102, vcc
  s_cmp_lg_u32 s3, 0
  s_cbranch_scc1 NS_37
  s_lshl_b32 s62, s4, 9
  s_add_u32 s62, s62, s52
  s_add_u32 s62, s62, 0
  v_lshlrev_b32 v221, 2, v254
  s_mov_b32 s58, 0
POLL_38:
  buffer_load_dword v220, v221, s[8:11], s62 offen sc1
  buffer_load_dword v219, v221, s[8:11], s62 offen offset:256 sc1
  s_waitcnt vmcnt(0)
  v_cmp_ne_u32 vcc, s7, v220
  v_cmp_ne_u32 s[60:61], s7, v219
  s_nop 1
  s_or_b64 vcc, vcc, s[60:61]
  s_add_u32 s58, s58, 1
  s_cmp_eq_u64 vcc, 0
  s_cbranch_scc1 POLLD_39
  s_cmp_lt_u32 s58, 0x200000
  s_cbranch_scc1 POLL_38
  v_mov_b32 v220, 1
  v_mov_b32 v221, 8
  s_mov_b32 s28, s40
  s_and_b32 s29, s41, 0xffff
  s_mov_b32 s30, 256
  s_mov_b32 s31, 0x20000
  s_mov_b64 exec, 1
  buffer_store_dword v220, v221, s[28:31], 0 offen
POLLD_39:
  s_mov_b64 exec, -1
NS_37:
  s_barrier
  s_mov_b32 s56, s92
  s_mov_b32 s57, s93
  s_setprio 1
  s_cmp_eq_u32 s69, 0
  s_cbranch_scc1 PR_40
  s_setprio 3
PR_40:
  s_add_u32 s88, s94, 0
  s_lshl_b32 s85, s88, 10
  s_add_u32 s85, s85, s44
  buffer_load_dwordx2 v[128:129], v200, s[8:11], s85 offen sc1
  buffer_load_dwordx2 v[130:131], v200, s[8:11], s85 offen offset:128 sc1
  s_add_u32 s88, s94, 1
  s_lshl_b32 s85, s88, 10
  s_add_u32 s85, s85, s44
  buffer_load_dwordx2 v[132:133], v200, s[8:11], s85 offen sc1
  buffer_load_dwordx2 v[134:135], v200, s[8:11], s85 offen offset:128 sc1
  s_cmp_lg_u32 s3, 7
  s_cbranch_scc1 NMR_41
  s_cmp_lg_u32 s42, 0
  s_cbranch_scc1 NMR_41
  s_cmp_lg_u32 s6, 0
  s_cbranch_scc1 MD_42
  s_mov_b32 s28, s40
  s_and_b32 s29, s41, 0xffff
  s_mov_b32 s30, 256
  s_mov_b32 s31, 0x20000
  s_mov_b32 s90, 0
ML_43:
  s_mov_b64 exec, 0xff
  v_lshlrev_b32 v40, 5, v254
  buffer_load_dwordx2 v[42:43], v40, s[28:31], 0 offen sc1
  s_waitcnt vmcnt(0)
  v_bcnt_u32_b32 v44, v42, v43
  s_mov_b64 exec, -1
  s_mov_b32 s89, 0
  v_readlane_b32 s88, v44, 0
  s_nop 0
  s_add_u32 s89, s89, s88
  v_readlane_b32 s88, v44, 1
  s_nop 0
  s_add_u32 s89, s89, s88
  v_readlane_b32 s88, v44, 2
  s_nop 0
  s_add_u32 s89, s89, s88
  v_readlane_b32 s88, v44, 3
  s_nop 0
  s_add_u32 s89, s89, s88
  v_readlane_b32 s88, v44, 4
  s_nop 0
  s_add_u32 s89, s89, s88
  v_readlane_b32 s88, v44, 5
  s_nop 0
  s_add_u32 s89, s89, s88
  v_readlane_b32 s88, v44, 6
  s_nop 0
  s_add_u32 s89, s89, s88
  v_readlane_b32 s88, v44, 7
  s_nop 0
  s_add_u32 s89, s89, s88
  v_readlane_b32 s88, v42, s4
  s_nop 0
  s_cmp_eq_u32 s88, -1
  s_cbranch_scc1 MD_42
  s_add_u32 s90, s90, 1
  s_cmp_ge_u32 s89, 256
  s_cselect_b32 s6, 1, 0
  s_cbranch_scc1 MD_42
  s_cmp_lt_u32 s90, 0x100000
  s_cbranch_scc1 ML_43
  s_mov_b32 s6, 1
MD_42:
  s_mov_b64 exec, 1
  v_mov_b32 v40, 161812
  s_add_u32 s88, s6, 1
  v_mov_b32 v41, s88
  ds_write_b32 v40, v41
  s_waitcnt lgkmcnt(0)
  s_mov_b64 exec, -1
  s_lshl_b32 s85, s4, 9
  v_lshlrev_b32 v198, 3, v254
  s_add_u32 s86, s85, 47190016
  buffer_load_dword v199, v198, s[8:11], s86 offen
  s_add_u32 s86, s85, 47194112
  buffer_load_dword v199, v198, s[8:11], s86 offen
  s_add_u32 s86, s85, 47198208
  buffer_load_dword v199, v198, s[8:11], s86 offen
  s_add_u32 s86, s85, 47218688
  buffer_load_dword v199, v198, s[8:11], s86 offen
  s_add_u32 s86, s85, 47222784
  buffer_load_dword v199, v198, s[8:11], s86 offen
  s_add_u32 s86, s85, 47226880
  buffer_load_dword v199, v198, s[8:11], s86 offen
  s_add_u32 s86, s85, 47230976
  buffer_load_dword v199, v198, s[8:11], s86 offen
NMR_41:
  s_cmp_lg_u32 s69, 0
  s_cbranch_scc1 NRP_44
  s_cmp_lg_u32 s42, 0
  s_cbranch_scc1 NRP_44
  v_lshrrev_b32 v64, 1, v254
  v_and_b32 v65, 1, v254
  v_lshlrev_b32 v65, 4, v65
  v_mul_u32_u24 v66, 3456, v64
  v_add_u32 v66, v66, v65
  v_mul_u32_u24 v67, 1280, v64
  v_add_u32 v67, v67, v65
  v_lshrrev_b32 v70, 4, v64
  v_lshlrev_b32 v68, 2, v70
  v_add_u32 v68, v68, v64
  v_mul_u32_u24 v68, 1280, v68
  v_add_u32 v68, v68, v65
  v_mul_u32_u24 v69, 80, v70
  v_bfe_u32 v71, v64, 2, 2
  v_mul_u32_u24 v71, 20, v71
  v_and_b32 v72, 3, v64
  v_add3_u32 v69, v69, v71, v72
  v_add_u32 v69, 16, v69
  v_mul_u32_u24 v69, 1280, v69
  v_add_u32 v69, v69, v65
  s_lshl_b32 s84, s4, 5
  s_add_u32 s84, s84, s5
  s_mul_i32 s84, s84, 20
  s_sub_u32 s85, s3, 4
  s_mul_i32 s86, s85, 5
  s_add_u32 s84, s84, s86
  s_mul_i32 s88, s85, 5120
  s_add_u32 s88, s88, 102400
  s_add_u32 s89, s84, 0
  s_add_u32 m0, s88, 0
  s_cmp_ge_u32 s89, 2160
  s_cbranch_scc1 RP2_45
  s_mul_hi_u32 s85, s89, 39768216
  s_mul_i32 s86, s85, 108
  s_sub_u32 s86, s89, s86
  s_mul_i32 s87, s85, 110592
  s_lshl_b32 s86, s86, 5
  s_add_u32 s87, s87, s86
  s_lshl_b32 s97, s89, 10
  s_add_u32 s97, s97, 50331648
  buffer_load_dwordx4 v66, s[20:23], s87 offen lds
  s_branch RPE_48
RP2_45:
  s_cmp_ge_u32 s89, 4320
  s_cbranch_scc1 RP3_46
  s_sub_u32 s89, s89, 2160
  s_mul_hi_u32 s85, s89, 107374183
  s_mul_i32 s86, s85, 40
  s_sub_u32 s86, s89, s86
  s_mul_i32 s87, s85, 40960
  s_lshl_b32 s86, s86, 5
  s_add_u32 s87, s87, s86
  s_lshl_b32 s97, s89, 10
  s_add_u32 s97, s97, 53477376
  buffer_load_dwordx4 v67, s[24:27], s87 offen lds
  s_branch RPE_48
RP3_46:
  s_sub_u32 s89, s89, 4320
  s_mul_hi_u32 s85, s89, 107374183
  s_mul_i32 s86, s85, 40
  s_sub_u32 s86, s89, s86
  s_lshl_b32 s97, s89, 10
  s_add_u32 s97, s97, 56623104
  s_lshl_b32 s86, s86, 5
  s_cmp_ge_u32 s85, 16
  s_cbranch_scc1 RP4_47
  s_mul_i32 s87, s85, 51200
  s_add_u32 s87, s87, s86
  buffer_load_dwordx4 v68, s[16:19], s87 offen lds
  s_branch RPE_48
RP4_47:
  s_sub_u32 s85, s85, 16
  s_mul_i32 s87, s85, 204800
  s_add_u32 s87, s87, s86
  buffer_load_dwordx4 v69, s[16:19], s87 offen lds
RPE_48:
  s_add_u32 s89, s84, 1
  s_add_u32 m0, s88, 1024
  s_cmp_ge_u32 s89, 2160
  s_cbranch_scc1 RP2_49
  s_mul_hi_u32 s85, s89, 39768216
  s_mul_i32 s86, s85, 108
  s_sub_u32 s86, s89, s86
  s_mul_i32 s87, s85, 110592
  s_lshl_b32 s86, s86, 5
  s_add_u32 s87, s87, s86
  s_lshl_b32 s98, s89, 10
  s_add_u32 s98, s98, 50331648
  buffer_load_dwordx4 v66, s[20:23], s87 offen lds
  s_branch RPE_52
RP2_49:
  s_cmp_ge_u32 s89, 4320
  s_cbranch_scc1 RP3_50
  s_sub_u32 s89, s89, 2160
  s_mul_hi_u32 s85, s89, 107374183
  s_mul_i32 s86, s85, 40
  s_sub_u32 s86, s89, s86
  s_mul_i32 s87, s85, 40960
  s_lshl_b32 s86, s86, 5
  s_add_u32 s87, s87, s86
  s_lshl_b32 s98, s89, 10
  s_add_u32 s98, s98, 53477376
  buffer_load_dwordx4 v67, s[24:27], s87 offen lds
  s_branch RPE_52
RP3_50:
  s_sub_u32 s89, s89, 4320
  s_mul_hi_u32 s85, s89, 107374183
  s_mul_i32 s86, s85, 40
  s_sub_u32 s86, s89, s86
  s_lshl_b32 s98, s89, 10
  s_add_u32 s98, s98, 56623104
  s_lshl_b32 s86, s86, 5
  s_cmp_ge_u32 s85, 16
  s_cbranch_scc1 RP4_51
  s_mul_i32 s87, s85, 51200
  s_add_u32 s87, s87, s86
  buffer_load_dwordx4 v68, s[16:19], s87 offen lds
  s_branch RPE_52
RP4_51:
  s_sub_u32 s85, s85, 16
  s_mul_i32 s87, s85, 204800
  s_add_u32 s87, s87, s86
  buffer_load_dwordx4 v69, s[16:19], s87 offen lds
RPE_52:
  s_add_u32 s89, s84, 2
  s_add_u32 m0, s88, 2048
  s_cmp_ge_u32 s89, 2160
  s_cbranch_scc1 RP2_53
  s_mul_hi_u32 s85, s89, 39768216
  s_mul_i32 s86, s85, 108
  s_sub_u32 s86, s89, s86
  s_mul_i32 s87, s85, 110592
  s_lshl_b32 s86, s86, 5
  s_add_u32 s87, s87, s86
  s_lshl_b32 s99, s89, 10
  s_add_u32 s99, s99, 50331648
  buffer_load_dwordx4 v66, s[20:23], s87 offen lds
  s_branch RPE_56
RP2_53:
  s_cmp_ge_u32 s89, 4320
  s_cbranch_scc1 RP3_54
  s_sub_u32 s89, s89, 2160
  s_mul_hi_u32 s85, s89, 107374183
  s_mul_i32 s86, s85, 40
  s_sub_u32 s86, s89, s86
  s_mul_i32 s87, s85, 40960
  s_lshl_b32 s86, s86, 5
  s_add_u32 s87, s87, s86
  s_lshl_b32 s99, s89, 10
  s_add_u32 s99, s99, 53477376
  buffer_load_dwordx4 v67, s[24:27], s87 offen lds
  s_branch RPE_56
RP3_54:
  s_sub_u32 s89, s89, 4320
  s_mul_hi_u32 s85, s89, 107374183
  s_mul_i32 s86, s85, 40
  s_sub_u32 s86, s89, s86
  s_lshl_b32 s99, s89, 10
  s_add_u32 s99, s99, 56623104
  s_lshl_b32 s86, s86, 5
  s_cmp_ge_u32 s85, 16
  s_cbranch_scc1 RP4_55
  s_mul_i32 s87, s85, 51200
  s_add_u32 s87, s87, s86
  buffer_load_dwordx4 v68, s[16:19], s87 offen lds
  s_branch RPE_56
RP4_55:
  s_sub_u32 s85, s85, 16
  s_mul_i32 s87, s85, 204800
  s_add_u32 s87, s87, s86
  buffer_load_dwordx4 v69, s[16:19], s87 offen lds
RPE_56:
  s_add_u32 s89, s84, 3
  s_add_u32 m0, s88, 3072
  s_cmp_ge_u32 s89, 2160
  s_cbranch_scc1 RP2_57
  s_mul_hi_u32 s85, s89, 39768216
  s_mul_i32 s86, s85, 108
  s_sub_u32 s86, s89, s86
  s_mul_i32 s87, s85, 110592
  s_lshl_b32 s86, s86, 5
  s_add_u32 s87, s87, s86
  s_lshl_b32 s100, s89, 10
  s_add_u32 s100, s100, 50331648
  buffer_load_dwordx4 v66, s[20:23], s87 offen lds
  s_branch RPE_60
RP2_57:
  s_cmp_ge_u32 s89, 4320
  s_cbranch_scc1 RP3_58
  s_sub_u32 s89, s89, 2160
  s_mul_hi_u32 s85, s89, 107374183
  s_mul_i32 s86, s85, 40
  s_sub_u32 s86, s89, s86
  s_mul_i32 s87, s85, 40960
  s_lshl_b32 s86, s86, 5
  s_add_u32 s87, s87, s86
  s_lshl_b32 s100, s89, 10
  s_add_u32 s100, s100, 53477376
  buffer_load_dwordx4 v67, s[24:27], s87 offen lds
  s_branch RPE_60
RP3_58:
  s_sub_u32 s89, s89, 4320
  s_mul_hi_u32 s85, s89, 107374183
  s_mul_i32 s86, s85, 40
  s_sub_u32 s86, s89, s86
  s_lshl_b32 s100, s89, 10
  s_add_u32 s100, s100, 56623104
  s_lshl_b32 s86, s86, 5
  s_cmp_ge_u32 s85, 16
  s_cbranch_scc1 RP4_59
  s_mul_i32 s87, s85, 51200
  s_add_u32 s87, s87, s86
  buffer_load_dwordx4 v68, s[16:19], s87 offen lds
  s_branch RPE_60
RP4_59:
  s_sub_u32 s85, s85, 16
  s_mul_i32 s87, s85, 204800
  s_add_u32 s87, s87, s86
  buffer_load_dwordx4 v69, s[16:19], s87 offen lds
RPE_60:
  s_add_u32 s89, s84, 4
  s_add_u32 m0, s88, 4096
  s_cmp_ge_u32 s89, 2160
  s_cbranch_scc1 RP2_61
  s_mul_hi_u32 s85, s89, 39768216
  s_mul_i32 s86, s85, 108
  s_sub_u32 s86, s89, s86
  s_mul_i32 s87, s85, 110592
  s_lshl_b32 s86, s86, 5
  s_add_u32 s87, s87, s86
  s_lshl_b32 s101, s89, 10
  s_add_u32 s101, s101, 50331648
  buffer_load_dwordx4 v66, s[20:23], s87 offen lds
  s_branch RPE_64
RP2_61:
  s_cmp_ge_u32 s89, 4320
  s_cbranch_scc1 RP3_62
  s_sub_u32 s89, s89, 2160
  s_mul_hi_u32 s85, s89, 107374183
  s_mul_i32 s86, s85, 40
  s_sub_u32 s86, s89, s86
  s_mul_i32 s87, s85, 40960
  s_lshl_b32 s86, s86, 5
  s_add_u32 s87, s87, s86
  s_lshl_b32 s101, s89, 10
  s_add_u32 s101, s101, 53477376
  buffer_load_dwordx4 v67, s[24:27], s87 offen lds
  s_branch RPE_64
RP3_62:
  s_sub_u32 s89, s89, 4320
  s_mul_hi_u32 s85, s89, 107374183
  s_mul_i32 s86, s85, 40
  s_sub_u32 s86, s89, s86
  s_lshl_b32 s101, s89, 10
  s_add_u32 s101, s101, 56623104
  s_lshl_b32 s86, s86, 5
  s_cmp_ge_u32 s85, 16
  s_cbranch_scc1 RP4_63
  s_mul_i32 s87, s85, 51200
  s_add_u32 s87, s87, s86
  buffer_load_dwordx4 v68, s[16:19], s87 offen lds
  s_branch RPE_64
RP4_63:
  s_sub_u32 s85, s85, 16
  s_mul_i32 s87, s85, 204800
  s_add_u32 s87, s87, s86
  buffer_load_dwordx4 v69, s[16:19], s87 offen lds
RPE_64:
  v_lshrrev_b32 v70, 2, v254
  v_lshlrev_b32 v70, 5, v70
  v_and_b32 v71, 3, v254
  v_lshlrev_b32 v71, 3, v71
  v_add3_u32 v70, v70, v71, s88
  s_waitcnt vmcnt(0)
  ds_read_b64_tr_b16 v[76:77], v70 offset:0
  ds_read_b64_tr_b16 v[78:79], v70 offset:512
  ds_read_b64_tr_b16 v[80:81], v70 offset:1024
  ds_read_b64_tr_b16 v[82:83], v70 offset:1536
  ds_read_b64_tr_b16 v[84:85], v70 offset:2048
  ds_read_b64_tr_b16 v[86:87], v70 offset:2560
  ds_read_b64_tr_b16 v[88:89], v70 offset:3072
  ds_read_b64_tr_b16 v[90:91], v70 offset:3584
  ds_read_b64_tr_b16 v[92:93], v70 offset:4096
  ds_read_b64_tr_b16 v[94:95], v70 offset:4608
  s_waitcnt lgkmcnt(0)
  buffer_store_dwordx4 v[76:79], v255, s[8:11], s97 offen sc1
  buffer_store_dwordx4 v[80:83], v255, s[8:11], s98 offen sc1
  buffer_store_dwordx4 v[84:87], v255, s[8:11], s99 offen sc1
  buffer_store_dwordx4 v[88:91], v255, s[8:11], s100 offen sc1
  buffer_store_dwordx4 v[92:95], v255, s[8:11], s101 offen sc1
  s_sub_u32 s84, s3, 4
  s_lshl_b32 s84, s84, 2
  s_add_u32 s84, s84, 161952
  s_mov_b64 exec, 1
  v_mov_b32 v70, s84
  v_mov_b32 v71, 1
  ds_write_b32 v70, v71
  s_mov_b64 exec, -1
  s_waitcnt vmcnt(0) lgkmcnt(0)
  s_lshl_b32 s85, s4, 5
  s_add_u32 s85, s85, s5
  s_lshl_b32 s85, s85, 4
  s_add_u32 s85, s85, s84
  s_sub_u32 s85, s85, 161952
  s_add_u32 s85, s85, 47382528
  v_mov_b32 v70, s7
  v_mov_b32 v71, 0
  s_mov_b64 exec, 1
  buffer_store_dword v70, v71, s[8:11], s85 offen sc1
  s_mov_b64 exec, -1
NRP_44:
  s_cmp_lg_u32 s69, 0
  s_cbranch_scc1 NG_65
  s_mov_b32 s92, 161904
  v_mov_b32 v220, s92
  s_mov_b32 s90, 0
LW_66:
  ds_read_b128 v[216:219], v220
  s_waitcnt lgkmcnt(0)
  v_min_u32 v216, v216, v217
  v_min_u32 v218, v218, v219
  v_min_u32 v216, v216, v218
  s_nop 0
  v_readfirstlane_b32 s91, v216
  s_add_u32 s90, s90, 1
  s_cmp_ge_u32 s91, s65
  s_cbranch_scc1 LWD_67
  s_sleep 1
  s_cmp_lt_u32 s90, 0x400000
  s_cbranch_scc1 LW_66
LWD_67:
NG_65:
  s_add_u32 s58, s56, 0
  buffer_load_dwordx4 v[64:67], v255, s[8:11], s58 offen offset:0 sc1
  s_add_u32 s59, s57, 0
  buffer_load_dwordx4 v[68:71], v255, s[8:11], s59 offen offset:0 sc1
  buffer_load_dwordx4 v[72:75], v255, s[8:11], s58 offen offset:1024 sc1
  buffer_load_dwordx4 v[76:79], v255, s[8:11], s59 offen offset:1024 sc1
  buffer_load_dwordx4 v[80:83], v255, s[8:11], s58 offen offset:2048 sc1
  buffer_load_dwordx4 v[84:87], v255, s[8:11], s59 offen offset:2048 sc1
  buffer_load_dwordx4 v[88:91], v255, s[8:11], s58 offen offset:3072 sc1
  buffer_load_dwordx4 v[92:95], v255, s[8:11], s59 offen offset:3072 sc1
  s_add_u32 s58, s56, 4096
  buffer_load_dwordx4 v[96:99], v255, s[8:11], s58 offen offset:0 sc1
  s_add_u32 s59, s57, 4096
  buffer_load_dwordx4 v[100:103], v255, s[8:11], s59 offen offset:0 sc1
  buffer_load_dwordx4 v[104:107], v255, s[8:11], s58 offen offset:1024 sc1
  buffer_load_dwordx4 v[108:111], v255, s[8:11], s59 offen offset:1024 sc1
  buffer_load_dwordx4 v[112:115], v255, s[8:11], s58 offen offset:2048 sc1
  buffer_load_dwordx4 v[116:119], v255, s[8:11], s59 offen offset:2048 sc1
  buffer_load_dwordx4 v[120:123], v255, s[8:11], s58 offen offset:3072 sc1
  buffer_load_dwordx4 v[124:127], v255, s[8:11], s59 offen offset:3072 sc1
  ds_read_b64_tr_b16 v[32:33], v208 offset:0
  ds_read_b64_tr_b16 v[34:35], v208 offset:2560
  ds_read_b64_tr_b16 v[36:37], v204 offset:0
  ds_read_b64_tr_b16 v[38:39], v204 offset:2560
  ds_read_b64_tr_b16 v[40:41], v208 offset:48
  ds_read_b64_tr_b16 v[42:43], v208 offset:2608
  ds_read_b64_tr_b16 v[44:45], v206 offset:0
  ds_read_b64_tr_b16 v[46:47], v206 offset:2560
  ds_read_b64_tr_b16 v[48:49], v208 offset:5120
  ds_read_b64_tr_b16 v[50:51], v208 offset:7680
  ds_read_b64_tr_b16 v[52:53], v204 offset:5120
  ds_read_b64_tr_b16 v[54:55], v204 offset:7680
  ds_read_b64_tr_b16 v[56:57], v208 offset:5168
  ds_read_b64_tr_b16 v[58:59], v208 offset:7728
  s_lshl_b32 s84, s4, 4
  s_lshl_b32 s85, s64, 1
  s_add_u32 s84, s84, s85
  s_mul_i32 s84, s84, 20480
  s_add_u32 s84, s84, s47
  s_lshr_b32 s85, s5, 1
  s_lshl_b32 s85, s85, 10
  s_and_b32 s86, s5, 1
  s_lshl_b32 s86, s86, 3
  s_add_u32 s85, s85, s86
  s_add_u32 s85, s85, s84
  s_lshr_b32 s86, s5, 3
  s_add_u32 s86, s86, 16
  s_lshl_b32 s86, s86, 10
  s_and_b32 s87, s5, 3
  s_lshl_b32 s87, s87, 8
  s_add_u32 s86, s86, s87
  s_bfe_u32 s87, s5, 0x10002
  s_lshl_b32 s87, s87, 3
  s_add_u32 s86, s86, s87
  s_add_u32 s86, s86, s84
  s_add_u32 s87, s85, 20480
  s_add_u32 s88, s86, 20480
  buffer_load_dword v217, v255, s[8:11], s85 offen
  buffer_load_dword v217, v255, s[8:11], s87 offen
  s_mov_b64 exec, 0xffff
  buffer_load_dword v217, v255, s[8:11], s86 offen
  buffer_load_dword v217, v255, s[8:11], s88 offen
  s_mov_b64 exec, -1
  s_waitcnt vmcnt(19) lgkmcnt(12)
  v_mfma_f32_16x16x32_bf16 v[0:3], v[32:35], v[64:67], 0
  ds_read_b64_tr_b16 v[60:61], v206 offset:5120
  ds_read_b64_tr_b16 v[62:63], v206 offset:7680
  s_waitcnt vmcnt(18)
  v_mfma_f32_16x16x32_bf16 v[4:7], v[32:35], v[68:71], 0
  s_waitcnt lgkmcnt(12)
  v_mfma_f32_16x16x32_bf16 v[8:11], v[36:39], v[64:67], 0
  ds_read_b64_tr_b16 v[32:33], v208 offset:10240
  ds_read_b64_tr_b16 v[34:35], v208 offset:12800
  v_mfma_f32_16x16x32_bf16 v[12:15], v[36:39], v[68:71], 0
  s_waitcnt lgkmcnt(12)
  v_mfma_f32_16x16x32_bf16 v[16:19], v[40:43], v[64:67], 0
  ds_read_b64_tr_b16 v[36:37], v204 offset:10240
  ds_read_b64_tr_b16 v[38:39], v204 offset:12800
  v_mfma_f32_16x16x32_bf16 v[20:23], v[40:43], v[68:71], 0
  s_waitcnt lgkmcnt(12)
  v_mfma_f32_16x16x32_bf16 v[24:27], v[44:47], v[64:67], 0
  ds_read_b64_tr_b16 v[40:41], v208 offset:10288
  ds_read_b64_tr_b16 v[42:43], v208 offset:12848
  s_add_u32 s58, s56, 8192
  buffer_load_dwordx4 v[64:67], v255, s[8:11], s58 offen offset:0 sc1
  v_mfma_f32_16x16x32_bf16 v[28:31], v[44:47], v[68:71], 0
  s_add_u32 s59, s57, 8192
  buffer_load_dwordx4 v[68:71], v255, s[8:11], s59 offen offset:0 sc1
  s_waitcnt vmcnt(19) lgkmcnt(12)
  v_mfma_f32_16x16x32_bf16 v[0:3], v[48:51], v[72:75], v[0:3]
  ds_read_b64_tr_b16 v[44:45], v206 offset:10240
  ds_read_b64_tr_b16 v[46:47], v206 offset:12800
  s_waitcnt vmcnt(18)
  v_mfma_f32_16x16x32_bf16 v[4:7], v[48:51], v[76:79], v[4:7]
  s_waitcnt lgkmcnt(12)
  v_mfma_f32_16x16x32_bf16 v[8:11], v[52:55], v[72:75], v[8:11]
  ds_read_b64_tr_b16 v[48:49], v208 offset:15360
  ds_read_b64_tr_b16 v[50:51], v208 offset:17920
  v_mfma_f32_16x16x32_bf16 v[12:15], v[52:55], v[76:79], v[12:15]
  s_waitcnt lgkmcnt(12)
  v_mfma_f32_16x16x32_bf16 v[16:19], v[56:59], v[72:75], v[16:19]
  ds_read_b64_tr_b16 v[52:53], v204 offset:15360
  ds_read_b64_tr_b16 v[54:55], v204 offset:17920
  v_mfma_f32_16x16x32_bf16 v[20:23], v[56:59], v[76:79], v[20:23]
  s_waitcnt lgkmcnt(12)
  v_mfma_f32_16x16x32_bf16 v[24:27], v[60:63], v[72:75], v[24:27]
  ds_read_b64_tr_b16 v[56:57], v208 offset:15408
  ds_read_b64_tr_b16 v[58:59], v208 offset:17968
  buffer_load_dwordx4 v[72:75], v255, s[8:11], s58 offen offset:1024 sc1
  v_mfma_f32_16x16x32_bf16 v[28:31], v[60:63], v[76:79], v[28:31]
  buffer_load_dwordx4 v[76:79], v255, s[8:11], s59 offen offset:1024 sc1
  s_waitcnt vmcnt(19) lgkmcnt(12)
  v_mfma_f32_16x16x32_bf16 v[0:3], v[32:35], v[80:83], v[0:3]
  ds_read_b64_tr_b16 v[60:61], v206 offset:15360
  ds_read_b64_tr_b16 v[62:63], v206 offset:17920
  s_waitcnt vmcnt(18)
  v_mfma_f32_16x16x32_bf16 v[4:7], v[32:35], v[84:87], v[4:7]
  ds_read_b128 v[148:151], v214 offset:0
  ds_read_b128 v[152:155], v214 offset:64
  ds_read_b128 v[156:159], v214 offset:128
  ds_read_b128 v[160:163], v214 offset:192
  s_waitcnt lgkmcnt(15)
  v_mfma_f32_16x16x32_bf16 v[8:11], v[36:39], v[80:83], v[8:11]
  ds_read_b64_tr_b16 v[32:33], v208 offset:20480
  ds_read_b64_tr_b16 v[34:35], v208 offset:23040
  v_pk_add_f32 v[128:129], v[128:129], v[130:131]
  v_mfma_f32_16x16x32_bf16 v[12:15], v[36:39], v[84:87], v[12:15]
  v_pk_add_f32 v[132:133], v[132:133], v[134:135]
  s_waitcnt lgkmcnt(15)
  v_mfma_f32_16x16x32_bf16 v[16:19], v[40:43], v[80:83], v[16:19]
  ds_read_b64_tr_b16 v[36:37], v204 offset:20480
  ds_read_b64_tr_b16 v[38:39], v204 offset:23040
  v_mov_b32 v144, v128
  v_mfma_f32_16x16x32_bf16 v[20:23], v[40:43], v[84:87], v[20:23]
  v_mov_b32 v145, v129
  s_waitcnt lgkmcnt(15)
  v_mfma_f32_16x16x32_bf16 v[24:27], v[44:47], v[80:83], v[24:27]
  ds_read_b64_tr_b16 v[40:41], v208 offset:20528
  ds_read_b64_tr_b16 v[42:43], v208 offset:23088
  buffer_load_dwordx4 v[80:83], v255, s[8:11], s58 offen offset:2048 sc1
  v_mov_b32 v146, v132
  v_mfma_f32_16x16x32_bf16 v[28:31], v[44:47], v[84:87], v[28:31]
  buffer_load_dwordx4 v[84:87], v255, s[8:11], s59 offen offset:2048 sc1
  s_waitcnt vmcnt(19) lgkmcnt(15)
  v_mfma_f32_16x16x32_bf16 v[0:3], v[48:51], v[88:91], v[0:3]
  ds_read_b64_tr_b16 v[44:45], v206 offset:20480
  ds_read_b64_tr_b16 v[46:47], v206 offset:23040
  v_mov_b32 v147, v133
  s_waitcnt vmcnt(18)
  v_mfma_f32_16x16x32_bf16 v[4:7], v[48:51], v[92:95], v[4:7]
  v_permlane16_swap_b32 v128, v144
  s_waitcnt lgkmcnt(15)
  v_mfma_f32_16x16x32_bf16 v[8:11], v[52:55], v[88:91], v[8:11]
  ds_read_b64_tr_b16 v[48:49], v208 offset:25600
  ds_read_b64_tr_b16 v[50:51], v208 offset:28160
  v_permlane16_swap_b32 v129, v145
  v_mfma_f32_16x16x32_bf16 v[12:15], v[52:55], v[92:95], v[12:15]
  v_permlane16_swap_b32 v132, v146
  s_waitcnt lgkmcnt(15)
  v_mfma_f32_16x16x32_bf16 v[16:19], v[56:59], v[88:91], v[16:19]
  ds_read_b64_tr_b16 v[52:53], v204 offset:25600
  ds_read_b64_tr_b16 v[54:55], v204 offset:28160
  v_permlane16_swap_b32 v133, v147
  v_mfma_f32_16x16x32_bf16 v[20:23], v[56:59], v[92:95], v[20:23]
  v_add_f32 v128, v128, v144
  s_waitcnt lgkmcnt(15)
  v_mfma_f32_16x16x32_bf16 v[24:27], v[60:63], v[88:91], v[24:27]
  ds_read_b64_tr_b16 v[56:57], v208 offset:25648
  ds_read_b64_tr_b16 v[58:59], v208 offset:28208
  buffer_load_dwordx4 v[88:91], v255, s[8:11], s58 offen offset:3072 sc1
  v_add_f32 v129, v129, v145
  v_mfma_f32_16x16x32_bf16 v[28:31], v[60:63], v[92:95], v[28:31]
  buffer_load_dwordx4 v[92:95], v255, s[8:11], s59 offen offset:3072 sc1
  v_add_f32 v132, v132, v146
  s_waitcnt vmcnt(19) lgkmcnt(12)
  v_mfma_f32_16x16x32_bf16 v[0:3], v[32:35], v[96:99], v[0:3]
  ds_read_b64_tr_b16 v[60:61], v206 offset:25600
  ds_read_b64_tr_b16 v[62:63], v206 offset:28160
  v_add_f32 v133, v133, v147
  s_waitcnt vmcnt(18)
  v_mfma_f32_16x16x32_bf16 v[4:7], v[32:35], v[100:103], v[4:7]
  v_mov_b32 v144, v128
  s_waitcnt lgkmcnt(12)
  v_mfma_f32_16x16x32_bf16 v[8:11], v[36:39], v[96:99], v[8:11]
  ds_read_b64_tr_b16 v[32:33], v208 offset:30720
  ds_read_b64_tr_b16 v[34:35], v208 offset:33280
  v_mov_b32 v145, v129
  v_mfma_f32_16x16x32_bf16 v[12:15], v[36:39], v[100:103], v[12:15]
  v_mov_b32 v146, v132
  s_waitcnt lgkmcnt(12)
  v_mfma_f32_16x16x32_bf16 v[16:19], v[40:43], v[96:99], v[16:19]
  ds_read_b64_tr_b16 v[36:37], v204 offset:30720
  ds_read_b64_tr_b16 v[38:39], v204 offset:33280
  v_mov_b32 v147, v133
  v_mfma_f32_16x16x32_bf16 v[20:23], v[40:43], v[100:103], v[20:23]
  v_permlane32_swap_b32 v128, v144
  s_waitcnt lgkmcnt(12)
  v_mfma_f32_16x16x32_bf16 v[24:27], v[44:47], v[96:99], v[24:27]
  ds_read_b64_tr_b16 v[40:41], v208 offset:30768
  ds_read_b64_tr_b16 v[42:43], v208 offset:33328
  s_add_u32 s58, s56, 12288
  buffer_load_dwordx4 v[96:99], v255, s[8:11], s58 offen offset:0 sc1
  v_permlane32_swap_b32 v129, v145
  v_mfma_f32_16x16x32_bf16 v[28:31], v[44:47], v[100:103], v[28:31]
  s_add_u32 s59, s57, 12288
  buffer_load_dwordx4 v[100:103], v255, s[8:11], s59 offen offset:0 sc1
  s_waitcnt vmcnt(19) lgkmcnt(12)
  v_mfma_f32_16x16x32_bf16 v[0:3], v[48:51], v[104:107], v[0:3]
  ds_read_b64_tr_b16 v[44:45], v206 offset:30720
  ds_read_b64_tr_b16 v[46:47], v206 offset:33280
  v_permlane32_swap_b32 v132, v146
  s_waitcnt vmcnt(18)
  v_mfma_f32_16x16x32_bf16 v[4:7], v[48:51], v[108:111], v[4:7]
  v_permlane32_swap_b32 v133, v147
  s_waitcnt lgkmcnt(12)
  v_mfma_f32_16x16x32_bf16 v[8:11], v[52:55], v[104:107], v[8:11]
  ds_read_b64_tr_b16 v[48:49], v208 offset:35840
  ds_read_b64_tr_b16 v[50:51], v208 offset:38400
  v_add_f32 v128, v128, v144
  v_mfma_f32_16x16x32_bf16 v[12:15], v[52:55], v[108:111], v[12:15]
  v_add_f32 v129, v129, v145
  s_waitcnt lgkmcnt(12)
  v_mfma_f32_16x16x32_bf16 v[16:19], v[56:59], v[104:107], v[16:19]
  ds_read_b64_tr_b16 v[52:53], v204 offset:35840
  ds_read_b64_tr_b16 v[54:55], v204 offset:38400
  v_add_f32 v132, v132, v146
  v_mfma_f32_16x16x32_bf16 v[20:23], v[56:59], v[108:111], v[20:23]
  v_add_f32 v133, v133, v147
  s_waitcnt lgkmcnt(12)
  v_mfma_f32_16x16x32_bf16 v[24:27], v[60:63], v[104:107], v[24:27]
  ds_read_b64_tr_b16 v[56:57], v208 offset:35888
  ds_read_b64_tr_b16 v[58:59], v208 offset:38448
  buffer_load_dwordx4 v[104:107], v255, s[8:11], s58 offen offset:1024 sc1
  v_mul_f32 v136, 0x3acccccd, v128
  v_mfma_f32_16x16x32_bf16 v[28:31], v[60:63], v[108:111], v[28:31]
  buffer_load_dwordx4 v[108:111], v255, s[8:11], s59 offen offset:1024 sc1
  v_mul_f32 v137, 0x3acccccd, v132
  s_waitcnt vmcnt(19) lgkmcnt(12)
  v_mfma_f32_16x16x32_bf16 v[0:3], v[32:35], v[112:115], v[0:3]
  ds_read_b64_tr_b16 v[60:61], v206 offset:35840
  ds_read_b64_tr_b16 v[62:63], v206 offset:38400
  v_mul_f32 v129, 0x3acccccd, v129
  s_waitcnt vmcnt(18)
  v_mfma_f32_16x16x32_bf16 v[4:7], v[32:35], v[116:119], v[4:7]
  v_mul_f32 v133, 0x3acccccd, v133
  s_waitcnt lgkmcnt(12)
  v_mfma_f32_16x16x32_bf16 v[8:11], v[36:39], v[112:115], v[8:11]
  ds_read_b64_tr_b16 v[32:33], v208 offset:40960
  ds_read_b64_tr_b16 v[34:35], v208 offset:43520
  v_fma_f32 v129, -v136, v136, v129
  v_mfma_f32_16x16x32_bf16 v[12:15], v[36:39], v[116:119], v[12:15]
  v_fma_f32 v133, -v137, v137, v133
  s_waitcnt lgkmcnt(12)
  v_mfma_f32_16x16x32_bf16 v[16:19], v[40:43], v[112:115], v[16:19]
  ds_read_b64_tr_b16 v[36:37], v204 offset:40960
  ds_read_b64_tr_b16 v[38:39], v204 offset:43520
  v_max_f32 v129, 0, v129
  v_mfma_f32_16x16x32_bf16 v[20:23], v[40:43], v[116:119], v[20:23]
  v_max_f32 v133, 0, v133
  s_waitcnt lgkmcnt(12)
  v_mfma_f32_16x16x32_bf16 v[24:27], v[44:47], v[112:115], v[24:27]
  ds_read_b64_tr_b16 v[40:41], v208 offset:41008
  ds_read_b64_tr_b16 v[42:43], v208 offset:43568
  buffer_load_dwordx4 v[112:115], v255, s[8:11], s58 offen offset:2048 sc1
  v_add_f32 v144, 0x3727c5ac, v129
  v_mfma_f32_16x16x32_bf16 v[28:31], v[44:47], v[116:119], v[28:31]
  buffer_load_dwordx4 v[116:119], v255, s[8:11], s59 offen offset:2048 sc1
  s_waitcnt vmcnt(19) lgkmcnt(12)
  v_mfma_f32_16x16x32_bf16 v[0:3], v[48:51], v[120:123], v[0:3]
  ds_read_b64_tr_b16 v[44:45], v206 offset:40960
  ds_read_b64_tr_b16 v[46:47], v206 offset:43520
  v_add_f32 v145, 0x3727c5ac, v133
  s_waitcnt vmcnt(18)
  v_mfma_f32_16x16x32_bf16 v[4:7], v[48:51], v[124:127], v[4:7]
  v_rsq_f32 v138, v144
  s_waitcnt lgkmcnt(12)
  v_mfma_f32_16x16x32_bf16 v[8:11], v[52:55], v[120:123], v[8:11]
  ds_read_b64_tr_b16 v[48:49], v208 offset:46080
  ds_read_b64_tr_b16 v[50:51], v208 offset:48640
  v_rsq_f32 v139, v145
  v_mfma_f32_16x16x32_bf16 v[12:15], v[52:55], v[124:127], v[12:15]
  v_mul_f32 v140, 0x3ea52b5c, v138
  s_waitcnt lgkmcnt(12)
  v_mfma_f32_16x16x32_bf16 v[16:19], v[56:59], v[120:123], v[16:19]
  ds_read_b64_tr_b16 v[52:53], v204 offset:46080
  ds_read_b64_tr_b16 v[54:55], v204 offset:48640
  v_mul_f32 v141, 0x3ea52b5c, v139
  v_mfma_f32_16x16x32_bf16 v[20:23], v[56:59], v[124:127], v[20:23]
  v_cndmask_b32 v142, v138, v140, s[72:73]
  s_waitcnt lgkmcnt(12)
  v_mfma_f32_16x16x32_bf16 v[24:27], v[60:63], v[120:123], v[24:27]
  ds_read_b64_tr_b16 v[56:57], v208 offset:46128
  ds_read_b64_tr_b16 v[58:59], v208 offset:48688
  buffer_load_dwordx4 v[120:123], v255, s[8:11], s58 offen offset:3072 sc1
  v_cndmask_b32 v143, v139, v141, s[72:73]
  v_mfma_f32_16x16x32_bf16 v[28:31], v[60:63], v[124:127], v[28:31]
  buffer_load_dwordx4 v[124:127], v255, s[8:11], s59 offen offset:3072 sc1
  v_mov_b32 v128, v136
  s_waitcnt vmcnt(15) lgkmcnt(12)
  v_mfma_f32_16x16x32_bf16 v[0:3], v[32:35], v[64:67], v[0:3]
  ds_read_b64_tr_b16 v[60:61], v206 offset:46080
  ds_read_b64_tr_b16 v[62:63], v206 offset:48640
  v_mov_b32 v129, v136
  s_waitcnt vmcnt(14)
  v_mfma_f32_16x16x32_bf16 v[4:7], v[32:35], v[68:71], v[4:7]
  v_mov_b32 v132, v138
  s_waitcnt lgkmcnt(12)
  v_mfma_f32_16x16x32_bf16 v[8:11], v[36:39], v[64:67], v[8:11]
  ds_read_b64_tr_b16 v[32:33], v208 offset:51200
  ds_read_b64_tr_b16 v[34:35], v208 offset:53760
  v_mov_b32 v133, v138
  v_mfma_f32_16x16x32_bf16 v[12:15], v[36:39], v[68:71], v[12:15]
  v_mov_b32 v144, v140
  s_waitcnt lgkmcnt(12)
  v_mfma_f32_16x16x32_bf16 v[16:19], v[40:43], v[64:67], v[16:19]
  ds_read_b64_tr_b16 v[36:37], v204 offset:51200
  ds_read_b64_tr_b16 v[38:39], v204 offset:53760
  v_mov_b32 v145, v140
  v_mfma_f32_16x16x32_bf16 v[20:23], v[40:43], v[68:71], v[20:23]
  v_mov_b32 v188, v142
  s_waitcnt lgkmcnt(12)
  v_mfma_f32_16x16x32_bf16 v[24:27], v[44:47], v[64:67], v[24:27]
  ds_read_b64_tr_b16 v[40:41], v208 offset:51248
  ds_read_b64_tr_b16 v[42:43], v208 offset:53808
  s_add_u32 s58, s56, 16384
  buffer_load_dwordx4 v[64:67], v255, s[8:11], s58 offen offset:0 sc1
  v_mov_b32 v189, v142
  v_mfma_f32_16x16x32_bf16 v[28:31], v[44:47], v[68:71], v[28:31]
  s_add_u32 s59, s57, 16384
  buffer_load_dwordx4 v[68:71], v255, s[8:11], s59 offen offset:0 sc1
  s_waitcnt vmcnt(15) lgkmcnt(12)
  v_mfma_f32_16x16x32_bf16 v[0:3], v[48:51], v[72:75], v[0:3]
  ds_read_b64_tr_b16 v[44:45], v206 offset:51200
  ds_read_b64_tr_b16 v[46:47], v206 offset:53760
  v_mov_b32 v130, v137
  s_waitcnt vmcnt(14)
  v_mfma_f32_16x16x32_bf16 v[4:7], v[48:51], v[76:79], v[4:7]
  v_mov_b32 v131, v137
  s_waitcnt lgkmcnt(12)
  v_mfma_f32_16x16x32_bf16 v[8:11], v[52:55], v[72:75], v[8:11]
  ds_read_b64_tr_b16 v[48:49], v208 offset:56320
  ds_read_b64_tr_b16 v[50:51], v208 offset:58880
  v_mov_b32 v134, v139
  v_mfma_f32_16x16x32_bf16 v[12:15], v[52:55], v[76:79], v[12:15]
  v_mov_b32 v135, v139
  s_waitcnt lgkmcnt(12)
  v_mfma_f32_16x16x32_bf16 v[16:19], v[56:59], v[72:75], v[16:19]
  ds_read_b64_tr_b16 v[52:53], v204 offset:56320
  ds_read_b64_tr_b16 v[54:55], v204 offset:58880
  v_mov_b32 v146, v141
  v_mfma_f32_16x16x32_bf16 v[20:23], v[56:59], v[76:79], v[20:23]
  v_mov_b32 v147, v141
  s_waitcnt lgkmcnt(12)
  v_mfma_f32_16x16x32_bf16 v[24:27], v[60:63], v[72:75], v[24:27]
  ds_read_b64_tr_b16 v[56:57], v208 offset:56368
  ds_read_b64_tr_b16 v[58:59], v208 offset:58928
  buffer_load_dwordx4 v[72:75], v255, s[8:11], s58 offen offset:1024 sc1
  v_mov_b32 v190, v143
  v_mfma_f32_16x16x32_bf16 v[28:31], v[60:63], v[76:79], v[28:31]
  buffer_load_dwordx4 v[76:79], v255, s[8:11], s59 offen offset:1024 sc1
  v_mov_b32 v191, v143
  s_waitcnt vmcnt(15) lgkmcnt(12)
  v_mfma_f32_16x16x32_bf16 v[0:3], v[32:35], v[80:83], v[0:3]
  ds_read_b64_tr_b16 v[60:61], v206 offset:56320
  ds_read_b64_tr_b16 v[62:63], v206 offset:58880
  s_lshl_b32 s84, s3, 2
  s_add_u32 s84, s84, 161904
  s_mov_b64 exec, 1
  v_mov_b32 v220, s84
  v_mov_b32 v221, s65
  ds_write_b32 v220, v221
  s_mov_b64 exec, -1
  s_waitcnt vmcnt(14)
  v_mfma_f32_16x16x32_bf16 v[4:7], v[32:35], v[84:87], v[4:7]
  s_waitcnt lgkmcnt(13)
  v_mfma_f32_16x16x32_bf16 v[8:11], v[36:39], v[80:83], v[8:11]
  ds_read_b64_tr_b16 v[32:33], v208 offset:61440
  ds_read_b64_tr_b16 v[34:35], v208 offset:64000
  v_mfma_f32_16x16x32_bf16 v[12:15], v[36:39], v[84:87], v[12:15]
  s_waitcnt lgkmcnt(13)
  v_mfma_f32_16x16x32_bf16 v[16:19], v[40:43], v[80:83], v[16:19]
  ds_read_b64_tr_b16 v[36:37], v204 offset:61440
  ds_read_b64_tr_b16 v[38:39], v204 offset:64000
  v_mfma_f32_16x16x32_bf16 v[20:23], v[40:43], v[84:87], v[20:23]
  s_waitcnt lgkmcnt(13)
  v_mfma_f32_16x16x32_bf16 v[24:27], v[44:47], v[80:83], v[24:27]
  ds_read_b64_tr_b16 v[40:41], v208 offset:61488
  ds_read_b64_tr_b16 v[42:43], v208 offset:64048
  buffer_load_dwordx4 v[80:83], v255, s[8:11], s58 offen offset:2048 sc1
  v_mfma_f32_16x16x32_bf16 v[28:31], v[44:47], v[84:87], v[28:31]
  buffer_load_dwordx4 v[84:87], v255, s[8:11], s59 offen offset:2048 sc1
  s_waitcnt vmcnt(15) lgkmcnt(13)
  v_mfma_f32_16x16x32_bf16 v[0:3], v[48:51], v[88:91], v[0:3]
  ds_read_b64_tr_b16 v[44:45], v206 offset:61440
  ds_read_b64_tr_b16 v[46:47], v206 offset:64000
  s_waitcnt vmcnt(14)
  v_mfma_f32_16x16x32_bf16 v[4:7], v[48:51], v[92:95], v[4:7]
  s_waitcnt lgkmcnt(13)
  v_mfma_f32_16x16x32_bf16 v[8:11], v[52:55], v[88:91], v[8:11]
  ds_read_b64_tr_b16 v[48:49], v209 offset:1024
  ds_read_b64_tr_b16 v[50:51], v209 offset:3584
  v_mfma_f32_16x16x32_bf16 v[12:15], v[52:55], v[92:95], v[12:15]
  s_waitcnt lgkmcnt(13)
  v_mfma_f32_16x16x32_bf16 v[16:19], v[56:59], v[88:91], v[16:19]
  ds_read_b64_tr_b16 v[52:53], v205 offset:1024
  ds_read_b64_tr_b16 v[54:55], v205 offset:3584
  v_mfma_f32_16x16x32_bf16 v[20:23], v[56:59], v[92:95], v[20:23]
  s_waitcnt lgkmcnt(13)
  v_mfma_f32_16x16x32_bf16 v[24:27], v[60:63], v[88:91], v[24:27]
  ds_read_b64_tr_b16 v[56:57], v209 offset:1072
  ds_read_b64_tr_b16 v[58:59], v209 offset:3632
  buffer_load_dwordx4 v[88:91], v255, s[8:11], s58 offen offset:3072 sc1
  v_mfma_f32_16x16x32_bf16 v[28:31], v[60:63], v[92:95], v[28:31]
  buffer_load_dwordx4 v[92:95], v255, s[8:11], s59 offen offset:3072 sc1
  s_waitcnt vmcnt(15) lgkmcnt(12)
  v_mfma_f32_16x16x32_bf16 v[0:3], v[32:35], v[96:99], v[0:3]
  ds_read_b64_tr_b16 v[60:61], v207 offset:1024
  ds_read_b64_tr_b16 v[62:63], v207 offset:3584
  s_waitcnt vmcnt(14)
  v_mfma_f32_16x16x32_bf16 v[4:7], v[32:35], v[100:103], v[4:7]
  s_waitcnt lgkmcnt(12)
  v_mfma_f32_16x16x32_bf16 v[8:11], v[36:39], v[96:99], v[8:11]
  ds_read_b64_tr_b16 v[32:33], v209 offset:6144
  ds_read_b64_tr_b16 v[34:35], v209 offset:8704
  v_mfma_f32_16x16x32_bf16 v[12:15], v[36:39], v[100:103], v[12:15]
  s_waitcnt lgkmcnt(12)
  v_mfma_f32_16x16x32_bf16 v[16:19], v[40:43], v[96:99], v[16:19]
  ds_read_b64_tr_b16 v[36:37], v205 offset:6144
  ds_read_b64_tr_b16 v[38:39], v205 offset:8704
  v_mfma_f32_16x16x32_bf16 v[20:23], v[40:43], v[100:103], v[20:23]
  s_waitcnt lgkmcnt(12)
  v_mfma_f32_16x16x32_bf16 v[24:27], v[44:47], v[96:99], v[24:27]
  ds_read_b64_tr_b16 v[40:41], v209 offset:6192
  ds_read_b64_tr_b16 v[42:43], v209 offset:8752
  v_mfma_f32_16x16x32_bf16 v[28:31], v[44:47], v[100:103], v[28:31]
  s_waitcnt vmcnt(13) lgkmcnt(12)
  v_mfma_f32_16x16x32_bf16 v[0:3], v[48:51], v[104:107], v[0:3]
  ds_read_b64_tr_b16 v[44:45], v207 offset:6144
  ds_read_b64_tr_b16 v[46:47], v207 offset:8704
  s_waitcnt vmcnt(12)
  v_mfma_f32_16x16x32_bf16 v[4:7], v[48:51], v[108:111], v[4:7]
  s_waitcnt lgkmcnt(12)
  v_mfma_f32_16x16x32_bf16 v[8:11], v[52:55], v[104:107], v[8:11]
  ds_read_b64_tr_b16 v[48:49], v209 offset:11264
  ds_read_b64_tr_b16 v[50:51], v209 offset:13824
  v_mfma_f32_16x16x32_bf16 v[12:15], v[52:55], v[108:111], v[12:15]
  s_waitcnt lgkmcnt(12)
  v_mfma_f32_16x16x32_bf16 v[16:19], v[56:59], v[104:107], v[16:19]
  ds_read_b64_tr_b16 v[52:53], v205 offset:11264
  ds_read_b64_tr_b16 v[54:55], v205 offset:13824
  v_mfma_f32_16x16x32_bf16 v[20:23], v[56:59], v[108:111], v[20:23]
  s_waitcnt lgkmcnt(12)
  v_mfma_f32_16x16x32_bf16 v[24:27], v[60:63], v[104:107], v[24:27]
  ds_read_b64_tr_b16 v[56:57], v209 offset:11312
  ds_read_b64_tr_b16 v[58:59], v209 offset:13872
  v_mfma_f32_16x16x32_bf16 v[28:31], v[60:63], v[108:111], v[28:31]
  s_waitcnt vmcnt(11) lgkmcnt(12)
  v_mfma_f32_16x16x32_bf16 v[0:3], v[32:35], v[112:115], v[0:3]
  ds_read_b64_tr_b16 v[60:61], v207 offset:11264
  ds_read_b64_tr_b16 v[62:63], v207 offset:13824
  s_waitcnt vmcnt(10)
  v_mfma_f32_16x16x32_bf16 v[4:7], v[32:35], v[116:119], v[4:7]
  s_waitcnt lgkmcnt(12)
  v_mfma_f32_16x16x32_bf16 v[8:11], v[36:39], v[112:115], v[8:11]
  ds_read_b64_tr_b16 v[32:33], v209 offset:16384
  ds_read_b64_tr_b16 v[34:35], v209 offset:18944
  v_mfma_f32_16x16x32_bf16 v[12:15], v[36:39], v[116:119], v[12:15]
  s_waitcnt lgkmcnt(12)
  v_mfma_f32_16x16x32_bf16 v[16:19], v[40:43], v[112:115], v[16:19]
  ds_read_b64_tr_b16 v[36:37], v205 offset:16384
  ds_read_b64_tr_b16 v[38:39], v205 offset:18944
  v_mfma_f32_16x16x32_bf16 v[20:23], v[40:43], v[116:119], v[20:23]
  s_waitcnt lgkmcnt(12)
  v_mfma_f32_16x16x32_bf16 v[24:27], v[44:47], v[112:115], v[24:27]
  ds_read_b64_tr_b16 v[40:41], v209 offset:16432
  ds_read_b64_tr_b16 v[42:43], v209 offset:18992
  v_mfma_f32_16x16x32_bf16 v[28:31], v[44:47], v[116:119], v[28:31]
  s_waitcnt vmcnt(9) lgkmcnt(12)
  v_mfma_f32_16x16x32_bf16 v[0:3], v[48:51], v[120:123], v[0:3]
  ds_read_b64_tr_b16 v[44:45], v207 offset:16384
  ds_read_b64_tr_b16 v[46:47], v207 offset:18944
  s_waitcnt vmcnt(8)
  v_mfma_f32_16x16x32_bf16 v[4:7], v[48:51], v[124:127], v[4:7]
  s_waitcnt lgkmcnt(12)
  v_mfma_f32_16x16x32_bf16 v[8:11], v[52:55], v[120:123], v[8:11]
  ds_read_b64_tr_b16 v[48:49], v209 offset:21504
  ds_read_b64_tr_b16 v[50:51], v209 offset:24064
  v_mfma_f32_16x16x32_bf16 v[12:15], v[52:55], v[124:127], v[12:15]
  s_waitcnt lgkmcnt(12)
  v_mfma_f32_16x16x32_bf16 v[16:19], v[56:59], v[120:123], v[16:19]
  ds_read_b64_tr_b16 v[52:53], v205 offset:21504
  ds_read_b64_tr_b16 v[54:55], v205 offset:24064
  v_mfma_f32_16x16x32_bf16 v[20:23], v[56:59], v[124:127], v[20:23]
  s_waitcnt lgkmcnt(12)
  v_mfma_f32_16x16x32_bf16 v[24:27], v[60:63], v[120:123], v[24:27]
  ds_read_b64_tr_b16 v[56:57], v209 offset:21552
  ds_read_b64_tr_b16 v[58:59], v209 offset:24112
  v_mfma_f32_16x16x32_bf16 v[28:31], v[60:63], v[124:127], v[28:31]
  s_waitcnt vmcnt(7) lgkmcnt(12)
  v_mfma_f32_16x16x32_bf16 v[0:3], v[32:35], v[64:67], v[0:3]
  ds_read_b64_tr_b16 v[60:61], v207 offset:21504
  ds_read_b64_tr_b16 v[62:63], v207 offset:24064
  s_waitcnt vmcnt(6)
  v_mfma_f32_16x16x32_bf16 v[4:7], v[32:35], v[68:71], v[4:7]
  s_waitcnt lgkmcnt(12)
  v_mfma_f32_16x16x32_bf16 v[8:11], v[36:39], v[64:67], v[8:11]
  ds_read_b64_tr_b16 v[32:33], v209 offset:26624
  ds_read_b64_tr_b16 v[34:35], v209 offset:29184
  v_mfma_f32_16x16x32_bf16 v[12:15], v[36:39], v[68:71], v[12:15]
  s_waitcnt lgkmcnt(12)
  v_mfma_f32_16x16x32_bf16 v[16:19], v[40:43], v[64:67], v[16:19]
  ds_read_b64_tr_b16 v[36:37], v205 offset:26624
  ds_read_b64_tr_b16 v[38:39], v205 offset:29184
  v_mfma_f32_16x16x32_bf16 v[20:23], v[40:43], v[68:71], v[20:23]
  s_waitcnt lgkmcnt(12)
  v_mfma_f32_16x16x32_bf16 v[24:27], v[44:47], v[64:67], v[24:27]
  ds_read_b64_tr_b16 v[40:41], v209 offset:26672
  ds_read_b64_tr_b16 v[42:43], v209 offset:29232
  v_mfma_f32_16x16x32_bf16 v[28:31], v[44:47], v[68:71], v[28:31]
  s_waitcnt vmcnt(5) lgkmcnt(12)
  v_mfma_f32_16x16x32_bf16 v[0:3], v[48:51], v[72:75], v[0:3]
  ds_read_b64_tr_b16 v[44:45], v207 offset:26624
  ds_read_b64_tr_b16 v[46:47], v207 offset:29184
  s_waitcnt vmcnt(4)
  v_mfma_f32_16x16x32_bf16 v[4:7], v[48:51], v[76:79], v[4:7]
  s_waitcnt lgkmcnt(12)
  v_mfma_f32_16x16x32_bf16 v[8:11], v[52:55], v[72:75], v[8:11]
  ds_read_b64_tr_b16 v[48:49], v209 offset:31744
  ds_read_b64_tr_b16 v[50:51], v209 offset:34304
  v_mfma_f32_16x16x32_bf16 v[12:15], v[52:55], v[76:79], v[12:15]
  s_waitcnt lgkmcnt(12)
  v_mfma_f32_16x16x32_bf16 v[16:19], v[56:59], v[72:75], v[16:19]
  ds_read_b64_tr_b16 v[52:53], v205 offset:31744
  ds_read_b64_tr_b16 v[54:55], v205 offset:34304
  v_mfma_f32_16x16x32_bf16 v[20:23], v[56:59], v[76:79], v[20:23]
  s_waitcnt lgkmcnt(12)
  v_mfma_f32_16x16x32_bf16 v[24:27], v[60:63], v[72:75], v[24:27]
  ds_read_b64_tr_b16 v[56:57], v209 offset:31792
  ds_read_b64_tr_b16 v[58:59], v209 offset:34352
  v_mfma_f32_16x16x32_bf16 v[28:31], v[60:63], v[76:79], v[28:31]
  s_waitcnt vmcnt(3) lgkmcnt(12)
  v_mfma_f32_16x16x32_bf16 v[0:3], v[32:35], v[80:83], v[0:3]
  ds_read_b64_tr_b16 v[60:61], v207 offset:31744
  ds_read_b64_tr_b16 v[62:63], v207 offset:34304
  s_waitcnt vmcnt(2)
  v_mfma_f32_16x16x32_bf16 v[4:7], v[32:35], v[84:87], v[4:7]
  s_waitcnt lgkmcnt(12)
  v_mfma_f32_16x16x32_bf16 v[8:11], v[36:39], v[80:83], v[8:11]
  v_mfma_f32_16x16x32_bf16 v[12:15], v[36:39], v[84:87], v[12:15]
  s_waitcnt lgkmcnt(10)
  v_mfma_f32_16x16x32_bf16 v[16:19], v[40:43], v[80:83], v[16:19]
  v_mfma_f32_16x16x32_bf16 v[20:23], v[40:43], v[84:87], v[20:23]
  s_waitcnt lgkmcnt(8)
  v_mfma_f32_16x16x32_bf16 v[24:27], v[44:47], v[80:83], v[24:27]
  v_mfma_f32_16x16x32_bf16 v[28:31], v[44:47], v[84:87], v[28:31]
  s_waitcnt vmcnt(1) lgkmcnt(6)
  v_mfma_f32_16x16x32_bf16 v[0:3], v[48:51], v[88:91], v[0:3]
  s_waitcnt vmcnt(0)
  v_mfma_f32_16x16x32_bf16 v[4:7], v[48:51], v[92:95], v[4:7]
  s_waitcnt lgkmcnt(4)
  v_mfma_f32_16x16x32_bf16 v[8:11], v[52:55], v[88:91], v[8:11]
  v_mfma_f32_16x16x32_bf16 v[12:15], v[52:55], v[92:95], v[12:15]
  s_waitcnt lgkmcnt(2)
  v_mfma_f32_16x16x32_bf16 v[16:19], v[56:59], v[88:91], v[16:19]
  v_mfma_f32_16x16x32_bf16 v[20:23], v[56:59], v[92:95], v[20:23]
  s_waitcnt lgkmcnt(0)
  v_mfma_f32_16x16x32_bf16 v[24:27], v[60:63], v[88:91], v[24:27]
  v_mfma_f32_16x16x32_bf16 v[28:31], v[60:63], v[92:95], v[28:31]
  v_pk_fma_f32 v[0:1], v[148:149], v[128:129], v[0:1] neg_lo:[0,1,0] neg_hi:[0,1,0]
  v_pk_fma_f32 v[2:3], v[150:151], v[128:129], v[2:3] neg_lo:[0,1,0] neg_hi:[0,1,0]
  v_pk_fma_f32 v[8:9], v[152:153], v[128:129], v[8:9] neg_lo:[0,1,0] neg_hi:[0,1,0]
  v_pk_fma_f32 v[10:11], v[154:155], v[128:129], v[10:11] neg_lo:[0,1,0] neg_hi:[0,1,0]
  v_pk_fma_f32 v[16:17], v[156:157], v[128:129], v[16:17] neg_lo:[0,1,0] neg_hi:[0,1,0]
  v_pk_fma_f32 v[18:19], v[158:159], v[128:129], v[18:19] neg_lo:[0,1,0] neg_hi:[0,1,0]
  s_nop 0
  v_pk_fma_f32 v[24:25], v[160:161], v[128:129], v[24:25] neg_lo:[0,1,0] neg_hi:[0,1,0]
  v_pk_fma_f32 v[26:27], v[162:163], v[128:129], v[26:27] neg_lo:[0,1,0] neg_hi:[0,1,0]
  v_pk_fma_f32 v[4:5], v[148:149], v[130:131], v[4:5] neg_lo:[0,1,0] neg_hi:[0,1,0]
  v_pk_fma_f32 v[6:7], v[150:151], v[130:131], v[6:7] neg_lo:[0,1,0] neg_hi:[0,1,0]
  v_pk_fma_f32 v[12:13], v[152:153], v[130:131], v[12:13] neg_lo:[0,1,0] neg_hi:[0,1,0]
  v_pk_fma_f32 v[14:15], v[154:155], v[130:131], v[14:15] neg_lo:[0,1,0] neg_hi:[0,1,0]
  v_pk_fma_f32 v[20:21], v[156:157], v[130:131], v[20:21] neg_lo:[0,1,0] neg_hi:[0,1,0]
  v_pk_fma_f32 v[22:23], v[158:159], v[130:131], v[22:23] neg_lo:[0,1,0] neg_hi:[0,1,0]
  v_pk_fma_f32 v[28:29], v[160:161], v[130:131], v[28:29] neg_lo:[0,1,0] neg_hi:[0,1,0]
  v_pk_fma_f32 v[30:31], v[162:163], v[130:131], v[30:31] neg_lo:[0,1,0] neg_hi:[0,1,0]
  v_pk_mul_f32 v[16:17], v[16:17], v[132:133]
  v_pk_mul_f32 v[18:19], v[18:19], v[132:133]
  v_pk_mul_f32 v[24:25], v[24:25], v[132:133]
  v_pk_mul_f32 v[26:27], v[26:27], v[132:133]
  v_pk_mul_f32 v[8:9], v[8:9], v[188:189]
  v_pk_mul_f32 v[10:11], v[10:11], v[188:189]
  v_pk_mul_f32 v[0:1], v[0:1], v[144:145]
  v_pk_mul_f32 v[2:3], v[2:3], v[144:145]
  v_pk_mul_f32 v[20:21], v[20:21], v[134:135]
  v_pk_mul_f32 v[22:23], v[22:23], v[134:135]
  v_pk_mul_f32 v[28:29], v[28:29], v[134:135]
  v_pk_mul_f32 v[30:31], v[30:31], v[134:135]
  v_pk_mul_f32 v[12:13], v[12:13], v[190:191]
  v_pk_mul_f32 v[14:15], v[14:15], v[190:191]
  v_pk_mul_f32 v[4:5], v[4:5], v[146:147]
  v_pk_mul_f32 v[6:7], v[6:7], v[146:147]
  v_mov_b32 v215, 0x3f80
  v_mov_b32 v216, 0
  v_cvt_pk_bf16_f32 v176, v16, v17
  v_cvt_pk_bf16_f32 v177, v18, v19
  v_cvt_pk_bf16_f32 v178, v24, v25
  v_cvt_pk_bf16_f32 v179, v26, v27
  v_cvt_pk_bf16_f32 v174, v8, v9
  v_cvt_pk_bf16_f32 v175, v10, v11
  v_cndmask_b32 v178, v178, v215, s[74:75]
  v_cndmask_b32 v179, v179, v216, s[74:75]
  v_cvt_pk_bf16_f32 v184, v20, v21
  v_cvt_pk_bf16_f32 v185, v22, v23
  v_cvt_pk_bf16_f32 v186, v28, v29
  v_cvt_pk_bf16_f32 v187, v30, v31
  v_cvt_pk_bf16_f32 v182, v12, v13
  v_cvt_pk_bf16_f32 v183, v14, v15
  v_cndmask_b32 v186, v186, v215, s[74:75]
  v_cndmask_b32 v187, v187, v216, s[74:75]
  s_add_u32 s91, s95, 0
  buffer_store_dwordx4 v[176:179], v255, s[8:11], s91 offen sc1
  buffer_store_dwordx2 v[174:175], v213, s[8:11], s91 offen offset:1024 sc1
  ds_write_b128 v210, v[176:179] offset:0
  ds_write_b64 v211, v[174:175] offset:1024
  s_add_u32 s91, s95, 1536
  buffer_store_dwordx4 v[184:187], v255, s[8:11], s91 offen sc1
  buffer_store_dwordx2 v[182:183], v213, s[8:11], s91 offen offset:1024 sc1
  ds_write_b128 v210, v[184:187] offset:1536
  ds_write_b64 v211, v[182:183] offset:2560
  v_cvt_pk_bf16_f32 v164, v0, v1
  v_cvt_pk_bf16_f32 v165, v2, v3
  v_cndmask_b32 v166, 0, v174, s[72:73]
  v_cndmask_b32 v167, 0, v175, s[72:73]
  v_cvt_pk_bf16_f32 v168, v4, v5
  v_cvt_pk_bf16_f32 v169, v6, v7
  v_cndmask_b32 v170, 0, v182, s[72:73]
  v_cndmask_b32 v171, 0, v183, s[72:73]
  s_waitcnt lgkmcnt(0)
  s_lshl_b32 s84, s3, 2
  s_mov_b64 exec, 1
  s_add_u32 s84, s84, 161856
  v_mov_b32 v220, s84
  v_mov_b32 v221, s65
  ds_write_b32 v220, v221
  s_mov_b64 exec, -1
  s_add_u32 s68, s64, 8
  s_mul_i32 s84, s68, 3072
  s_add_u32 s84, s84, 102400
  v_add_u32 v80, s84, v255
  v_add_u32 v81, s84, v192
  v_add_u32 v82, s84, v193
  ds_read_b128 v[64:67], v80
  ds_read_b128 v[68:71], v80 offset:1536
  ds_read_b64_tr_b16 v[72:73], v81
  ds_read_b64_tr_b16 v[74:75], v81 offset:1536
  ds_read_b64_tr_b16 v[76:77], v82
  ds_read_b64_tr_b16 v[78:79], v82 offset:1536
  s_waitcnt lgkmcnt(4)
  v_mfma_f32_16x16x32_bf16 v[24:27], v[64:67], v[164:167], 0
  v_mfma_f32_16x16x32_bf16 v[28:31], v[64:67], v[168:171], 0
  v_mfma_f32_16x16x32_bf16 v[36:39], v[68:71], v[168:171], 0
  v_mov_b32 v86, 0xf149f2ca
  v_mov_b32 v32, v86
  v_mov_b32 v33, v86
  v_mov_b32 v34, v86
  v_mov_b32 v35, v86
  s_nop 0
  v_cndmask_b32 v24, v86, v24, s[76:77]
  v_cndmask_b32 v25, v86, v25, s[78:79]
  v_cndmask_b32 v26, v86, v26, s[80:81]
  v_cndmask_b32 v27, v86, v27, s[82:83]
  v_cndmask_b32 v36, v86, v36, s[76:77]
  v_cndmask_b32 v37, v86, v37, s[78:79]
  v_cndmask_b32 v38, v86, v38, s[80:81]
  v_cndmask_b32 v39, v86, v39, s[82:83]
  v_max3_f32 v84, v24, v25, v26
  v_max3_f32 v85, v28, v29, v30
  v_max3_f32 v86, v27, v32, v33
  v_max3_f32 v87, v31, v36, v37
  v_max3_f32 v84, v84, v34, v35
  v_max3_f32 v85, v85, v38, v39
  v_max_f32 v84, v84, v86
  v_max_f32 v85, v85, v87
  v_mov_b32 v86, v84
  v_mov_b32 v87, v85
  s_nop 0
  v_permlane16_swap_b32 v84, v86
  v_permlane16_swap_b32 v85, v87
  v_max_f32 v84, v84, v86
  v_max_f32 v85, v85, v87
  v_mov_b32 v86, v84
  v_mov_b32 v87, v85
  s_nop 0
  v_permlane32_swap_b32 v84, v86
  v_permlane32_swap_b32 v85, v87
  v_max_f32 v84, v84, v86
  v_max_f32 v85, v85, v87
  v_sub_f32 v24, v24, v84
  v_sub_f32 v25, v25, v84
  v_sub_f32 v26, v26, v84
  v_sub_f32 v27, v27, v84
  v_sub_f32 v32, v32, v84
  v_sub_f32 v33, v33, v84
  v_sub_f32 v34, v34, v84
  v_sub_f32 v35, v35, v84
  v_sub_f32 v0, 0, v84
  v_sub_f32 v1, 0, v84
  v_sub_f32 v2, 0, v84
  v_sub_f32 v3, 0, v84
  v_sub_f32 v28, v28, v85
  v_sub_f32 v29, v29, v85
  v_sub_f32 v30, v30, v85
  v_sub_f32 v31, v31, v85
  v_sub_f32 v36, v36, v85
  v_sub_f32 v37, v37, v85
  v_sub_f32 v38, v38, v85
  v_sub_f32 v39, v39, v85
  v_sub_f32 v4, 0, v85
  v_sub_f32 v5, 0, v85
  v_sub_f32 v6, 0, v85
  v_sub_f32 v7, 0, v85
  v_exp_f32 v24, v24
  v_exp_f32 v25, v25
  v_exp_f32 v26, v26
  v_exp_f32 v27, v27
  v_exp_f32 v32, v32
  v_exp_f32 v33, v33
  v_exp_f32 v34, v34
  v_exp_f32 v35, v35
  v_cvt_pk_bf16_f32 v56, v24, v25
  v_cvt_pk_bf16_f32 v57, v26, v27
  v_cvt_pk_bf16_f32 v58, v32, v33
  v_cvt_pk_bf16_f32 v59, v34, v35
  s_waitcnt lgkmcnt(0)
  s_nop 0
  v_mfma_f32_16x16x32_bf16 v[8:11], v[72:75], v[56:59], 0
  v_exp_f32 v28, v28
  v_exp_f32 v29, v29
  v_mfma_f32_16x16x32_bf16 v[16:19], v[76:79], v[56:59], 0
  v_exp_f32 v30, v30
  v_exp_f32 v31, v31
  v_exp_f32 v36, v36
  v_exp_f32 v37, v37
  v_exp_f32 v38, v38
  v_exp_f32 v39, v39
  v_cvt_pk_bf16_f32 v60, v28, v29
  v_cvt_pk_bf16_f32 v61, v30, v31
  v_cvt_pk_bf16_f32 v62, v36, v37
  v_cvt_pk_bf16_f32 v63, v38, v39
  s_nop 1
  v_mfma_f32_16x16x32_bf16 v[12:15], v[72:75], v[60:63], 0
  v_mfma_f32_16x16x32_bf16 v[20:23], v[76:79], v[60:63], 0
  s_waitcnt vmcnt(0)
  s_lshl_b32 s84, s4, 10
  s_lshl_b32 s85, s5, 5
  s_add_u32 s84, s84, s85
  s_lshl_b32 s85, s64, 2
  s_add_u32 s84, s84, s85
  s_add_u32 s84, s84, s52
  s_add_u32 s84, s84, 0x4000
  v_mov_b32 v220, s7
  v_mov_b32 v221, 0
  s_mov_b64 exec, 1
  buffer_store_dword v220, v221, s[8:11], s84 offen sc1
  s_mov_b64 exec, -1
  s_cmp_eq_u32 s69, 0
  s_cbranch_scc1 PR_79
  s_setprio 0
PR_79:
  s_cmp_lg_u32 s3, 3
  s_cbranch_scc1 NF_80
  s_mov_b32 s92, 161952
  s_mov_b32 s93, 1
  v_mov_b32 v220, s92
  s_mov_b32 s90, 0
LW_81:
  ds_read_b128 v[216:219], v220
  s_waitcnt lgkmcnt(0)
  v_min_u32 v216, v216, v217
  v_min_u32 v218, v218, v219
  v_min_u32 v216, v216, v218
  s_nop 0
  v_readfirstlane_b32 s91, v216
  s_add_u32 s90, s90, 1
  s_cmp_ge_u32 s91, s93
  s_cbranch_scc1 LWD_82
  s_sleep 1
  s_cmp_lt_u32 s90, 0x400000
  s_cbranch_scc1 LW_81
LWD_82:
  s_cmp_eq_u32 s4, 0
  s_cbranch_scc1 NH_83
  s_sub_u32 s92, s4, 1
  s_lshl_b32 s93, s92, 10
  s_lshl_b32 s84, s5, 5
  s_add_u32 s93, s93, s84
  s_add_u32 s93, s93, s52
  s_add_u32 s93, s93, 16400
  v_lshlrev_b32 v221, 2, v254
  s_mov_b32 s58, 0
  s_mov_b64 exec, 0xf
POLL_84:
  buffer_load_dword v220, v221, s[8:11], s93 offen sc1
  s_waitcnt vmcnt(0)
  v_cmp_ne_u32 vcc, s7, v220
  s_add_u32 s58, s58, 1
  s_cbranch_vccz POLLD_85
  s_cmp_lt_u32 s58, 0x200000
  s_cbranch_scc1 POLL_84
  v_mov_b32 v220, 100
  v_mov_b32 v221, 8
  s_mov_b32 s28, s40
  s_and_b32 s29, s41, 0xffff
  s_mov_b32 s30, 256
  s_mov_b32 s31, 0x20000
  s_mov_b64 exec, 1
  buffer_store_dword v220, v221, s[28:31], 0 offen
POLLD_85:
  s_mov_b64 exec, -1
  s_lshl_b32 s92, s92, 5
  s_add_u32 s92, s92, s5
  s_mul_i32 s92, s92, 24576
  s_add_u32 s92, s92, s49
  s_mov_b32 m0, 114688
  s_add_u32 s84, s92, 12288
  buffer_load_dwordx4 v255, s[8:11], s84 offen sc1 lds
  s_mov_b32 m0, 115712
  s_add_u32 s84, s92, 13312
  buffer_load_dwordx4 v255, s[8:11], s84 offen sc1 lds
  s_mov_b32 m0, 116736
  s_add_u32 s84, s92, 14336
  buffer_load_dwordx4 v255, s[8:11], s84 offen sc1 lds
  s_mov_b32 m0, 117760
  s_add_u32 s84, s92, 15360
  buffer_load_dwordx4 v255, s[8:11], s84 offen sc1 lds
  s_mov_b32 m0, 118784
  s_add_u32 s84, s92, 16384
  buffer_load_dwordx4 v255, s[8:11], s84 offen sc1 lds
  s_mov_b32 m0, 119808
  s_add_u32 s84, s92, 17408
  buffer_load_dwordx4 v255, s[8:11], s84 offen sc1 lds
  s_mov_b32 m0, 120832
  s_add_u32 s84, s92, 18432
  buffer_load_dwordx4 v255, s[8:11], s84 offen sc1 lds
  s_mov_b32 m0, 121856
  s_add_u32 s84, s92, 19456
  buffer_load_dwordx4 v255, s[8:11], s84 offen sc1 lds
  s_mov_b32 m0, 122880
  s_add_u32 s84, s92, 20480
  buffer_load_dwordx4 v255, s[8:11], s84 offen sc1 lds
  s_mov_b32 m0, 123904
  s_add_u32 s84, s92, 21504
  buffer_load_dwordx4 v255, s[8:11], s84 offen sc1 lds
  s_mov_b32 m0, 124928
  s_add_u32 s84, s92, 22528
  buffer_load_dwordx4 v255, s[8:11], s84 offen sc1 lds
  s_mov_b32 m0, 125952
  s_add_u32 s84, s92, 23552
  buffer_load_dwordx4 v255, s[8:11], s84 offen sc1 lds
NH_83:
  s_waitcnt vmcnt(0)
  s_mov_b64 exec, 1
  v_mov_b32 v220, 161888
  v_mov_b32 v221, s65
  ds_write_b32 v220, v221
  s_mov_b64 exec, -1
NF_80:
  s_mov_b32 s92, 161872
  s_cmp_lg_u32 s69, 0
  s_cselect_b32 s92, 161856, s92
  v_mov_b32 v220, s92
  s_mov_b32 s90, 0
LW_86:
  ds_read_b128 v[216:219], v220
  s_waitcnt lgkmcnt(0)
  v_min_u32 v216, v216, v217
  v_min_u32 v218, v218, v219
  v_min_u32 v216, v216, v218
  s_nop 0
  v_readfirstlane_b32 s91, v216
  s_add_u32 s90, s90, 1
  s_cmp_ge_u32 s91, s65
  s_cbranch_scc1 LWD_87
  s_sleep 1
  s_cmp_lt_u32 s90, 0x400000
  s_cbranch_scc1 LW_86
LWD_87:
  s_sub_u32 s84, s64, 4
  s_cmp_lg_u32 s69, 0
  s_cselect_b32 s67, s84, s64
  s_cselect_b32 s68, 12, 8
  s_nop 3
  s_call_b64 s[94:95], L_FULLS
  s_nop 3
  s_cmp_eq_u32 s4, 0
  s_cbranch_scc1 NY_88
  s_mov_b32 s92, 161888
  v_mov_b32 v220, s92
  s_mov_b32 s90, 0
LW_89:
  ds_read_b32 v216, v220
  s_waitcnt lgkmcnt(0)
  v_readfirstlane_b32 s91, v216
  s_add_u32 s90, s90, 1
  s_cmp_ge_u32 s91, s65
  s_cbranch_scc1 LWD_90
  s_sleep 1
  s_cmp_lt_u32 s90, 0x400000
  s_cbranch_scc1 LW_89
LWD_90:
  s_sub_u32 s84, 7, s64
  s_add_u32 s85, s64, 1
  s_cmp_lg_u32 s69, 0
  s_cselect_b32 s67, s84, 4
  s_cselect_b32 s68, s85, 4
  s_nop 3
  s_call_b64 s[94:95], L_FULLS
  s_nop 3
  s_cmp_eq_u32 s69, 0
  s_cbranch_scc1 NFA_91
  s_mul_i32 s84, s64, 3072
  s_add_u32 s84, s84, 102400
  v_add_u32 v80, s84, v255
  v_add_u32 v81, s84, v192
  v_add_u32 v82, s84, v193
  ds_read_b128 v[64:67], v80
  ds_read_b128 v[68:71], v80 offset:1536
  ds_read_b64_tr_b16 v[72:73], v81
  ds_read_b64_tr_b16 v[74:75], v81 offset:1536
  ds_read_b64_tr_b16 v[76:77], v82
  ds_read_b64_tr_b16 v[78:79], v82 offset:1536
  s_waitcnt lgkmcnt(4)
  v_mfma_f32_16x16x32_bf16 v[24:27], v[64:67], v[164:167], v[0:3]
  v_mfma_f32_16x16x32_bf16 v[32:35], v[68:71], v[164:167], v[0:3]
  v_mfma_f32_16x16x32_bf16 v[36:39], v[68:71], v[168:171], v[4:7]
  v_mov_b32 v86, 0xf149f2ca
  v_mov_b32 v28, v86
  v_mov_b32 v29, v86
  v_mov_b32 v30, v86
  v_mov_b32 v31, v86
  s_nop 0
  v_cndmask_b32 v24, v24, v86, s[76:77]
  v_cndmask_b32 v25, v25, v86, s[78:79]
  v_cndmask_b32 v26, v26, v86, s[80:81]
  v_cndmask_b32 v27, v27, v86, s[82:83]
  v_cndmask_b32 v36, v36, v86, s[76:77]
  v_cndmask_b32 v37, v37, v86, s[78:79]
  v_cndmask_b32 v38, v38, v86, s[80:81]
  v_cndmask_b32 v39, v39, v86, s[82:83]
  v_max3_f32 v84, v24, v25, v26
  v_max3_f32 v85, v28, v29, v30
  v_max3_f32 v86, v27, v32, v33
  v_max3_f32 v87, v31, v36, v37
  v_max3_f32 v84, v84, v34, v35
  v_max3_f32 v85, v85, v38, v39
  v_max_f32 v84, v84, v86
  v_max_f32 v85, v85, v87
  v_max_f32 v86, v84, v85
  v_cmp_lt_f32 vcc, s66, v86
  s_cbranch_vccnz AR_92
AB_93:
  v_exp_f32 v24, v24
  v_exp_f32 v25, v25
  v_exp_f32 v26, v26
  v_exp_f32 v27, v27
  v_exp_f32 v32, v32
  v_exp_f32 v33, v33
  v_exp_f32 v34, v34
  v_exp_f32 v35, v35
  v_cvt_pk_bf16_f32 v56, v24, v25
  v_cvt_pk_bf16_f32 v57, v26, v27
  v_cvt_pk_bf16_f32 v58, v32, v33
  v_cvt_pk_bf16_f32 v59, v34, v35
  s_waitcnt lgkmcnt(0)
  s_nop 0
  v_mfma_f32_16x16x32_bf16 v[8:11], v[72:75], v[56:59], v[8:11]
  v_exp_f32 v28, v28
  v_exp_f32 v29, v29
  v_mfma_f32_16x16x32_bf16 v[16:19], v[76:79], v[56:59], v[16:19]
  v_exp_f32 v30, v30
  v_exp_f32 v31, v31
  v_exp_f32 v36, v36
  v_exp_f32 v37, v37
  v_exp_f32 v38, v38
  v_exp_f32 v39, v39
  v_cvt_pk_bf16_f32 v60, v28, v29
  v_cvt_pk_bf16_f32 v61, v30, v31
  v_cvt_pk_bf16_f32 v62, v36, v37
  v_cvt_pk_bf16_f32 v63, v38, v39
  s_nop 1
  v_mfma_f32_16x16x32_bf16 v[12:15], v[72:75], v[60:63], v[12:15]
  v_mfma_f32_16x16x32_bf16 v[20:23], v[76:79], v[60:63], v[20:23]
  s_nop 7
NFA_91:
NY_88:
  s_cmp_eq_u32 s69, 0
  s_cbranch_scc1 ZL_94
  s_mov_b32 s92, 161872
  v_mov_b32 v220, s92
  s_mov_b32 s90, 0
LW_96:
  ds_read_b128 v[216:219], v220
  s_waitcnt lgkmcnt(0)
  v_min_u32 v216, v216, v217
  v_min_u32 v218, v218, v219
  v_min_u32 v216, v216, v218
  s_nop 0
  v_readfirstlane_b32 s91, v216
  s_add_u32 s90, s90, 1
  s_cmp_ge_u32 s91, s65
  s_cbranch_scc1 LWD_97
  s_sleep 1
  s_cmp_lt_u32 s90, 0x400000
  s_cbranch_scc1 LW_96
LWD_97:
  s_cmp_lg_u32 s3, 0
  s_cbranch_scc1 NLF_98
  s_mov_b32 s92, 161952
  s_mov_b32 s93, 1
  v_mov_b32 v220, s92
  s_mov_b32 s90, 0
LW_99:
  ds_read_b128 v[216:219], v220
  s_waitcnt lgkmcnt(0)
  v_min_u32 v216, v216, v217
  v_min_u32 v218, v218, v219
  v_min_u32 v216, v216, v218
  s_nop 0
  v_readfirstlane_b32 s91, v216
  s_add_u32 s90, s90, 1
  s_cmp_ge_u32 s91, s93
  s_cbranch_scc1 LWD_100
  s_sleep 1
  s_cmp_lt_u32 s90, 0x400000
  s_cbranch_scc1 LW_99
LWD_100:
  s_cmp_eq_u32 s4, 0
  s_cbranch_scc1 NH_101
  s_sub_u32 s92, s4, 1
  s_lshl_b32 s93, s92, 10
  s_lshl_b32 s84, s5, 5
  s_add_u32 s93, s93, s84
  s_add_u32 s93, s93, s52
  s_add_u32 s93, s93, 16384
  v_lshlrev_b32 v221, 2, v254
  s_mov_b32 s58, 0
  s_mov_b64 exec, 0xf
POLL_102:
  buffer_load_dword v220, v221, s[8:11], s93 offen sc1
  s_waitcnt vmcnt(0)
  v_cmp_ne_u32 vcc, s7, v220
  s_add_u32 s58, s58, 1
  s_cbranch_vccz POLLD_103
  s_cmp_lt_u32 s58, 0x200000
  s_cbranch_scc1 POLL_102
  v_mov_b32 v220, 101
  v_mov_b32 v221, 8
  s_mov_b32 s28, s40
  s_and_b32 s29, s41, 0xffff
  s_mov_b32 s30, 256
  s_mov_b32 s31, 0x20000
  s_mov_b64 exec, 1
  buffer_store_dword v220, v221, s[28:31], 0 offen
POLLD_103:
  s_mov_b64 exec, -1
  s_lshl_b32 s92, s92, 5
  s_add_u32 s92, s92, s5
  s_mul_i32 s92, s92, 24576
  s_add_u32 s92, s92, s49
  s_mov_b32 m0, 102400
  s_add_u32 s84, s92, 0
  buffer_load_dwordx4 v255, s[8:11], s84 offen sc1 lds
  s_mov_b32 m0, 103424
  s_add_u32 s84, s92, 1024
  buffer_load_dwordx4 v255, s[8:11], s84 offen sc1 lds
  s_mov_b32 m0, 104448
  s_add_u32 s84, s92, 2048
  buffer_load_dwordx4 v255, s[8:11], s84 offen sc1 lds
  s_mov_b32 m0, 105472
  s_add_u32 s84, s92, 3072
  buffer_load_dwordx4 v255, s[8:11], s84 offen sc1 lds
  s_mov_b32 m0, 106496
  s_add_u32 s84, s92, 4096
  buffer_load_dwordx4 v255, s[8:11], s84 offen sc1 lds
  s_mov_b32 m0, 107520
  s_add_u32 s84, s92, 5120
  buffer_load_dwordx4 v255, s[8:11], s84 offen sc1 lds
  s_mov_b32 m0, 108544
  s_add_u32 s84, s92, 6144
  buffer_load_dwordx4 v255, s[8:11], s84 offen sc1 lds
  s_mov_b32 m0, 109568
  s_add_u32 s84, s92, 7168
  buffer_load_dwordx4 v255, s[8:11], s84 offen sc1 lds
  s_mov_b32 m0, 110592
  s_add_u32 s84, s92, 8192
  buffer_load_dwordx4 v255, s[8:11], s84 offen sc1 lds
  s_mov_b32 m0, 111616
  s_add_u32 s84, s92, 9216
  buffer_load_dwordx4 v255, s[8:11], s84 offen sc1 lds
  s_mov_b32 m0, 112640
  s_add_u32 s84, s92, 10240
  buffer_load_dwordx4 v255, s[8:11], s84 offen sc1 lds
  s_mov_b32 m0, 113664
  s_add_u32 s84, s92, 11264
  buffer_load_dwordx4 v255, s[8:11], s84 offen sc1 lds
NH_101:
  s_waitcnt vmcnt(0)
  s_mov_b64 exec, 1
  v_mov_b32 v220, 161892
  v_mov_b32 v221, s65
  ds_write_b32 v220, v221
  s_mov_b64 exec, -1
NLF_98:
  s_mov_b32 s67, 4
  s_mov_b32 s68, 8
  s_nop 3
  s_call_b64 s[94:95], L_FULLS
  s_nop 3
  s_cmp_eq_u32 s3, 0
  s_cbranch_scc1 NB3_105
  s_cmp_lg_u32 s42, 0
  s_cbranch_scc1 NRW_106
  s_mov_b32 s90, 0
  s_mov_b32 s89, 47382528
RW_107:
  buffer_load_dwordx4 v[120:123], v255, s[8:11], s89 offen offset:0 sc1
  buffer_load_dwordx4 v[124:127], v255, s[8:11], s89 offen offset:1024 sc1
  buffer_load_dwordx4 v[128:131], v255, s[8:11], s89 offen offset:2048 sc1
  buffer_load_dwordx4 v[132:135], v255, s[8:11], s89 offen offset:3072 sc1
  s_waitcnt vmcnt(0)
  s_mov_b64 s[92:93], 0
  v_cmp_ne_u32 vcc, s7, v120
  s_nop 1
  s_or_b64 s[92:93], s[92:93], vcc
  v_cmp_ne_u32 vcc, s7, v121
  s_nop 1
  s_or_b64 s[92:93], s[92:93], vcc
  v_cmp_ne_u32 vcc, s7, v122
  s_nop 1
  s_or_b64 s[92:93], s[92:93], vcc
  v_cmp_ne_u32 vcc, s7, v123
  s_nop 1
  s_or_b64 s[92:93], s[92:93], vcc
  v_cmp_ne_u32 vcc, s7, v124
  s_nop 1
  s_or_b64 s[92:93], s[92:93], vcc
  v_cmp_ne_u32 vcc, s7, v125
  s_nop 1
  s_or_b64 s[92:93], s[92:93], vcc
  v_cmp_ne_u32 vcc, s7, v126
  s_nop 1
  s_or_b64 s[92:93], s[92:93], vcc
  v_cmp_ne_u32 vcc, s7, v127
  s_nop 1
  s_or_b64 s[92:93], s[92:93], vcc
  v_cmp_ne_u32 vcc, s7, v128
  s_nop 1
  s_or_b64 s[92:93], s[92:93], vcc
  v_cmp_ne_u32 vcc, s7, v129
  s_nop 1
  s_or_b64 s[92:93], s[92:93], vcc
  v_cmp_ne_u32 vcc, s7, v130
  s_nop 1
  s_or_b64 s[92:93], s[92:93], vcc
  v_cmp_ne_u32 vcc, s7, v131
  s_nop 1
  s_or_b64 s[92:93], s[92:93], vcc
  v_cmp_ne_u32 vcc, s7, v132
  s_nop 1
  s_or_b64 s[92:93], s[92:93], vcc
  v_cmp_ne_u32 vcc, s7, v133
  s_nop 1
  s_or_b64 s[92:93], s[92:93], vcc
  v_cmp_ne_u32 vcc, s7, v134
  s_nop 1
  s_or_b64 s[92:93], s[92:93], vcc
  v_cmp_ne_u32 vcc, s7, v135
  s_nop 1
  s_or_b64 s[92:93], s[92:93], vcc
  s_add_u32 s90, s90, 1
  s_cmp_eq_u64 s[92:93], 0
  s_cbranch_scc1 RWD_108
  s_cmp_lt_u32 s90, 0x40000
  s_cbranch_scc1 RW_107
RWD_108:
NRW_106:
  s_sub_u32 s67, s3, 1
B2L_104:
  s_and_b32 s84, s67, 1
  s_mul_i32 s84, s84, 10
  s_lshr_b32 s85, s67, 1
  s_add_u32 s84, s84, s85
  s_mul_i32 s84, s84, 40
  s_and_b32 s86, s5, 7
  s_mul_i32 s86, s86, 5
  s_add_u32 s84, s84, s86
  s_lshl_b32 s84, s84, 10
  s_add_u32 s84, s84, 56623104
  s_mul_i32 s85, s67, 5120
  s_add_u32 m0, s85, 0
  s_add_u32 s86, s84, 0
  buffer_load_dwordx4 v255, s[8:11], s86 offen sc1 lds
  s_add_u32 m0, s85, 1024
  s_add_u32 s86, s84, 1024
  buffer_load_dwordx4 v255, s[8:11], s86 offen sc1 lds
  s_add_u32 m0, s85, 2048
  s_add_u32 s86, s84, 2048
  buffer_load_dwordx4 v255, s[8:11], s86 offen sc1 lds
  s_add_u32 m0, s85, 3072
  s_add_u32 s86, s84, 3072
  buffer_load_dwordx4 v255, s[8:11], s86 offen sc1 lds
  s_add_u32 m0, s85, 4096
  s_add_u32 s86, s84, 4096
  buffer_load_dwordx4 v255, s[8:11], s86 offen sc1 lds
  s_add_u32 s67, s67, 3
  s_cmp_lt_u32 s67, 20
  s_cbranch_scc1 B2L_104
NB3_105:
  s_branch ZE_95
ZL_94:
  s_cmp_eq_u32 s4, 0
  s_cbranch_scc1 NZ_109
  s_mov_b32 s92, 161892
  v_mov_b32 v220, s92
  s_mov_b32 s90, 0
LW_110:
  ds_read_b32 v216, v220
  s_waitcnt lgkmcnt(0)
  v_readfirstlane_b32 s91, v216
  s_add_u32 s90, s90, 1
  s_cmp_ge_u32 s91, s65
  s_cbranch_scc1 LWD_111
  s_sleep 1
  s_cmp_lt_u32 s90, 0x400000
  s_cbranch_scc1 LW_110
LWD_111:
  s_sub_u32 s67, 3, s64
  s_add_u32 s68, s64, 1
  s_nop 3
  s_call_b64 s[94:95], L_FULLS
  s_nop 3
  s_mul_i32 s84, s64, 3072
  s_add_u32 s84, s84, 102400
  v_add_u32 v80, s84, v255
  v_add_u32 v81, s84, v192
  v_add_u32 v82, s84, v193
  ds_read_b128 v[64:67], v80
  ds_read_b128 v[68:71], v80 offset:1536
  ds_read_b64_tr_b16 v[72:73], v81
  ds_read_b64_tr_b16 v[74:75], v81 offset:1536
  ds_read_b64_tr_b16 v[76:77], v82
  ds_read_b64_tr_b16 v[78:79], v82 offset:1536
  s_waitcnt lgkmcnt(4)
  v_mfma_f32_16x16x32_bf16 v[24:27], v[64:67], v[164:167], v[0:3]
  v_mfma_f32_16x16x32_bf16 v[32:35], v[68:71], v[164:167], v[0:3]
  v_mfma_f32_16x16x32_bf16 v[36:39], v[68:71], v[168:171], v[4:7]
  v_mov_b32 v86, 0xf149f2ca
  v_mov_b32 v28, v86
  v_mov_b32 v29, v86
  v_mov_b32 v30, v86
  v_mov_b32 v31, v86
  s_nop 0
  v_cndmask_b32 v24, v24, v86, s[76:77]
  v_cndmask_b32 v25, v25, v86, s[78:79]
  v_cndmask_b32 v26, v26, v86, s[80:81]
  v_cndmask_b32 v27, v27, v86, s[82:83]
  v_cndmask_b32 v36, v36, v86, s[76:77]
  v_cndmask_b32 v37, v37, v86, s[78:79]
  v_cndmask_b32 v38, v38, v86, s[80:81]
  v_cndmask_b32 v39, v39, v86, s[82:83]
  v_max3_f32 v84, v24, v25, v26
  v_max3_f32 v85, v28, v29, v30
  v_max3_f32 v86, v27, v32, v33
  v_max3_f32 v87, v31, v36, v37
  v_max3_f32 v84, v84, v34, v35
  v_max3_f32 v85, v85, v38, v39
  v_max_f32 v84, v84, v86
  v_max_f32 v85, v85, v87
  v_max_f32 v86, v84, v85
  v_cmp_lt_f32 vcc, s66, v86
  s_cbranch_vccnz AR_112
AB_113:
  v_exp_f32 v24, v24
  v_exp_f32 v25, v25
  v_exp_f32 v26, v26
  v_exp_f32 v27, v27
  v_exp_f32 v32, v32
  v_exp_f32 v33, v33
  v_exp_f32 v34, v34
  v_exp_f32 v35, v35
  v_cvt_pk_bf16_f32 v56, v24, v25
  v_cvt_pk_bf16_f32 v57, v26, v27
  v_cvt_pk_bf16_f32 v58, v32, v33
  v_cvt_pk_bf16_f32 v59, v34, v35
  s_waitcnt lgkmcnt(0)
  s_nop 0
  v_mfma_f32_16x16x32_bf16 v[8:11], v[72:75], v[56:59], v[8:11]
  v_exp_f32 v28, v28
  v_exp_f32 v29, v29
  v_mfma_f32_16x16x32_bf16 v[16:19], v[76:79], v[56:59], v[16:19]
  v_exp_f32 v30, v30
  v_exp_f32 v31, v31
  v_exp_f32 v36, v36
  v_exp_f32 v37, v37
  v_exp_f32 v38, v38
  v_exp_f32 v39, v39
  v_cvt_pk_bf16_f32 v60, v28, v29
  v_cvt_pk_bf16_f32 v61, v30, v31
  v_cvt_pk_bf16_f32 v62, v36, v37
  v_cvt_pk_bf16_f32 v63, v38, v39
  s_nop 1
  v_mfma_f32_16x16x32_bf16 v[12:15], v[72:75], v[60:63], v[12:15]
  v_mfma_f32_16x16x32_bf16 v[20:23], v[76:79], v[60:63], v[20:23]
  s_nop 7
NZ_109:
ZE_95:
  s_mov_b32 s92, 161812
  s_mov_b32 s93, 1
  v_mov_b32 v220, s92
  s_mov_b32 s90, 0
LW_114:
  ds_read_b32 v216, v220
  s_waitcnt lgkmcnt(0)
  v_readfirstlane_b32 s91, v216
  s_add_u32 s90, s90, 1
  s_cmp_ge_u32 s91, s93
  s_cbranch_scc1 LWD_115
  s_sleep 1
  s_cmp_lt_u32 s90, 0x400000
  s_cbranch_scc1 LW_114
LWD_115:
  s_sub_u32 s6, s91, 1
  s_cmp_eq_u32 s6, 0
  s_cselect_b32 s45, s43, s45
  s_cselect_b32 s50, s43, s50
  s_lshl_b32 s84, s4, 4
  s_lshl_b32 s85, s64, 1
  s_add_u32 s84, s84, s85
  s_mul_i32 s84, s84, 20480
  s_add_u32 s84, s84, s47
  s_lshr_b32 s85, s5, 1
  s_lshl_b32 s85, s85, 10
  s_and_b32 s86, s5, 1
  s_lshl_b32 s86, s86, 3
  s_add_u32 s85, s85, s86
  s_add_u32 s85, s85, s84
  s_lshr_b32 s86, s5, 3
  s_add_u32 s86, s86, 16
  s_lshl_b32 s86, s86, 10
  s_and_b32 s87, s5, 3
  s_lshl_b32 s87, s87, 8
  s_add_u32 s86, s86, s87
  s_bfe_u32 s87, s5, 0x10002
  s_lshl_b32 s87, s87, 3
  s_add_u32 s86, s86, s87
  s_add_u32 s86, s86, s84
  s_add_u32 s87, s85, 20480
  s_add_u32 s88, s86, 20480
  v_mov_b32 v100, v16
  v_mov_b32 v101, v16
  v_mov_b32 v102, v20
  v_mov_b32 v103, v20
  v_permlane16_swap_b32 v100, v101
  s_nop 0
  v_permlane16_swap_b32 v102, v103
  v_rcp_f32 v101, v101
  v_rcp_f32 v103, v103
  v_mul_f32 v8, v8, v101
  v_mul_f32 v9, v9, v101
  v_mul_f32 v10, v10, v101
  v_mul_f32 v11, v11, v101
  v_mul_f32 v16, v16, v101
  v_mul_f32 v17, v17, v101
  v_mul_f32 v18, v18, v101
  v_mul_f32 v19, v19, v101
  v_mul_f32 v12, v12, v103
  v_mul_f32 v13, v13, v103
  v_mul_f32 v14, v14, v103
  v_mul_f32 v15, v15, v103
  v_mul_f32 v20, v20, v103
  v_mul_f32 v21, v21, v103
  v_mul_f32 v22, v22, v103
  v_mul_f32 v23, v23, v103
  v_cvt_pk_bf16_f32 v104, v8, v9
  v_cvt_pk_bf16_f32 v105, v10, v11
  v_cvt_pk_bf16_f32 v106, v16, v17
  v_cvt_pk_bf16_f32 v107, v18, v19
  v_cvt_pk_bf16_f32 v108, v12, v13
  v_cvt_pk_bf16_f32 v109, v14, v15
  v_cvt_pk_bf16_f32 v110, v20, v21
  v_cvt_pk_bf16_f32 v111, v22, v23
  s_nop 3
  s_cmp_lg_u32 s6, 0
  s_cbranch_scc1 HS_116
  buffer_store_dwordx2 v[104:105], v255, s[8:11], s85 offen
  buffer_store_dwordx2 v[108:109], v255, s[8:11], s87 offen
  s_mov_b64 exec, 0xffff
  buffer_store_dwordx2 v[106:107], v255, s[8:11], s86 offen
  buffer_store_dwordx2 v[110:111], v255, s[8:11], s88 offen
  s_mov_b64 exec, -1
  s_branch HE_117
HS_116:
  buffer_store_dwordx2 v[104:105], v255, s[8:11], s85 offen sc1
  buffer_store_dwordx2 v[108:109], v255, s[8:11], s87 offen sc1
  s_mov_b64 exec, 0xffff
  buffer_store_dwordx2 v[106:107], v255, s[8:11], s86 offen sc1
  buffer_store_dwordx2 v[110:111], v255, s[8:11], s88 offen sc1
  s_mov_b64 exec, -1
HE_117:
  s_nop 1
  s_waitcnt vmcnt(0) lgkmcnt(0)
  s_setprio 0
  s_barrier
  s_cmp_ge_u32 s3, 4
  s_cbranch_scc1 L_HATT
  s_branch L_CATT
  s_endpgm
L_FULLS:
  s_cmp_eq_u32 s67, 0
  s_cbranch_scc1 FR_68
  s_mul_i32 s84, s68, 3072
  s_add_u32 s84, s84, 102400
  v_add_u32 v80, s84, v255
  v_add_u32 v81, s84, v192
  v_add_u32 v82, s84, v193
  ds_read_b128 v[64:67], v80
  ds_read_b128 v[68:71], v80 offset:1536
  s_waitcnt lgkmcnt(0)
  v_mfma_f32_16x16x32_bf16 v[24:27], v[64:67], v[164:167], v[0:3]
  v_mfma_f32_16x16x32_bf16 v[32:35], v[68:71], v[164:167], v[0:3]
  v_mfma_f32_16x16x32_bf16 v[28:31], v[64:67], v[168:171], v[4:7]
  v_mfma_f32_16x16x32_bf16 v[36:39], v[68:71], v[168:171], v[4:7]
  v_add_u32 v80, 3072, v80
  ds_read_b128 v[64:67], v80
  ds_read_b128 v[68:71], v80 offset:1536
  ds_read_b64_tr_b16 v[72:73], v81
  ds_read_b64_tr_b16 v[74:75], v81 offset:1536
  ds_read_b64_tr_b16 v[76:77], v82
  ds_read_b64_tr_b16 v[78:79], v82 offset:1536
  v_add_u32 v81, 3072, v81
  v_add_u32 v82, 3072, v82
  v_max3_f32 v84, v24, v25, v26
  v_max3_f32 v85, v28, v29, v30
  v_max3_f32 v86, v27, v32, v33
  v_max3_f32 v87, v31, v36, v37
  v_max3_f32 v84, v84, v34, v35
  v_max3_f32 v85, v85, v38, v39
  v_max_f32 v84, v84, v86
  v_max_f32 v85, v85, v87
  v_max_f32 v86, v84, v85
  v_cmp_lt_f32 vcc, s66, v86
  s_cbranch_vccnz AR_69
AB_70:
  s_sub_u32 s67, s67, 1
  s_cmp_eq_u32 s67, 0
  s_cbranch_scc1 ST0_73
SA_71:
  s_waitcnt lgkmcnt(4)
  v_mfma_f32_16x16x32_bf16 v[40:43], v[64:67], v[164:167], v[0:3]
  v_exp_f32 v24, v24
  v_exp_f32 v25, v25
  v_mfma_f32_16x16x32_bf16 v[48:51], v[68:71], v[164:167], v[0:3]
  v_exp_f32 v26, v26
  v_exp_f32 v27, v27
  v_mfma_f32_16x16x32_bf16 v[44:47], v[64:67], v[168:171], v[4:7]
  v_exp_f32 v32, v32
  v_exp_f32 v33, v33
  v_mfma_f32_16x16x32_bf16 v[52:55], v[68:71], v[168:171], v[4:7]
  v_exp_f32 v34, v34
  v_exp_f32 v35, v35
  v_add_u32 v80, 3072, v80
  v_cvt_pk_bf16_f32 v56, v24, v25
  v_cvt_pk_bf16_f32 v57, v26, v27
  ds_read_b128 v[64:67], v80
  ds_read_b128 v[68:71], v80 offset:1536
  v_cvt_pk_bf16_f32 v58, v32, v33
  v_cvt_pk_bf16_f32 v59, v34, v35
  s_waitcnt lgkmcnt(2)
  s_nop 0
  v_mfma_f32_16x16x32_bf16 v[8:11], v[72:75], v[56:59], v[8:11]
  v_exp_f32 v28, v28
  v_exp_f32 v29, v29
  v_mfma_f32_16x16x32_bf16 v[16:19], v[76:79], v[56:59], v[16:19]
  v_exp_f32 v30, v30
  v_exp_f32 v31, v31
  v_exp_f32 v36, v36
  v_exp_f32 v37, v37
  v_exp_f32 v38, v38
  v_exp_f32 v39, v39
  v_cvt_pk_bf16_f32 v60, v28, v29
  v_cvt_pk_bf16_f32 v61, v30, v31
  v_cvt_pk_bf16_f32 v62, v36, v37
  v_cvt_pk_bf16_f32 v63, v38, v39
  v_max3_f32 v84, v40, v41, v42
  v_max3_f32 v85, v44, v45, v46
  v_mfma_f32_16x16x32_bf16 v[12:15], v[72:75], v[60:63], v[12:15]
  v_max3_f32 v86, v43, v48, v49
  v_max3_f32 v87, v47, v52, v53
  v_mfma_f32_16x16x32_bf16 v[20:23], v[76:79], v[60:63], v[20:23]
  v_max3_f32 v84, v84, v50, v51
  v_max3_f32 v85, v85, v54, v55
  v_max_f32 v84, v84, v86
  v_max_f32 v85, v85, v87
  ds_read_b64_tr_b16 v[72:73], v81
  ds_read_b64_tr_b16 v[74:75], v81 offset:1536
  ds_read_b64_tr_b16 v[76:77], v82
  ds_read_b64_tr_b16 v[78:79], v82 offset:1536
  v_add_u32 v81, 3072, v81
  v_add_u32 v82, 3072, v82
  v_max_f32 v86, v84, v85
  v_cmp_lt_f32 vcc, s66, v86
  s_cbranch_vccnz AR_75
AB_76:
  s_sub_u32 s67, s67, 1
  s_cmp_eq_u32 s67, 0
  s_cbranch_scc1 ST1_74
SB_72:
  s_waitcnt lgkmcnt(4)
  v_mfma_f32_16x16x32_bf16 v[24:27], v[64:67], v[164:167], v[0:3]
  v_exp_f32 v40, v40
  v_exp_f32 v41, v41
  v_mfma_f32_16x16x32_bf16 v[32:35], v[68:71], v[164:167], v[0:3]
  v_exp_f32 v42, v42
  v_exp_f32 v43, v43
  v_mfma_f32_16x16x32_bf16 v[28:31], v[64:67], v[168:171], v[4:7]
  v_exp_f32 v48, v48
  v_exp_f32 v49, v49
  v_mfma_f32_16x16x32_bf16 v[36:39], v[68:71], v[168:171], v[4:7]
  v_exp_f32 v50, v50
  v_exp_f32 v51, v51
  v_add_u32 v80, 3072, v80
  v_cvt_pk_bf16_f32 v56, v40, v41
  v_cvt_pk_bf16_f32 v57, v42, v43
  ds_read_b128 v[64:67], v80
  ds_read_b128 v[68:71], v80 offset:1536
  v_cvt_pk_bf16_f32 v58, v48, v49
  v_cvt_pk_bf16_f32 v59, v50, v51
  s_waitcnt lgkmcnt(2)
  s_nop 0
  v_mfma_f32_16x16x32_bf16 v[8:11], v[72:75], v[56:59], v[8:11]
  v_exp_f32 v44, v44
  v_exp_f32 v45, v45
  v_mfma_f32_16x16x32_bf16 v[16:19], v[76:79], v[56:59], v[16:19]
  v_exp_f32 v46, v46
  v_exp_f32 v47, v47
  v_exp_f32 v52, v52
  v_exp_f32 v53, v53
  v_exp_f32 v54, v54
  v_exp_f32 v55, v55
  v_cvt_pk_bf16_f32 v60, v44, v45
  v_cvt_pk_bf16_f32 v61, v46, v47
  v_cvt_pk_bf16_f32 v62, v52, v53
  v_cvt_pk_bf16_f32 v63, v54, v55
  v_max3_f32 v84, v24, v25, v26
  v_max3_f32 v85, v28, v29, v30
  v_mfma_f32_16x16x32_bf16 v[12:15], v[72:75], v[60:63], v[12:15]
  v_max3_f32 v86, v27, v32, v33
  v_max3_f32 v87, v31, v36, v37
  v_mfma_f32_16x16x32_bf16 v[20:23], v[76:79], v[60:63], v[20:23]
  v_max3_f32 v84, v84, v34, v35
  v_max3_f32 v85, v85, v38, v39
  v_max_f32 v84, v84, v86
  v_max_f32 v85, v85, v87
  ds_read_b64_tr_b16 v[72:73], v81
  ds_read_b64_tr_b16 v[74:75], v81 offset:1536
  ds_read_b64_tr_b16 v[76:77], v82
  ds_read_b64_tr_b16 v[78:79], v82 offset:1536
  v_add_u32 v81, 3072, v81
  v_add_u32 v82, 3072, v82
  v_max_f32 v86, v84, v85
  v_cmp_lt_f32 vcc, s66, v86
  s_cbranch_vccnz AR_77
AB_78:
  s_sub_u32 s67, s67, 1
  s_cmp_lg_u32 s67, 0
  s_cbranch_scc1 SA_71
ST0_73:
  s_nop 2
  v_exp_f32 v24, v24
  v_exp_f32 v25, v25
  v_exp_f32 v26, v26
  v_exp_f32 v27, v27
  v_exp_f32 v32, v32
  v_exp_f32 v33, v33
  v_exp_f32 v34, v34
  v_exp_f32 v35, v35
  v_cvt_pk_bf16_f32 v56, v24, v25
  v_cvt_pk_bf16_f32 v57, v26, v27
  v_cvt_pk_bf16_f32 v58, v32, v33
  v_cvt_pk_bf16_f32 v59, v34, v35
  s_waitcnt lgkmcnt(0)
  s_nop 0
  v_mfma_f32_16x16x32_bf16 v[8:11], v[72:75], v[56:59], v[8:11]
  v_exp_f32 v28, v28
  v_exp_f32 v29, v29
  v_mfma_f32_16x16x32_bf16 v[16:19], v[76:79], v[56:59], v[16:19]
  v_exp_f32 v30, v30
  v_exp_f32 v31, v31
  v_exp_f32 v36, v36
  v_exp_f32 v37, v37
  v_exp_f32 v38, v38
  v_exp_f32 v39, v39
  v_cvt_pk_bf16_f32 v60, v28, v29
  v_cvt_pk_bf16_f32 v61, v30, v31
  v_cvt_pk_bf16_f32 v62, v36, v37
  v_cvt_pk_bf16_f32 v63, v38, v39
  s_nop 1
  v_mfma_f32_16x16x32_bf16 v[12:15], v[72:75], v[60:63], v[12:15]
  v_mfma_f32_16x16x32_bf16 v[20:23], v[76:79], v[60:63], v[20:23]
  s_branch FR_68
ST1_74:
  s_nop 2
  v_exp_f32 v40, v40
  v_exp_f32 v41, v41
  v_exp_f32 v42, v42
  v_exp_f32 v43, v43
  v_exp_f32 v48, v48
  v_exp_f32 v49, v49
  v_exp_f32 v50, v50
  v_exp_f32 v51, v51
  v_cvt_pk_bf16_f32 v56, v40, v41
  v_cvt_pk_bf16_f32 v57, v42, v43
  v_cvt_pk_bf16_f32 v58, v48, v49
  v_cvt_pk_bf16_f32 v59, v50, v51
  s_waitcnt lgkmcnt(0)
  s_nop 0
  v_mfma_f32_16x16x32_bf16 v[8:11], v[72:75], v[56:59], v[8:11]
  v_exp_f32 v44, v44
  v_exp_f32 v45, v45
  v_mfma_f32_16x16x32_bf16 v[16:19], v[76:79], v[56:59], v[16:19]
  v_exp_f32 v46, v46
  v_exp_f32 v47, v47
  v_exp_f32 v52, v52
  v_exp_f32 v53, v53
  v_exp_f32 v54, v54
  v_exp_f32 v55, v55
  v_cvt_pk_bf16_f32 v60, v44, v45
  v_cvt_pk_bf16_f32 v61, v46, v47
  v_cvt_pk_bf16_f32 v62, v52, v53
  v_cvt_pk_bf16_f32 v63, v54, v55
  s_nop 1
  v_mfma_f32_16x16x32_bf16 v[12:15], v[72:75], v[60:63], v[12:15]
  v_mfma_f32_16x16x32_bf16 v[20:23], v[76:79], v[60:63], v[20:23]
FR_68:
  s_nop 7
  s_setpc_b64 s[94:95]
AR_69:
  s_nop 7
  s_nop 7
  v_mov_b32 v86, v84
  v_mov_b32 v87, v85
  s_nop 0
  v_permlane16_swap_b32 v84, v86
  v_permlane16_swap_b32 v85, v87
  v_max_f32 v84, v84, v86
  v_max_f32 v85, v85, v87
  v_mov_b32 v86, v84
  v_mov_b32 v87, v85
  s_nop 0
  v_permlane32_swap_b32 v84, v86
  v_permlane32_swap_b32 v85, v87
  v_max_f32 v84, v84, v86
  v_max_f32 v85, v85, v87
  v_max_f32 v84, 0, v84
  v_sub_f32 v24, v24, v84
  v_sub_f32 v25, v25, v84
  v_sub_f32 v26, v26, v84
  v_sub_f32 v27, v27, v84
  v_sub_f32 v32, v32, v84
  v_sub_f32 v33, v33, v84
  v_sub_f32 v34, v34, v84
  v_sub_f32 v35, v35, v84
  v_sub_f32 v0, v0, v84
  v_sub_f32 v1, v1, v84
  v_sub_f32 v2, v2, v84
  v_sub_f32 v3, v3, v84
  v_sub_f32 v86, 0, v84
  v_exp_f32 v86, v86
  s_nop 1
  v_mul_f32 v8, v8, v86
  v_mul_f32 v9, v9, v86
  v_mul_f32 v10, v10, v86
  v_mul_f32 v11, v11, v86
  v_mul_f32 v16, v16, v86
  v_mul_f32 v17, v17, v86
  v_mul_f32 v18, v18, v86
  v_mul_f32 v19, v19, v86
  v_max_f32 v85, 0, v85
  v_sub_f32 v28, v28, v85
  v_sub_f32 v29, v29, v85
  v_sub_f32 v30, v30, v85
  v_sub_f32 v31, v31, v85
  v_sub_f32 v36, v36, v85
  v_sub_f32 v37, v37, v85
  v_sub_f32 v38, v38, v85
  v_sub_f32 v39, v39, v85
  v_sub_f32 v4, v4, v85
  v_sub_f32 v5, v5, v85
  v_sub_f32 v6, v6, v85
  v_sub_f32 v7, v7, v85
  v_sub_f32 v86, 0, v85
  v_exp_f32 v86, v86
  s_nop 1
  v_mul_f32 v12, v12, v86
  v_mul_f32 v13, v13, v86
  v_mul_f32 v14, v14, v86
  v_mul_f32 v15, v15, v86
  v_mul_f32 v20, v20, v86
  v_mul_f32 v21, v21, v86
  v_mul_f32 v22, v22, v86
  v_mul_f32 v23, v23, v86
  s_nop 7
  s_branch AB_70
AR_75:
  s_nop 7
  s_nop 7
  v_mov_b32 v86, v84
  v_mov_b32 v87, v85
  s_nop 0
  v_permlane16_swap_b32 v84, v86
  v_permlane16_swap_b32 v85, v87
  v_max_f32 v84, v84, v86
  v_max_f32 v85, v85, v87
  v_mov_b32 v86, v84
  v_mov_b32 v87, v85
  s_nop 0
  v_permlane32_swap_b32 v84, v86
  v_permlane32_swap_b32 v85, v87
  v_max_f32 v84, v84, v86
  v_max_f32 v85, v85, v87
  v_max_f32 v84, 0, v84
  v_sub_f32 v40, v40, v84
  v_sub_f32 v41, v41, v84
  v_sub_f32 v42, v42, v84
  v_sub_f32 v43, v43, v84
  v_sub_f32 v48, v48, v84
  v_sub_f32 v49, v49, v84
  v_sub_f32 v50, v50, v84
  v_sub_f32 v51, v51, v84
  v_sub_f32 v0, v0, v84
  v_sub_f32 v1, v1, v84
  v_sub_f32 v2, v2, v84
  v_sub_f32 v3, v3, v84
  v_sub_f32 v86, 0, v84
  v_exp_f32 v86, v86
  s_nop 1
  v_mul_f32 v8, v8, v86
  v_mul_f32 v9, v9, v86
  v_mul_f32 v10, v10, v86
  v_mul_f32 v11, v11, v86
  v_mul_f32 v16, v16, v86
  v_mul_f32 v17, v17, v86
  v_mul_f32 v18, v18, v86
  v_mul_f32 v19, v19, v86
  v_max_f32 v85, 0, v85
  v_sub_f32 v44, v44, v85
  v_sub_f32 v45, v45, v85
  v_sub_f32 v46, v46, v85
  v_sub_f32 v47, v47, v85
  v_sub_f32 v52, v52, v85
  v_sub_f32 v53, v53, v85
  v_sub_f32 v54, v54, v85
  v_sub_f32 v55, v55, v85
  v_sub_f32 v4, v4, v85
  v_sub_f32 v5, v5, v85
  v_sub_f32 v6, v6, v85
  v_sub_f32 v7, v7, v85
  v_sub_f32 v86, 0, v85
  v_exp_f32 v86, v86
  s_nop 1
  v_mul_f32 v12, v12, v86
  v_mul_f32 v13, v13, v86
  v_mul_f32 v14, v14, v86
  v_mul_f32 v15, v15, v86
  v_mul_f32 v20, v20, v86
  v_mul_f32 v21, v21, v86
  v_mul_f32 v22, v22, v86
  v_mul_f32 v23, v23, v86
  s_nop 7
  s_branch AB_76
AR_77:
  s_nop 7
  s_nop 7
  v_mov_b32 v86, v84
  v_mov_b32 v87, v85
  s_nop 0
  v_permlane16_swap_b32 v84, v86
  v_permlane16_swap_b32 v85, v87
  v_max_f32 v84, v84, v86
  v_max_f32 v85, v85, v87
  v_mov_b32 v86, v84
  v_mov_b32 v87, v85
  s_nop 0
  v_permlane32_swap_b32 v84, v86
  v_permlane32_swap_b32 v85, v87
  v_max_f32 v84, v84, v86
  v_max_f32 v85, v85, v87
  v_max_f32 v84, 0, v84
  v_sub_f32 v24, v24, v84
  v_sub_f32 v25, v25, v84
  v_sub_f32 v26, v26, v84
  v_sub_f32 v27, v27, v84
  v_sub_f32 v32, v32, v84
  v_sub_f32 v33, v33, v84
  v_sub_f32 v34, v34, v84
  v_sub_f32 v35, v35, v84
  v_sub_f32 v0, v0, v84
  v_sub_f32 v1, v1, v84
  v_sub_f32 v2, v2, v84
  v_sub_f32 v3, v3, v84
  v_sub_f32 v86, 0, v84
  v_exp_f32 v86, v86
  s_nop 1
  v_mul_f32 v8, v8, v86
  v_mul_f32 v9, v9, v86
  v_mul_f32 v10, v10, v86
  v_mul_f32 v11, v11, v86
  v_mul_f32 v16, v16, v86
  v_mul_f32 v17, v17, v86
  v_mul_f32 v18, v18, v86
  v_mul_f32 v19, v19, v86
  v_max_f32 v85, 0, v85
  v_sub_f32 v28, v28, v85
  v_sub_f32 v29, v29, v85
  v_sub_f32 v30, v30, v85
  v_sub_f32 v31, v31, v85
  v_sub_f32 v36, v36, v85
  v_sub_f32 v37, v37, v85
  v_sub_f32 v38, v38, v85
  v_sub_f32 v39, v39, v85
  v_sub_f32 v4, v4, v85
  v_sub_f32 v5, v5, v85
  v_sub_f32 v6, v6, v85
  v_sub_f32 v7, v7, v85
  v_sub_f32 v86, 0, v85
  v_exp_f32 v86, v86
  s_nop 1
  v_mul_f32 v12, v12, v86
  v_mul_f32 v13, v13, v86
  v_mul_f32 v14, v14, v86
  v_mul_f32 v15, v15, v86
  v_mul_f32 v20, v20, v86
  v_mul_f32 v21, v21, v86
  v_mul_f32 v22, v22, v86
  v_mul_f32 v23, v23, v86
  s_nop 7
  s_branch AB_78
AR_92:
  s_nop 7
  s_nop 7
  v_mov_b32 v86, v84
  v_mov_b32 v87, v85
  s_nop 0
  v_permlane16_swap_b32 v84, v86
  v_permlane16_swap_b32 v85, v87
  v_max_f32 v84, v84, v86
  v_max_f32 v85, v85, v87
  v_mov_b32 v86, v84
  v_mov_b32 v87, v85
  s_nop 0
  v_permlane32_swap_b32 v84, v86
  v_permlane32_swap_b32 v85, v87
  v_max_f32 v84, v84, v86
  v_max_f32 v85, v85, v87
  v_max_f32 v84, 0, v84
  v_sub_f32 v24, v24, v84
  v_sub_f32 v25, v25, v84
  v_sub_f32 v26, v26, v84
  v_sub_f32 v27, v27, v84
  v_sub_f32 v32, v32, v84
  v_sub_f32 v33, v33, v84
  v_sub_f32 v34, v34, v84
  v_sub_f32 v35, v35, v84
  v_sub_f32 v0, v0, v84
  v_sub_f32 v1, v1, v84
  v_sub_f32 v2, v2, v84
  v_sub_f32 v3, v3, v84
  v_sub_f32 v86, 0, v84
  v_exp_f32 v86, v86
  s_nop 1
  v_mul_f32 v8, v8, v86
  v_mul_f32 v9, v9, v86
  v_mul_f32 v10, v10, v86
  v_mul_f32 v11, v11, v86
  v_mul_f32 v16, v16, v86
  v_mul_f32 v17, v17, v86
  v_mul_f32 v18, v18, v86
  v_mul_f32 v19, v19, v86
  v_max_f32 v85, 0, v85
  v_sub_f32 v28, v28, v85
  v_sub_f32 v29, v29, v85
  v_sub_f32 v30, v30, v85
  v_sub_f32 v31, v31, v85
  v_sub_f32 v36, v36, v85
  v_sub_f32 v37, v37, v85
  v_sub_f32 v38, v38, v85
  v_sub_f32 v39, v39, v85
  v_sub_f32 v4, v4, v85
  v_sub_f32 v5, v5, v85
  v_sub_f32 v6, v6, v85
  v_sub_f32 v7, v7, v85
  v_sub_f32 v86, 0, v85
  v_exp_f32 v86, v86
  s_nop 1
  v_mul_f32 v12, v12, v86
  v_mul_f32 v13, v13, v86
  v_mul_f32 v14, v14, v86
  v_mul_f32 v15, v15, v86
  v_mul_f32 v20, v20, v86
  v_mul_f32 v21, v21, v86
  v_mul_f32 v22, v22, v86
  v_mul_f32 v23, v23, v86
  s_nop 7
  s_branch AB_93
AR_112:
  s_nop 7
  s_nop 7
  v_mov_b32 v86, v84
  v_mov_b32 v87, v85
  s_nop 0
  v_permlane16_swap_b32 v84, v86
  v_permlane16_swap_b32 v85, v87
  v_max_f32 v84, v84, v86
  v_max_f32 v85, v85, v87
  v_mov_b32 v86, v84
  v_mov_b32 v87, v85
  s_nop 0
  v_permlane32_swap_b32 v84, v86
  v_permlane32_swap_b32 v85, v87
  v_max_f32 v84, v84, v86
  v_max_f32 v85, v85, v87
  v_max_f32 v84, 0, v84
  v_sub_f32 v24, v24, v84
  v_sub_f32 v25, v25, v84
  v_sub_f32 v26, v26, v84
  v_sub_f32 v27, v27, v84
  v_sub_f32 v32, v32, v84
  v_sub_f32 v33, v33, v84
  v_sub_f32 v34, v34, v84
  v_sub_f32 v35, v35, v84
  v_sub_f32 v0, v0, v84
  v_sub_f32 v1, v1, v84
  v_sub_f32 v2, v2, v84
  v_sub_f32 v3, v3, v84
  v_sub_f32 v86, 0, v84
  v_exp_f32 v86, v86
  s_nop 1
  v_mul_f32 v8, v8, v86
  v_mul_f32 v9, v9, v86
  v_mul_f32 v10, v10, v86
  v_mul_f32 v11, v11, v86
  v_mul_f32 v16, v16, v86
  v_mul_f32 v17, v17, v86
  v_mul_f32 v18, v18, v86
  v_mul_f32 v19, v19, v86
  v_max_f32 v85, 0, v85
  v_sub_f32 v28, v28, v85
  v_sub_f32 v29, v29, v85
  v_sub_f32 v30, v30, v85
  v_sub_f32 v31, v31, v85
  v_sub_f32 v36, v36, v85
  v_sub_f32 v37, v37, v85
  v_sub_f32 v38, v38, v85
  v_sub_f32 v39, v39, v85
  v_sub_f32 v4, v4, v85
  v_sub_f32 v5, v5, v85
  v_sub_f32 v6, v6, v85
  v_sub_f32 v7, v7, v85
  v_sub_f32 v86, 0, v85
  v_exp_f32 v86, v86
  s_nop 1
  v_mul_f32 v12, v12, v86
  v_mul_f32 v13, v13, v86
  v_mul_f32 v14, v14, v86
  v_mul_f32 v15, v15, v86
  v_mul_f32 v20, v20, v86
  v_mul_f32 v21, v21, v86
  v_mul_f32 v22, v22, v86
  v_mul_f32 v23, v23, v86
  s_nop 7
  s_branch AB_113
L_EXIT:
  s_endpgm
L_CODE_END:
.section .rodata,"a"
.p2align 6
.amdhsa_kernel interleave_layers__sliding_block__mixer_channel_mlp__prompt_kernel
  .amdhsa_next_free_vgpr 256
  .amdhsa_next_free_sgpr 102
  .amdhsa_accum_offset 256
  .amdhsa_group_segment_fixed_size 0
  .amdhsa_kernarg_size 88
  .amdhsa_user_sgpr_count 2
  .amdhsa_user_sgpr_kernarg_segment_ptr 1
  .amdhsa_system_sgpr_workgroup_id_x 1
.end_amdhsa_kernel
```
